```python
import torch

def _softmax(x, axis=-1):
    return torch.softmax(x, dim=axis)
def _gelu(x):
    return torch.nn.functional.gelu(x, approximate="tanh")
def _silu(x):
    return torch.nn.functional.silu(x)
def _sigmoid(x):
    return torch.sigmoid(x)
def _layernorm(x, axis=-1, eps=1e-5):
    m = x.mean(dim=axis, keepdim=True)
    v = x.var(dim=axis, keepdim=True, unbiased=False)
    return (x - m) / torch.sqrt(v + eps)
def _scatter_add(tgt, idx, src, axis=0):
    return tgt.clone().index_add_(axis, idx, src)
def _segment_sum(src, seg, n):
    out = torch.zeros((n,) + src.shape[1:], dtype=src.dtype)
    return out.index_add_(0, seg, src)
def _pad(x, pw):
    flat = tuple(v for pair in reversed(pw) for v in pair)
    return torch.nn.functional.pad(x, flat)

kernel_name = 'concat_heads__linear_kernel_hedgehog__ssm_conv_s4d__prompt'

def setup_inputs():

    _w = (lambda a: (lambda t: t.to(torch.bfloat16) if t.is_floating_point() else t)(torch.as_tensor(a)))
    def _A_setup():
        B, S, D, H = 1, 2048, 576, 32
        Dh = D // H
        return {
            "x": _w((lambda *s: torch.randn(*s, dtype=torch.bfloat16) * 0.4)(B, S, D)),
            "wqkv": _w((lambda *s: torch.randn(*s, dtype=torch.bfloat16) * 0.4)(D, 3 * D)),
            "w_phi": _w((lambda *s: torch.randn(*s, dtype=torch.bfloat16) * 0.4)(H, Dh, Dh) * (Dh ** -0.5)),
            "wo": _w((lambda *s: torch.randn(*s, dtype=torch.bfloat16) * 0.05)(D, D)),
        }
    _A_in = _A_setup()

    def _B_setup():
        Bsz, L, D, N = 1, 2048, 576, 128
        return {
            "u": _w((lambda *s: torch.randn(*s, dtype=torch.bfloat16) * 0.05)(Bsz, L, D)),
            "log_A_real": _w((lambda *s: torch.randn(*s, dtype=torch.bfloat16) * 3.2)(D, N) * 0.5),
            "A_imag": _w((lambda *s: torch.randn(*s, dtype=torch.bfloat16) * 0.2)(D, N) * 3.14),
            "C_real": _w((lambda *s: torch.randn(*s, dtype=torch.bfloat16) * 3.2)(D, N) / N ** 0.5),
            "C_imag": _w((lambda *s: torch.randn(*s, dtype=torch.bfloat16) * 3.2)(D, N) / N ** 0.5),
            "log_dt": _w((lambda *s: torch.randn(*s, dtype=torch.bfloat16) * 0.2)(D) * 0.5 - 4.0),
            "D_skip": _w((lambda *s: torch.randn(*s, dtype=torch.bfloat16) * 0.4)(D)),
        }
    _B_in = _B_setup()

    return {
        "A_x": _A_in["x"],
        "A_wqkv": _A_in["wqkv"],
        "A_w_phi": _A_in["w_phi"],
        "A_wo": _A_in["wo"],
        "B_u": _B_in["u"],
        "B_log_A_real": _B_in["log_A_real"],
        "B_A_imag": _B_in["A_imag"],
        "B_C_real": _B_in["C_real"],
        "B_C_imag": _B_in["C_imag"],
        "B_log_dt": _B_in["log_dt"],
        "B_D_skip": _B_in["D_skip"],
    }

def reference(A_x, A_wqkv, A_w_phi, A_wo, B_u, B_log_A_real, B_A_imag, B_C_real, B_C_imag, B_log_dt, B_D_skip):
    def _A_ref(x, wqkv, w_phi, wo):
        B, S, D = x.shape
        H = 32; Dh = D // H
        qkv = (lambda x, *d: x.permute(*d))((x @ wqkv).reshape(B, S, 3, H, Dh), 2, 0, 3, 1, 4)
        q, k, v = qkv[0], qkv[1], qkv[2]
        pq = torch.einsum("bhsd,hdf->bhsf", q, w_phi)
        pk = torch.einsum("bhsd,hdf->bhsf", k, w_phi)
        phi_q = torch.concatenate([_softmax(pq, axis=-1), _softmax(-pq, axis=-1)], axis=-1)
        phi_k = torch.concatenate([_softmax(pk, axis=-1), _softmax(-pk, axis=-1)], axis=-1)
        kv = torch.einsum("bhsf,bhsd->bhfd", phi_k, v)
        z  = torch.einsum("bhsf->bhf", phi_k)
        num = torch.einsum("bhqf,bhfd->bhqd", phi_q, kv)
        den = torch.einsum("bhqf,bhf->bhq", phi_q, z)[..., None] + 1e-6
        o = num / den
        return (lambda x, *d: x.permute(*d))(o, 0, 2, 1, 3).reshape(B, S, D) @ wo

    def _B_ref(u, log_A_real, A_imag, C_real, C_imag, log_dt, D_skip):
        L = u.shape[1]
        dt = torch.exp(log_dt)
        A = -torch.exp(log_A_real) + 1j * A_imag
        C = (C_real + 1j * C_imag) * dt[:, None]
        pos = (lambda x, dt: x.to(dt))(torch.arange(L), log_dt.dtype)
        P = torch.exp((A * dt[:, None])[:, :, None] * pos[None, None, :])
        K = 2.0 * torch.einsum("dn,dnl->dl", C, P).real
        L2 = 2 * L
        u_t = (lambda x, *d: x.permute(*d))(u, 0, 2, 1)
        Kf = (lambda x, *a, **k: torch.fft.rfft(x.float(), *a, **k))(K, L2)
        Uf = (lambda x, *a, **k: torch.fft.rfft(x.float(), *a, **k))(u_t, L2)
        y = (lambda x, *a, **k: torch.fft.irfft(x, *a, **k).to(torch.bfloat16))(Uf * Kf[None, :, :], L2)[:, :, :L]
        y = (lambda x, *d: x.permute(*d))(y, 0, 2, 1)
        return y + u * D_skip[None, None, :]

    a = _A_ref(A_x, A_wqkv, A_w_phi, A_wo)
    b = _B_ref(B_u, B_log_A_real, B_A_imag, B_C_real, B_C_imag, B_log_dt, B_D_skip)
    return torch.concatenate([a, b], axis=-1)
```

```asm
; @launch grid=(256,1,1) block=(512,1,1) lds=163840
.amdgcn_target "amdgcn-amd-amdhsa--gfx950"
.text
.globl concat_heads__linear_kernel_hedgehog__ssm_conv_s4d__prompt_kernel
.p2align 8
.type concat_heads__linear_kernel_hedgehog__ssm_conv_s4d__prompt_kernel,@function
concat_heads__linear_kernel_hedgehog__ssm_conv_s4d__prompt_kernel:
s_cmp_ge_u32 s2, 256
s_cbranch_scc1 L_end
s_load_dwordx16 s[36:51], s[0:1], 0
s_load_dwordx8 s[52:59], s[0:1], 64
s_load_dwordx4 s[60:63], s[0:1], 96
s_sub_u32 s3, s2, 8
s_cmp_ge_u32 s3, 16
s_cbranch_scc1 L_nopf
v_readfirstlane_b32 s3, v0
s_cmp_ge_u32 s3, 448
s_cbranch_scc1 L_nopf
s_getpc_b64 s[4:5]
L_pc0:
v_lshlrev_b32 v2, 7, v0
s_sub_u32 s4, s4, L_pc0-concat_heads__linear_kernel_hedgehog__ssm_conv_s4d__prompt_kernel
s_subb_u32 s5, s5, 0
v_min_u32 v2, L_end-concat_heads__linear_kernel_hedgehog__ssm_conv_s4d__prompt_kernel, v2
v_mov_b32 v3, s5
v_add_co_u32 v2, vcc, s4, v2
s_nop 1
v_addc_co_u32 v3, vcc, 0, v3, vcc
global_load_dword v254, v[2:3], off
L_nopf:
s_memrealtime s[96:97]
v_lshrrev_b32 v1, 6, v0
v_and_b32 v0, 63, v0
s_and_b32 s6, s2, 7
v_readfirstlane_b32 s3, v1
v_lshlrev_b32 v2, 2, v0
v_mov_b32 v3, 0
ds_write_b32 v2, v3
s_lshr_b32 s7, s2, 3
s_lshr_b32 s4, s6, 1
s_lshl_b32 s4, s4, 2
s_and_b32 s68, s7, 3
s_add_u32 s4, s4, s68
s_and_b32 s5, s6, 1
s_lshl_b32 s5, s5, 3
s_lshr_b32 s68, s7, 2
s_add_u32 s5, s5, s68
s_lshr_b32 s98, s7, 2
s_and_b32 s68, s7, 3
s_lshl1_add_u32 s98, s68, s98
s_sub_u32 s68, s98, 9
s_cselect_b32 s98, s98, s68
s_lshr_b32 s99, s5, 1
s_add_u32 s99, s99, s4
s_lshl_b32 s99, s99, 1
s_and_b32 s68, s5, 1
s_add_u32 s99, s99, s68
s_lshl_b32 s99, s99, 1
s_and_b32 s99, s99, 15
s_mov_b32 s64, 0x40000
s_mov_b32 s85, 0x05040100
s_mov_b32 s86, 0x07060302
s_cmp_eq_u32 s3, 7
s_cbranch_scc1 L_loader
s_cmp_ge_u32 s3, 4
s_cbranch_scc1 L_bteam
s_lshr_b32 s67, s3, 1
s_xor_b32 s67, s67, 1
s_bitcmp1_b32 s3, 0
s_cselect_b32 s68, 2, 0
s_or_b32 s67, s67, s68
s_setprio 1
v_and_b32 v1, 15, v0
v_lshrrev_b32 v2, 4, v0
v_mov_b32 v3, s3
v_lshlrev_b32 v3, 2, v3
v_lshrrev_b32 v8, 3, v0
v_mul_u32_u24 v8, 1152, v8
v_and_b32 v9, 7, v0
v_xor_b32 v9, v9, v2
v_lshlrev_b32 v9, 4, v9
v_add_u32 v6, v8, v9
v_xor_b32 v7, 64, v6
s_lshl_b32 s80, s4, 7
s_lshl_b32 s68, s3, 5
s_add_u32 s80, s80, s68
s_mul_i32 s80, s80, 1152
s_mul_i32 s81, s3, 12288
s_add_u32 s81, s81, 43264
s_lshl_b32 s88, s98, 7
s_add_u32 s88, s88, s80
s_add_u32 s89, s80, 1152
v_lshlrev_b32 v10, 4, v0
v_add_u32 v11, 1024, v10
v_mov_b32 v12, 0x40000000
v_cmp_gt_u32 vcc, 17, v0
s_nop 1
v_cndmask_b32 v11, v12, v11, vcc
v_lshrrev_b32 v12, 2, v1
v_and_b32 v12, 1, v12
v_mul_u32_u24 v12, 9, v12
v_and_b32 v13, 3, v1
v_add_u32 v12, v12, v13
v_lshlrev_b32 v12, 1, v12
v_mul_u32_u24 v13, 144, v2
v_add_u32 v12, v12, v13
v_add_u32 v40, 98560, v12
v_mov_b32 v12, 0x80008000
v_cmp_lt_u32 vcc, 7, v1
s_nop 1
v_cndmask_b32 v41, 0, v12, vcc
s_waitcnt lgkmcnt(0)
s_mov_b32 s8, s36
s_mov_b32 s9, s37
s_mov_b32 s10, 0x240000
s_mov_b32 s11, 0x20000
s_add_u32 m0, s81, 0
s_nop 0
buffer_load_dwordx4 v6, s[8:11], s88 offen lds
s_add_u32 m0, s81, 1024
s_add_u32 s68, s88, 9216
buffer_load_dwordx4 v7, s[8:11], s68 offen lds
s_add_u32 m0, s81, 2048
s_add_u32 s68, s88, 18432
buffer_load_dwordx4 v6, s[8:11], s68 offen lds
s_add_u32 m0, s81, 3072
s_add_u32 s68, s88, 27648
buffer_load_dwordx4 v7, s[8:11], s68 offen lds
s_add_u32 s88, s88, 128
s_cmp_eq_u32 s88, s89
s_cselect_b32 s88, s80, s88
s_mov_b32 s24, s40
s_mov_b32 s25, s41
s_mov_b32 s26, 0x5100
s_mov_b32 s27, 0x20000
s_mul_i32 s69, s5, 1296
s_mov_b32 m0, 98560
s_mov_b32 exec_hi, -1
buffer_load_dwordx4 v10, s[24:27], s69 offen lds
s_mov_b32 m0, 99584
s_mov_b32 exec_hi, 0
buffer_load_dwordx4 v11, s[24:27], s69 offen lds
s_mov_b32 exec_hi, -1
s_barrier
s_mov_b32 s16, s62
s_mov_b32 s17, s63
s_mov_b32 s18, 0x2000000
s_mov_b32 s19, 0x20000
s_mov_b32 s20, s58
s_mov_b32 s21, s59
s_mov_b32 s22, 0x480000
s_mov_b32 s23, 0x20000
s_add_u32 m0, s81, 4096
s_nop 0
buffer_load_dwordx4 v6, s[8:11], s88 offen lds
s_add_u32 m0, s81, 5120
s_add_u32 s68, s88, 9216
buffer_load_dwordx4 v7, s[8:11], s68 offen lds
s_add_u32 m0, s81, 6144
s_add_u32 s68, s88, 18432
buffer_load_dwordx4 v6, s[8:11], s68 offen lds
s_add_u32 m0, s81, 7168
s_add_u32 s68, s88, 27648
buffer_load_dwordx4 v7, s[8:11], s68 offen lds
s_add_u32 s88, s88, 128
s_cmp_eq_u32 s88, s89
s_cselect_b32 s88, s80, s88
s_add_u32 m0, s81, 8192
s_nop 0
buffer_load_dwordx4 v6, s[8:11], s88 offen lds
s_add_u32 m0, s81, 9216
s_add_u32 s68, s88, 9216
buffer_load_dwordx4 v7, s[8:11], s68 offen lds
s_add_u32 m0, s81, 10240
s_add_u32 s68, s88, 18432
buffer_load_dwordx4 v6, s[8:11], s68 offen lds
s_add_u32 m0, s81, 11264
s_add_u32 s68, s88, 27648
buffer_load_dwordx4 v7, s[8:11], s68 offen lds
s_add_u32 s88, s88, 128
s_cmp_eq_u32 s88, s89
s_cselect_b32 s88, s80, s88
v_lshrrev_b32 v10, 1, v1
v_and_b32 v10, 7, v10
v_xor_b32 v10, v10, v2
v_lshlrev_b32 v11, 3, v1
v_add_u32 v10, v10, v11
v_lshlrev_b32 v10, 4, v10
v_add_u32 v8, s81, v10
v_xor_b32 v9, 64, v8
v_lshrrev_b32 v10, 1, v2
v_lshlrev_b32 v10, 4, v10
v_and_b32 v11, 1, v2
v_lshlrev_b32 v11, 2, v11
v_add_u32 v10, v10, v11
v_lshrrev_b32 v11, 2, v1
v_add_u32 v10, v10, v11
v_mul_u32_u24 v10, 96, v10
v_add_u32 v10, 256, v10
v_add_u32 v5, 32, v10
v_and_b32 v11, 3, v1
v_lshlrev_b32 v11, 3, v11
v_add_u32 v4, v10, v11
v_lshrrev_b32 v10, 2, v1
v_cmp_eq_u32 vcc, v10, v2
v_and_b32 v11, 3, v1
v_and_b32 v12, 1, v11
v_lshlrev_b32 v12, 4, v12
v_mov_b32 v13, 0x3f80
v_lshlrev_b32 v13, v12, v13
v_cndmask_b32 v13, 0, v13, vcc
v_cmp_gt_u32 vcc, 2, v11
s_nop 1
v_cndmask_b32 v48, 0, v13, vcc
v_mov_b32 v14, 0
v_cndmask_b32 v49, v13, v14, vcc
v_and_b32 v44, 0xffff, v48
v_mov_b32 v45, 0
v_mov_b32 v46, 0
v_mov_b32 v47, 0
v_mov_b32 v50, 0
v_mov_b32 v51, 0
s_mov_b32 s82, 0x3fb8aa3b
s_mov_b32 s83, 0xbfb8aa3b
s_mov_b32 s65, 0
s_mov_b32 s28, s60
s_mov_b32 s29, s61
s_mov_b32 s30, 0x100
s_mov_b32 s31, 0x20000
s_waitcnt vmcnt(8)
s_cmp_lg_u32 s3, 0
s_cbranch_scc1 pb_2
s_mov_b64 s[70:71], 0xffff
s_not_b64 s[72:73], s[70:71]
v_add_u32 v42, 0, v40
ds_read_u16 v20, v42 offset:0
ds_read_u16 v21, v42 offset:36
ds_read_u16 v22, v42 offset:72
ds_read_u16 v23, v42 offset:108
ds_read_u16 v24, v42 offset:576
ds_read_u16 v25, v42 offset:612
v_add_u32 v42, 584, v40
ds_read_u16 v28, v42 offset:0
ds_read_u16 v29, v42 offset:36
ds_read_u16 v30, v42 offset:72
ds_read_u16 v31, v42 offset:108
ds_read_u16 v32, v42 offset:576
ds_read_u16 v33, v42 offset:612
ds_read_u16 v34, v42 offset:648
ds_read_u16 v35, v42 offset:684
v_lshlrev_b32 v42, 4, v0
v_add_u32 v42, 92416, v42
s_waitcnt lgkmcnt(0)
v_lshl_or_b32 v36, v21, 16, v20
v_lshl_or_b32 v37, v23, 16, v22
v_lshl_or_b32 v38, v25, 16, v24
v_xor_b32 v36, v36, v41
v_xor_b32 v37, v37, v41
v_xor_b32 v38, v38, v41
v_mov_b32 v39, 0
v_cndmask_b32 v38, 0, v38, s[70:71]
ds_write_b128 v42, v[36:39] offset:0
v_lshl_or_b32 v56, v29, 16, v28
v_lshl_or_b32 v57, v31, 16, v30
v_lshl_or_b32 v58, v33, 16, v32
v_lshl_or_b32 v59, v35, 16, v34
v_xor_b32 v56, v56, v41
v_xor_b32 v57, v57, v41
v_xor_b32 v58, v58, v41
v_xor_b32 v59, v59, v41
v_cndmask_b32 v56, 0, v56, s[72:73]
v_cndmask_b32 v58, 0, v58, s[70:71]
v_cndmask_b32 v59, 0, v59, s[70:71]
ds_write_b128 v42, v[56:59] offset:4096
s_branch pbd_1
pb_2:
s_cmp_lg_u32 s3, 1
s_cbranch_scc1 pb_3
s_mov_b64 s[70:71], 0xffff
s_not_b64 s[72:73], s[70:71]
v_add_u32 v42, 8, v40
ds_read_u16 v20, v42 offset:0
ds_read_u16 v21, v42 offset:36
ds_read_u16 v22, v42 offset:72
ds_read_u16 v23, v42 offset:108
ds_read_u16 v24, v42 offset:576
ds_read_u16 v25, v42 offset:612
v_add_u32 v42, 592, v40
ds_read_u16 v28, v42 offset:0
ds_read_u16 v29, v42 offset:36
ds_read_u16 v30, v42 offset:72
ds_read_u16 v31, v42 offset:108
ds_read_u16 v32, v42 offset:576
ds_read_u16 v33, v42 offset:612
ds_read_u16 v34, v42 offset:648
ds_read_u16 v35, v42 offset:684
v_lshlrev_b32 v42, 4, v0
v_add_u32 v42, 92416, v42
s_waitcnt lgkmcnt(0)
v_lshl_or_b32 v36, v21, 16, v20
v_lshl_or_b32 v37, v23, 16, v22
v_lshl_or_b32 v38, v25, 16, v24
v_xor_b32 v36, v36, v41
v_xor_b32 v37, v37, v41
v_xor_b32 v38, v38, v41
v_mov_b32 v39, 0
v_cndmask_b32 v38, 0, v38, s[70:71]
ds_write_b128 v42, v[36:39] offset:1024
v_lshl_or_b32 v56, v29, 16, v28
v_lshl_or_b32 v57, v31, 16, v30
v_lshl_or_b32 v58, v33, 16, v32
v_lshl_or_b32 v59, v35, 16, v34
v_xor_b32 v56, v56, v41
v_xor_b32 v57, v57, v41
v_xor_b32 v58, v58, v41
v_xor_b32 v59, v59, v41
s_mov_b32 s74, 0x11111111
s_mov_b32 s75, 0x11111111
v_cndmask_b32 v56, 0, v56, s[74:75]
v_cndmask_b32 v57, 0, v57, s[74:75]
v_cndmask_b32 v58, 0, v58, s[74:75]
v_cndmask_b32 v59, 0, v59, s[74:75]
v_cndmask_b32 v56, 0, v56, s[72:73]
v_cndmask_b32 v58, 0, v58, s[70:71]
v_cndmask_b32 v59, 0, v59, s[70:71]
ds_write_b128 v42, v[56:59] offset:5120
s_branch pbd_1
pb_3:
s_cmp_lg_u32 s3, 2
s_cbranch_scc1 pb_4
s_mov_b64 s[70:71], 0xffff
s_not_b64 s[72:73], s[70:71]
v_add_u32 v42, 16, v40
ds_read_u16 v20, v42 offset:0
ds_read_u16 v21, v42 offset:36
ds_read_u16 v22, v42 offset:72
ds_read_u16 v23, v42 offset:108
ds_read_u16 v24, v42 offset:576
ds_read_u16 v25, v42 offset:612
v_lshlrev_b32 v42, 4, v0
v_add_u32 v42, 92416, v42
s_waitcnt lgkmcnt(0)
v_lshl_or_b32 v36, v21, 16, v20
v_lshl_or_b32 v37, v23, 16, v22
v_lshl_or_b32 v38, v25, 16, v24
v_xor_b32 v36, v36, v41
v_xor_b32 v37, v37, v41
v_xor_b32 v38, v38, v41
v_mov_b32 v39, 0
s_mov_b32 s74, 0x11111111
s_mov_b32 s75, 0x11111111
v_cndmask_b32 v36, 0, v36, s[74:75]
v_cndmask_b32 v37, 0, v37, s[74:75]
v_cndmask_b32 v38, 0, v38, s[74:75]
v_cndmask_b32 v38, 0, v38, s[70:71]
ds_write_b128 v42, v[36:39] offset:2048
s_branch pbd_1
pb_4:
s_mov_b64 s[70:71], 0xffff
s_not_b64 s[72:73], s[70:71]
v_add_u32 v42, 576, v40
ds_read_u16 v20, v42 offset:0
ds_read_u16 v21, v42 offset:36
ds_read_u16 v22, v42 offset:72
ds_read_u16 v23, v42 offset:108
ds_read_u16 v24, v42 offset:576
ds_read_u16 v25, v42 offset:612
ds_read_u16 v26, v42 offset:648
ds_read_u16 v27, v42 offset:684
v_lshlrev_b32 v42, 4, v0
v_add_u32 v42, 92416, v42
s_waitcnt lgkmcnt(0)
v_lshl_or_b32 v36, v21, 16, v20
v_lshl_or_b32 v37, v23, 16, v22
v_lshl_or_b32 v38, v25, 16, v24
v_lshl_or_b32 v39, v27, 16, v26
v_xor_b32 v36, v36, v41
v_xor_b32 v37, v37, v41
v_xor_b32 v38, v38, v41
v_xor_b32 v39, v39, v41
v_cndmask_b32 v36, 0, v36, s[72:73]
v_cndmask_b32 v38, 0, v38, s[70:71]
v_cndmask_b32 v39, 0, v39, s[70:71]
ds_write_b128 v42, v[36:39] offset:3072
pbd_1:
s_waitcnt lgkmcnt(0)
v_mov_b32 v10, 1
ds_write_b32 v3, v10 offset:64
v_lshlrev_b32 v13, 2, v0
v_add_u32 v13, v13, v3
v_add_u32 v13, 16, v13
v_and_b32 v13, 255, v13
v_cmp_eq_u32 vcc, 0, v0
s_nop 1
v_cndmask_b32 v15, 0, 1, vcc
s_waitcnt vmcnt(8)
ds_read_b128 v[112:115], v8 offset:0
ds_read_b128 v[116:119], v8 offset:2048
ds_read_b128 v[120:123], v9 offset:0
ds_read_b128 v[124:127], v9 offset:2048
s_cmp_ge_u32 s65, 3
s_cbranch_scc0 slow_7
bk_6:
ds_read_b64_tr_b16 v[88:89], v4 offset:0
ds_read_b64_tr_b16 v[90:91], v4 offset:768
ds_read_b64_tr_b16 v[92:93], v4 offset:32
ds_read_b64_tr_b16 v[94:95], v4 offset:800
ds_read_b64_tr_b16 v[96:97], v4 offset:64
ds_read_b64_tr_b16 v[98:99], v4 offset:832
s_waitcnt lgkmcnt(4)
v_mfma_f32_16x16x32_bf16 v[64:67], v[88:91], v[112:115], 0
s_cmp_ge_u32 s65, 6
s_cbranch_scc0 slow_9
bk_8:
ds_read_b64_tr_b16 v[100:101], v4 offset:3072
v_mfma_f32_16x16x32_bf16 v[68:71], v[88:91], v[116:119], 0
ds_read_b64_tr_b16 v[102:103], v4 offset:3840
s_waitcnt lgkmcnt(4)
s_add_u32 m0, s81, 0
s_nop 0
buffer_load_dwordx4 v6, s[8:11], s88 offen lds
s_add_u32 m0, s81, 1024
s_add_u32 s68, s88, 9216
buffer_load_dwordx4 v7, s[8:11], s68 offen lds
s_add_u32 m0, s81, 2048
s_add_u32 s68, s88, 18432
buffer_load_dwordx4 v6, s[8:11], s68 offen lds
s_add_u32 m0, s81, 3072
s_add_u32 s68, s88, 27648
buffer_load_dwordx4 v7, s[8:11], s68 offen lds
s_add_u32 s88, s88, 128
s_cmp_eq_u32 s88, s89
s_cselect_b32 s88, s80, s88
v_mfma_f32_16x16x32_bf16 v[72:75], v[92:95], v[112:115], 0
ds_read_b64_tr_b16 v[104:105], v4 offset:3104
v_mfma_f32_16x16x32_bf16 v[76:79], v[92:95], v[116:119], 0
ds_read_b64_tr_b16 v[106:107], v4 offset:3872
s_waitcnt lgkmcnt(4)
v_mfma_f32_16x16x32_bf16 v[80:83], v[96:99], v[112:115], 0
ds_read_b64_tr_b16 v[108:109], v4 offset:3136
ds_add_u32 v13, v15
v_mfma_f32_16x16x32_bf16 v[84:87], v[96:99], v[116:119], 0
ds_read_b64_tr_b16 v[110:111], v4 offset:3904
s_waitcnt lgkmcnt(5)
v_mfma_f32_16x16x32_bf16 v[64:67], v[100:103], v[120:123], v[64:67]
s_cmp_ge_u32 s65, 9
s_cbranch_scc0 slow_11
bk_10:
s_waitcnt vmcnt(8)
ds_read_b128 v[128:131], v8 offset:4096
ds_read_b64_tr_b16 v[88:89], v4 offset:6144
v_mfma_f32_16x16x32_bf16 v[68:71], v[100:103], v[124:127], v[68:71]
ds_read_b128 v[132:135], v8 offset:6144
ds_read_b64_tr_b16 v[90:91], v4 offset:6912
s_waitcnt lgkmcnt(7)
v_mfma_f32_16x16x32_bf16 v[72:75], v[104:107], v[120:123], v[72:75]
ds_read_b128 v[136:139], v9 offset:4096
ds_read_b64_tr_b16 v[92:93], v4 offset:6176
v_mfma_f32_16x16x32_bf16 v[76:79], v[104:107], v[124:127], v[76:79]
ds_read_b128 v[140:143], v9 offset:6144
ds_read_b64_tr_b16 v[94:95], v4 offset:6944
s_waitcnt lgkmcnt(8)
v_mfma_f32_16x16x32_bf16 v[80:83], v[108:111], v[120:123], v[80:83]
ds_read_b64_tr_b16 v[96:97], v4 offset:6208
ds_add_u32 v13, v15
v_mfma_f32_16x16x32_bf16 v[84:87], v[108:111], v[124:127], v[84:87]
ds_read_b64_tr_b16 v[98:99], v4 offset:6976
s_waitcnt lgkmcnt(7)
v_mfma_f32_16x16x32_bf16 v[64:67], v[88:91], v[128:131], v[64:67]
s_cmp_ge_u32 s65, 12
s_cbranch_scc0 slow_13
bk_12:
ds_read_b64_tr_b16 v[100:101], v4 offset:9216
v_mfma_f32_16x16x32_bf16 v[68:71], v[88:91], v[132:135], v[68:71]
ds_read_b64_tr_b16 v[102:103], v4 offset:9984
s_waitcnt lgkmcnt(5)
s_add_u32 m0, s81, 4096
s_nop 0
buffer_load_dwordx4 v6, s[8:11], s88 offen lds
s_add_u32 m0, s81, 5120
s_add_u32 s68, s88, 9216
buffer_load_dwordx4 v7, s[8:11], s68 offen lds
s_add_u32 m0, s81, 6144
s_add_u32 s68, s88, 18432
buffer_load_dwordx4 v6, s[8:11], s68 offen lds
s_add_u32 m0, s81, 7168
s_add_u32 s68, s88, 27648
buffer_load_dwordx4 v7, s[8:11], s68 offen lds
s_add_u32 s88, s88, 128
s_cmp_eq_u32 s88, s89
s_cselect_b32 s88, s80, s88
v_mfma_f32_16x16x32_bf16 v[72:75], v[92:95], v[128:131], v[72:75]
ds_read_b64_tr_b16 v[104:105], v4 offset:9248
v_mfma_f32_16x16x32_bf16 v[76:79], v[92:95], v[132:135], v[76:79]
ds_read_b64_tr_b16 v[106:107], v4 offset:10016
s_waitcnt lgkmcnt(4)
v_mfma_f32_16x16x32_bf16 v[80:83], v[96:99], v[128:131], v[80:83]
ds_read_b64_tr_b16 v[108:109], v4 offset:9280
ds_add_u32 v13, v15
v_mfma_f32_16x16x32_bf16 v[84:87], v[96:99], v[132:135], v[84:87]
ds_read_b64_tr_b16 v[110:111], v4 offset:10048
s_waitcnt lgkmcnt(5)
v_mfma_f32_16x16x32_bf16 v[64:67], v[100:103], v[136:139], v[64:67]
s_cmp_ge_u32 s65, 15
s_cbranch_scc0 slow_15
bk_14:
s_waitcnt vmcnt(8)
ds_read_b128 v[144:147], v8 offset:8192
ds_read_b64_tr_b16 v[88:89], v4 offset:12288
v_mfma_f32_16x16x32_bf16 v[68:71], v[100:103], v[140:143], v[68:71]
ds_read_b128 v[148:151], v8 offset:10240
ds_read_b64_tr_b16 v[90:91], v4 offset:13056
s_waitcnt lgkmcnt(7)
v_mfma_f32_16x16x32_bf16 v[72:75], v[104:107], v[136:139], v[72:75]
ds_read_b128 v[152:155], v9 offset:8192
ds_read_b64_tr_b16 v[92:93], v4 offset:12320
v_mfma_f32_16x16x32_bf16 v[76:79], v[104:107], v[140:143], v[76:79]
ds_read_b128 v[156:159], v9 offset:10240
ds_read_b64_tr_b16 v[94:95], v4 offset:13088
s_waitcnt lgkmcnt(8)
v_mfma_f32_16x16x32_bf16 v[80:83], v[108:111], v[136:139], v[80:83]
ds_read_b64_tr_b16 v[96:97], v4 offset:12352
ds_add_u32 v13, v15
v_mfma_f32_16x16x32_bf16 v[84:87], v[108:111], v[140:143], v[84:87]
ds_read_b64_tr_b16 v[98:99], v4 offset:13120
s_waitcnt lgkmcnt(7)
v_mfma_f32_16x16x32_bf16 v[64:67], v[88:91], v[144:147], v[64:67]
s_cmp_ge_u32 s65, 18
s_cbranch_scc0 slow_17
bk_16:
ds_read_b64_tr_b16 v[100:101], v4 offset:15360
v_mfma_f32_16x16x32_bf16 v[68:71], v[88:91], v[148:151], v[68:71]
ds_read_b64_tr_b16 v[102:103], v4 offset:16128
s_waitcnt lgkmcnt(5)
s_add_u32 m0, s81, 8192
s_nop 0
buffer_load_dwordx4 v6, s[8:11], s88 offen lds
s_add_u32 m0, s81, 9216
s_add_u32 s68, s88, 9216
buffer_load_dwordx4 v7, s[8:11], s68 offen lds
s_add_u32 m0, s81, 10240
s_add_u32 s68, s88, 18432
buffer_load_dwordx4 v6, s[8:11], s68 offen lds
s_add_u32 m0, s81, 11264
s_add_u32 s68, s88, 27648
buffer_load_dwordx4 v7, s[8:11], s68 offen lds
s_add_u32 s88, s88, 128
s_cmp_eq_u32 s88, s89
s_cselect_b32 s88, s80, s88
v_mfma_f32_16x16x32_bf16 v[72:75], v[92:95], v[144:147], v[72:75]
ds_read_b64_tr_b16 v[104:105], v4 offset:15392
v_mfma_f32_16x16x32_bf16 v[76:79], v[92:95], v[148:151], v[76:79]
ds_read_b64_tr_b16 v[106:107], v4 offset:16160
s_waitcnt lgkmcnt(4)
v_mfma_f32_16x16x32_bf16 v[80:83], v[96:99], v[144:147], v[80:83]
ds_read_b64_tr_b16 v[108:109], v4 offset:15424
ds_add_u32 v13, v15
v_mfma_f32_16x16x32_bf16 v[84:87], v[96:99], v[148:151], v[84:87]
ds_read_b64_tr_b16 v[110:111], v4 offset:16192
s_waitcnt lgkmcnt(5)
v_mfma_f32_16x16x32_bf16 v[64:67], v[100:103], v[152:155], v[64:67]
s_cmp_ge_u32 s65, 21
s_cbranch_scc0 slow_19
bk_18:
s_waitcnt vmcnt(8)
ds_read_b128 v[160:163], v8 offset:0
ds_read_b64_tr_b16 v[88:89], v4 offset:18432
v_mfma_f32_16x16x32_bf16 v[68:71], v[100:103], v[156:159], v[68:71]
ds_read_b128 v[164:167], v8 offset:2048
ds_read_b64_tr_b16 v[90:91], v4 offset:19200
s_waitcnt lgkmcnt(7)
v_mfma_f32_16x16x32_bf16 v[72:75], v[104:107], v[152:155], v[72:75]
ds_read_b128 v[168:171], v9 offset:0
ds_read_b64_tr_b16 v[92:93], v4 offset:18464
v_mfma_f32_16x16x32_bf16 v[76:79], v[104:107], v[156:159], v[76:79]
ds_read_b128 v[172:175], v9 offset:2048
ds_read_b64_tr_b16 v[94:95], v4 offset:19232
s_waitcnt lgkmcnt(8)
v_mfma_f32_16x16x32_bf16 v[80:83], v[108:111], v[152:155], v[80:83]
ds_read_b64_tr_b16 v[96:97], v4 offset:18496
ds_add_u32 v13, v15
v_mfma_f32_16x16x32_bf16 v[84:87], v[108:111], v[156:159], v[84:87]
ds_read_b64_tr_b16 v[98:99], v4 offset:19264
s_waitcnt lgkmcnt(7)
v_mfma_f32_16x16x32_bf16 v[64:67], v[88:91], v[160:163], v[64:67]
s_cmp_ge_u32 s65, 24
s_cbranch_scc0 slow_21
bk_20:
ds_read_b64_tr_b16 v[100:101], v4 offset:21504
v_mfma_f32_16x16x32_bf16 v[68:71], v[88:91], v[164:167], v[68:71]
ds_read_b64_tr_b16 v[102:103], v4 offset:22272
s_waitcnt lgkmcnt(5)
s_add_u32 m0, s81, 0
s_nop 0
buffer_load_dwordx4 v6, s[8:11], s88 offen lds
s_add_u32 m0, s81, 1024
s_add_u32 s68, s88, 9216
buffer_load_dwordx4 v7, s[8:11], s68 offen lds
s_add_u32 m0, s81, 2048
s_add_u32 s68, s88, 18432
buffer_load_dwordx4 v6, s[8:11], s68 offen lds
s_add_u32 m0, s81, 3072
s_add_u32 s68, s88, 27648
buffer_load_dwordx4 v7, s[8:11], s68 offen lds
s_add_u32 s88, s88, 128
s_cmp_eq_u32 s88, s89
s_cselect_b32 s88, s80, s88
v_mfma_f32_16x16x32_bf16 v[72:75], v[92:95], v[160:163], v[72:75]
ds_read_b64_tr_b16 v[104:105], v4 offset:21536
v_mfma_f32_16x16x32_bf16 v[76:79], v[92:95], v[164:167], v[76:79]
ds_read_b64_tr_b16 v[106:107], v4 offset:22304
s_waitcnt lgkmcnt(4)
v_mfma_f32_16x16x32_bf16 v[80:83], v[96:99], v[160:163], v[80:83]
ds_read_b64_tr_b16 v[108:109], v4 offset:21568
ds_add_u32 v13, v15
v_mfma_f32_16x16x32_bf16 v[84:87], v[96:99], v[164:167], v[84:87]
ds_read_b64_tr_b16 v[110:111], v4 offset:22336
s_waitcnt lgkmcnt(5)
v_mfma_f32_16x16x32_bf16 v[64:67], v[100:103], v[168:171], v[64:67]
s_cmp_ge_u32 s65, 27
s_cbranch_scc0 slow_23
bk_22:
s_waitcnt vmcnt(8)
ds_read_b128 v[176:179], v8 offset:4096
ds_read_b64_tr_b16 v[88:89], v4 offset:24576
v_mfma_f32_16x16x32_bf16 v[68:71], v[100:103], v[172:175], v[68:71]
ds_read_b128 v[180:183], v8 offset:6144
ds_read_b64_tr_b16 v[90:91], v4 offset:25344
s_waitcnt lgkmcnt(7)
v_mfma_f32_16x16x32_bf16 v[72:75], v[104:107], v[168:171], v[72:75]
ds_read_b128 v[184:187], v9 offset:4096
ds_read_b64_tr_b16 v[92:93], v4 offset:24608
v_mfma_f32_16x16x32_bf16 v[76:79], v[104:107], v[172:175], v[76:79]
ds_read_b128 v[188:191], v9 offset:6144
ds_read_b64_tr_b16 v[94:95], v4 offset:25376
s_waitcnt lgkmcnt(8)
v_mfma_f32_16x16x32_bf16 v[80:83], v[108:111], v[168:171], v[80:83]
ds_read_b64_tr_b16 v[96:97], v4 offset:24640
ds_add_u32 v13, v15
v_mfma_f32_16x16x32_bf16 v[84:87], v[108:111], v[172:175], v[84:87]
ds_read_b64_tr_b16 v[98:99], v4 offset:25408
s_waitcnt lgkmcnt(7)
v_mfma_f32_16x16x32_bf16 v[64:67], v[88:91], v[176:179], v[64:67]
s_cmp_ge_u32 s65, 30
s_cbranch_scc0 slow_25
bk_24:
ds_read_b64_tr_b16 v[100:101], v4 offset:27648
v_mfma_f32_16x16x32_bf16 v[68:71], v[88:91], v[180:183], v[68:71]
ds_read_b64_tr_b16 v[102:103], v4 offset:28416
s_waitcnt lgkmcnt(5)
s_add_u32 m0, s81, 4096
s_nop 0
buffer_load_dwordx4 v6, s[8:11], s88 offen lds
s_add_u32 m0, s81, 5120
s_add_u32 s68, s88, 9216
buffer_load_dwordx4 v7, s[8:11], s68 offen lds
s_add_u32 m0, s81, 6144
s_add_u32 s68, s88, 18432
buffer_load_dwordx4 v6, s[8:11], s68 offen lds
s_add_u32 m0, s81, 7168
s_add_u32 s68, s88, 27648
buffer_load_dwordx4 v7, s[8:11], s68 offen lds
s_add_u32 s88, s88, 128
s_cmp_eq_u32 s88, s89
s_cselect_b32 s88, s80, s88
v_mfma_f32_16x16x32_bf16 v[72:75], v[92:95], v[176:179], v[72:75]
ds_read_b64_tr_b16 v[104:105], v4 offset:27680
v_mfma_f32_16x16x32_bf16 v[76:79], v[92:95], v[180:183], v[76:79]
ds_read_b64_tr_b16 v[106:107], v4 offset:28448
s_waitcnt lgkmcnt(4)
v_mfma_f32_16x16x32_bf16 v[80:83], v[96:99], v[176:179], v[80:83]
ds_read_b64_tr_b16 v[108:109], v4 offset:27712
ds_add_u32 v13, v15
v_mfma_f32_16x16x32_bf16 v[84:87], v[96:99], v[180:183], v[84:87]
ds_read_b64_tr_b16 v[110:111], v4 offset:28480
s_waitcnt lgkmcnt(5)
v_mfma_f32_16x16x32_bf16 v[64:67], v[100:103], v[184:187], v[64:67]
s_cmp_ge_u32 s65, 33
s_cbranch_scc0 slow_27
bk_26:
s_waitcnt vmcnt(8)
ds_read_b128 v[192:195], v8 offset:8192
ds_read_b64_tr_b16 v[88:89], v4 offset:30720
v_mfma_f32_16x16x32_bf16 v[68:71], v[100:103], v[188:191], v[68:71]
ds_read_b128 v[196:199], v8 offset:10240
ds_read_b64_tr_b16 v[90:91], v4 offset:31488
s_waitcnt lgkmcnt(7)
v_mfma_f32_16x16x32_bf16 v[72:75], v[104:107], v[184:187], v[72:75]
ds_read_b128 v[200:203], v9 offset:8192
ds_read_b64_tr_b16 v[92:93], v4 offset:30752
v_mfma_f32_16x16x32_bf16 v[76:79], v[104:107], v[188:191], v[76:79]
ds_read_b128 v[204:207], v9 offset:10240
ds_read_b64_tr_b16 v[94:95], v4 offset:31520
s_waitcnt lgkmcnt(8)
v_mfma_f32_16x16x32_bf16 v[80:83], v[108:111], v[184:187], v[80:83]
ds_read_b64_tr_b16 v[96:97], v4 offset:30784
ds_add_u32 v13, v15
v_mfma_f32_16x16x32_bf16 v[84:87], v[108:111], v[188:191], v[84:87]
ds_read_b64_tr_b16 v[98:99], v4 offset:31552
s_waitcnt lgkmcnt(7)
v_mfma_f32_16x16x32_bf16 v[64:67], v[88:91], v[192:195], v[64:67]
s_cmp_ge_u32 s65, 36
s_cbranch_scc0 slow_29
bk_28:
ds_read_b64_tr_b16 v[100:101], v4 offset:33792
v_mfma_f32_16x16x32_bf16 v[68:71], v[88:91], v[196:199], v[68:71]
ds_read_b64_tr_b16 v[102:103], v4 offset:34560
s_waitcnt lgkmcnt(5)
s_add_u32 m0, s81, 8192
s_nop 0
buffer_load_dwordx4 v6, s[8:11], s88 offen lds
s_add_u32 m0, s81, 9216
s_add_u32 s68, s88, 9216
buffer_load_dwordx4 v7, s[8:11], s68 offen lds
s_add_u32 m0, s81, 10240
s_add_u32 s68, s88, 18432
buffer_load_dwordx4 v6, s[8:11], s68 offen lds
s_add_u32 m0, s81, 11264
s_add_u32 s68, s88, 27648
buffer_load_dwordx4 v7, s[8:11], s68 offen lds
v_mfma_f32_16x16x32_bf16 v[72:75], v[92:95], v[192:195], v[72:75]
ds_read_b64_tr_b16 v[104:105], v4 offset:33824
v_mfma_f32_16x16x32_bf16 v[76:79], v[92:95], v[196:199], v[76:79]
ds_read_b64_tr_b16 v[106:107], v4 offset:34592
s_waitcnt lgkmcnt(4)
v_mfma_f32_16x16x32_bf16 v[80:83], v[96:99], v[192:195], v[80:83]
ds_read_b64_tr_b16 v[108:109], v4 offset:33856
ds_add_u32 v13, v15
v_mfma_f32_16x16x32_bf16 v[84:87], v[96:99], v[196:199], v[84:87]
ds_read_b64_tr_b16 v[110:111], v4 offset:34624
s_waitcnt lgkmcnt(5)
v_mfma_f32_16x16x32_bf16 v[64:67], v[100:103], v[200:203], v[64:67]
s_cmp_ge_u32 s65, 39
s_cbranch_scc0 slow_31
bk_30:
s_waitcnt vmcnt(8)
ds_read_b128 v[208:211], v8 offset:0
ds_read_b64_tr_b16 v[88:89], v4 offset:36864
v_mfma_f32_16x16x32_bf16 v[68:71], v[100:103], v[204:207], v[68:71]
ds_read_b128 v[212:215], v8 offset:2048
ds_read_b64_tr_b16 v[90:91], v4 offset:37632
s_waitcnt lgkmcnt(7)
v_mfma_f32_16x16x32_bf16 v[72:75], v[104:107], v[200:203], v[72:75]
ds_read_b128 v[216:219], v9 offset:0
ds_read_b64_tr_b16 v[92:93], v4 offset:36896
v_mfma_f32_16x16x32_bf16 v[76:79], v[104:107], v[204:207], v[76:79]
ds_read_b128 v[220:223], v9 offset:2048
ds_read_b64_tr_b16 v[94:95], v4 offset:37664
s_waitcnt lgkmcnt(8)
v_mfma_f32_16x16x32_bf16 v[80:83], v[108:111], v[200:203], v[80:83]
ds_read_b64_tr_b16 v[96:97], v4 offset:36928
ds_add_u32 v13, v15
v_mfma_f32_16x16x32_bf16 v[84:87], v[108:111], v[204:207], v[84:87]
ds_read_b64_tr_b16 v[98:99], v4 offset:37696
s_waitcnt lgkmcnt(7)
v_mfma_f32_16x16x32_bf16 v[64:67], v[88:91], v[208:211], v[64:67]
s_cmp_ge_u32 s65, 42
s_cbranch_scc0 slow_33
bk_32:
ds_read_b64_tr_b16 v[100:101], v4 offset:39936
v_mfma_f32_16x16x32_bf16 v[68:71], v[88:91], v[212:215], v[68:71]
ds_read_b64_tr_b16 v[102:103], v4 offset:40704
s_waitcnt lgkmcnt(5)
buffer_load_dword v14, v45, s[28:31], 0 offen sc1
v_mfma_f32_16x16x32_bf16 v[72:75], v[92:95], v[208:211], v[72:75]
ds_read_b64_tr_b16 v[104:105], v4 offset:39968
v_mfma_f32_16x16x32_bf16 v[76:79], v[92:95], v[212:215], v[76:79]
ds_read_b64_tr_b16 v[106:107], v4 offset:40736
s_waitcnt lgkmcnt(4)
v_mfma_f32_16x16x32_bf16 v[80:83], v[96:99], v[208:211], v[80:83]
ds_read_b64_tr_b16 v[108:109], v4 offset:40000
ds_add_u32 v13, v15
v_mfma_f32_16x16x32_bf16 v[84:87], v[96:99], v[212:215], v[84:87]
ds_read_b64_tr_b16 v[110:111], v4 offset:40768
s_waitcnt lgkmcnt(5)
v_mfma_f32_16x16x32_bf16 v[64:67], v[100:103], v[216:219], v[64:67]
s_cmp_ge_u32 s65, 45
s_cbranch_scc0 slow_35
bk_34:
s_waitcnt vmcnt(4)
ds_read_b128 v[224:227], v8 offset:4096
ds_read_b64_tr_b16 v[88:89], v4 offset:0
v_mfma_f32_16x16x32_bf16 v[68:71], v[100:103], v[220:223], v[68:71]
ds_read_b128 v[228:231], v8 offset:6144
ds_read_b64_tr_b16 v[90:91], v4 offset:768
s_waitcnt lgkmcnt(7)
v_mfma_f32_16x16x32_bf16 v[72:75], v[104:107], v[216:219], v[72:75]
ds_read_b128 v[232:235], v9 offset:4096
ds_read_b64_tr_b16 v[92:93], v4 offset:32
v_mfma_f32_16x16x32_bf16 v[76:79], v[104:107], v[220:223], v[76:79]
ds_read_b128 v[236:239], v9 offset:6144
ds_read_b64_tr_b16 v[94:95], v4 offset:800
s_waitcnt lgkmcnt(8)
v_mfma_f32_16x16x32_bf16 v[80:83], v[108:111], v[216:219], v[80:83]
ds_read_b64_tr_b16 v[96:97], v4 offset:64
ds_add_u32 v13, v15
v_mfma_f32_16x16x32_bf16 v[84:87], v[108:111], v[220:223], v[84:87]
ds_read_b64_tr_b16 v[98:99], v4 offset:832
s_waitcnt lgkmcnt(7)
v_mfma_f32_16x16x32_bf16 v[64:67], v[88:91], v[224:227], v[64:67]
s_cmp_ge_u32 s65, 48
s_cbranch_scc0 slow_37
bk_36:
ds_read_b64_tr_b16 v[100:101], v4 offset:3072
v_mfma_f32_16x16x32_bf16 v[68:71], v[88:91], v[228:231], v[68:71]
ds_read_b64_tr_b16 v[102:103], v4 offset:3840
s_waitcnt lgkmcnt(5)
v_mfma_f32_16x16x32_bf16 v[72:75], v[92:95], v[224:227], v[72:75]
ds_read_b64_tr_b16 v[104:105], v4 offset:3104
v_mfma_f32_16x16x32_bf16 v[76:79], v[92:95], v[228:231], v[76:79]
ds_read_b64_tr_b16 v[106:107], v4 offset:3872
s_waitcnt lgkmcnt(4)
v_mfma_f32_16x16x32_bf16 v[80:83], v[96:99], v[224:227], v[80:83]
ds_read_b64_tr_b16 v[108:109], v4 offset:3136
ds_add_u32 v13, v15
v_mfma_f32_16x16x32_bf16 v[84:87], v[96:99], v[228:231], v[84:87]
ds_read_b64_tr_b16 v[110:111], v4 offset:3904
s_waitcnt lgkmcnt(5)
v_mfma_f32_16x16x32_bf16 v[64:67], v[100:103], v[232:235], v[64:67]
s_cmp_ge_u32 s65, 51
s_cbranch_scc0 slow_39
bk_38:
s_waitcnt vmcnt(0)
ds_read_b128 v[240:243], v8 offset:8192
ds_read_b64_tr_b16 v[88:89], v4 offset:6144
v_mfma_f32_16x16x32_bf16 v[68:71], v[100:103], v[236:239], v[68:71]
ds_read_b128 v[244:247], v8 offset:10240
ds_read_b64_tr_b16 v[90:91], v4 offset:6912
s_waitcnt lgkmcnt(7)
v_mfma_f32_16x16x32_bf16 v[72:75], v[104:107], v[232:235], v[72:75]
ds_read_b128 v[248:251], v9 offset:8192
ds_read_b64_tr_b16 v[92:93], v4 offset:6176
v_mfma_f32_16x16x32_bf16 v[76:79], v[104:107], v[236:239], v[76:79]
ds_read_b128 v[252:255], v9 offset:10240
ds_read_b64_tr_b16 v[94:95], v4 offset:6944
s_waitcnt lgkmcnt(8)
v_mfma_f32_16x16x32_bf16 v[80:83], v[108:111], v[232:235], v[80:83]
ds_read_b64_tr_b16 v[96:97], v4 offset:6208
ds_add_u32 v13, v15
v_mfma_f32_16x16x32_bf16 v[84:87], v[108:111], v[236:239], v[84:87]
ds_read_b64_tr_b16 v[98:99], v4 offset:6976
s_waitcnt lgkmcnt(7)
v_mfma_f32_16x16x32_bf16 v[64:67], v[88:91], v[240:243], v[64:67]
s_cmp_ge_u32 s65, 54
s_cbranch_scc0 slow_41
bk_40:
ds_read_b64_tr_b16 v[100:101], v4 offset:9216
v_mfma_f32_16x16x32_bf16 v[68:71], v[88:91], v[244:247], v[68:71]
ds_read_b64_tr_b16 v[102:103], v4 offset:9984
s_waitcnt lgkmcnt(5)
v_mfma_f32_16x16x32_bf16 v[72:75], v[92:95], v[240:243], v[72:75]
ds_read_b64_tr_b16 v[104:105], v4 offset:9248
v_mfma_f32_16x16x32_bf16 v[76:79], v[92:95], v[244:247], v[76:79]
ds_read_b64_tr_b16 v[106:107], v4 offset:10016
s_waitcnt lgkmcnt(4)
v_mfma_f32_16x16x32_bf16 v[80:83], v[96:99], v[240:243], v[80:83]
ds_read_b64_tr_b16 v[108:109], v4 offset:9280
ds_add_u32 v13, v15
v_mfma_f32_16x16x32_bf16 v[84:87], v[96:99], v[244:247], v[84:87]
ds_read_b64_tr_b16 v[110:111], v4 offset:10048
s_waitcnt lgkmcnt(5)
v_mfma_f32_16x16x32_bf16 v[64:67], v[100:103], v[248:251], v[64:67]
v_mfma_f32_16x16x32_bf16 v[68:71], v[100:103], v[252:255], v[68:71]
s_waitcnt lgkmcnt(3)
v_mfma_f32_16x16x32_bf16 v[72:75], v[104:107], v[248:251], v[72:75]
v_mfma_f32_16x16x32_bf16 v[76:79], v[104:107], v[252:255], v[76:79]
s_waitcnt lgkmcnt(0)
v_mfma_f32_16x16x32_bf16 v[80:83], v[108:111], v[248:251], v[80:83]
ds_add_u32 v13, v15
v_mfma_f32_16x16x32_bf16 v[84:87], v[108:111], v[252:255], v[84:87]
v_readfirstlane_b32 s66, v14
s_cmp_lg_u32 s66, 0
s_cbranch_scc1 nok_42
poll_44:
buffer_load_dword v14, v45, s[28:31], 0 offen sc1
s_waitcnt vmcnt(0)
v_readfirstlane_b32 s66, v14
s_cmp_lg_u32 s66, 0
s_cbranch_scc1 ok_43
s_sleep 1
s_sub_u32 s64, s64, 64
s_cbranch_scc0 poll_44
s_mov_b32 s64, 0
ok_43:
nok_42:
s_setprio 2
v_cvt_pk_bf16_f32 v52, v64, v65
v_cvt_pk_bf16_f32 v53, v66, v67
v_cvt_pk_bf16_f32 v54, v72, v73
v_cvt_pk_bf16_f32 v55, v74, v75
v_cvt_pk_bf16_f32 v56, v80, v81
v_cvt_pk_bf16_f32 v57, v82, v83
v_cvt_pk_bf16_f32 v58, v68, v69
v_cvt_pk_bf16_f32 v59, v70, v71
v_cvt_pk_bf16_f32 v60, v76, v77
v_cvt_pk_bf16_f32 v61, v78, v79
v_cvt_pk_bf16_f32 v62, v84, v85
v_cvt_pk_bf16_f32 v63, v86, v87
s_mov_b32 s75, 0
s_cmp_ge_u32 s75, 1
s_cbranch_scc1 ok_45
poll_46:
ds_read_b128 v[16:19], v45 offset:64
s_waitcnt lgkmcnt(0)
v_min_u32 v16, v16, v17
v_min3_u32 v16, v16, v18, v19
s_nop 0
v_readfirstlane_b32 s75, v16
s_cmp_ge_u32 s75, 1
s_cbranch_scc1 ok_45
s_sub_u32 s64, s64, 1
s_cbranch_scc0 poll_46
s_mov_b32 s64, 0
ok_45:
s_waitcnt lgkmcnt(0)
v_lshlrev_b32 v10, 4, v0
v_add_u32 v10, s81, v10
v_add_u32 v8, 0x8000, v4
v_add_u32 v9, 0x8000, v5
v_lshlrev_b32 v19, 4, v0
v_add_u32 v19, 92416, v19
ds_read_b128 v[88:91], v19 offset:0
ds_read_b128 v[92:95], v19 offset:1024
ds_read_b128 v[96:99], v19 offset:2048
v_lshlrev_b32 v19, 4, v0
v_add_u32 v19, 92416, v19
ds_read_b128 v[32:35], v19 offset:3072
ds_read_b128 v[36:39], v19 offset:4096
ds_read_b128 v[40:43], v19 offset:5120
s_waitcnt lgkmcnt(3)
v_mfma_f32_16x16x32_bf16 v[64:67], v[88:91], v[52:55], 0
v_mfma_f32_16x16x32_bf16 v[68:71], v[92:95], v[52:55], 0
v_mfma_f32_16x16x32_bf16 v[72:75], v[96:99], v[52:55], 0
v_mfma_f32_16x16x32_bf16 v[76:79], v[88:91], v[58:61], 0
v_mfma_f32_16x16x32_bf16 v[80:83], v[92:95], v[58:61], 0
v_mfma_f32_16x16x32_bf16 v[84:87], v[96:99], v[58:61], 0
s_nop 2
v_max3_f32 v16, v64, v65, v66
v_max3_f32 v17, v67, v68, v69
v_max3_f32 v16, v16, v70, v71
v_max3_f32 v6, v76, v77, v78
v_max3_f32 v16, v16, v17, v72
v_max3_f32 v7, v79, v80, v81
v_mov_b32 v17, v16
v_max3_f32 v6, v6, v82, v83
s_nop 0
v_permlane16_swap_b32 v16, v17
v_max3_f32 v6, v6, v7, v84
v_max_f32 v16, v16, v17
v_mov_b32 v7, v6
v_mul_f32 v16, s83, v16
s_nop 0
v_permlane16_swap_b32 v6, v7
v_pk_fma_f32 v[64:65], v[64:65], s[82:83], v[16:17] op_sel_hi:[1,0,0]
v_max_f32 v6, v6, v7
v_pk_fma_f32 v[66:67], v[66:67], s[82:83], v[16:17] op_sel_hi:[1,0,0]
v_mul_f32 v6, s83, v6
v_pk_fma_f32 v[68:69], v[68:69], s[82:83], v[16:17] op_sel_hi:[1,0,0]
v_pk_fma_f32 v[76:77], v[76:77], s[82:83], v[6:7] op_sel_hi:[1,0,0]
v_pk_fma_f32 v[70:71], v[70:71], s[82:83], v[16:17] op_sel_hi:[1,0,0]
v_pk_fma_f32 v[78:79], v[78:79], s[82:83], v[6:7] op_sel_hi:[1,0,0]
v_fma_f32 v72, v72, s82, v16
v_pk_fma_f32 v[80:81], v[80:81], s[82:83], v[6:7] op_sel_hi:[1,0,0]
v_exp_f32 v64, v64
v_pk_fma_f32 v[82:83], v[82:83], s[82:83], v[6:7] op_sel_hi:[1,0,0]
v_exp_f32 v65, v65
v_fma_f32 v84, v84, s82, v6
v_exp_f32 v66, v66
v_exp_f32 v76, v76
v_exp_f32 v67, v67
v_exp_f32 v77, v77
v_exp_f32 v68, v68
v_exp_f32 v78, v78
v_exp_f32 v69, v69
v_exp_f32 v79, v79
v_exp_f32 v70, v70
v_exp_f32 v80, v80
v_exp_f32 v71, v71
v_exp_f32 v81, v81
v_exp_f32 v72, v72
v_exp_f32 v82, v82
v_pk_add_f32 v[16:17], v[64:65], v[66:67]
v_exp_f32 v83, v83
v_pk_add_f32 v[74:75], v[68:69], v[70:71]
v_exp_f32 v84, v84
v_pk_add_f32 v[16:17], v[16:17], v[74:75]
v_pk_add_f32 v[6:7], v[76:77], v[78:79]
v_add_f32 v18, v16, v72
v_pk_add_f32 v[86:87], v[80:81], v[82:83]
v_add_f32 v18, v18, v17
v_pk_add_f32 v[6:7], v[6:7], v[86:87]
v_mov_b32 v17, v18
v_add_f32 v12, v6, v84
s_nop 0
v_permlane16_swap_b32 v18, v17
v_add_f32 v12, v12, v7
v_add_f32 v18, v18, v17
v_mov_b32 v7, v12
v_rcp_f32 v18, v18
s_nop 0
v_permlane16_swap_b32 v12, v7
v_pk_mul_f32 v[64:65], v[64:65], v[18:19] op_sel_hi:[1,0]
v_add_f32 v12, v12, v7
v_pk_mul_f32 v[66:67], v[66:67], v[18:19] op_sel_hi:[1,0]
v_rcp_f32 v12, v12
v_pk_mul_f32 v[68:69], v[68:69], v[18:19] op_sel_hi:[1,0]
v_pk_mul_f32 v[76:77], v[76:77], v[12:13] op_sel_hi:[1,0]
v_pk_mul_f32 v[70:71], v[70:71], v[18:19] op_sel_hi:[1,0]
v_pk_mul_f32 v[78:79], v[78:79], v[12:13] op_sel_hi:[1,0]
v_mul_f32 v72, v72, v18
v_pk_mul_f32 v[80:81], v[80:81], v[12:13] op_sel_hi:[1,0]
v_cvt_pk_bf16_f32 v100, v64, v65
v_pk_mul_f32 v[82:83], v[82:83], v[12:13] op_sel_hi:[1,0]
v_cvt_pk_bf16_f32 v101, v66, v67
v_mul_f32 v84, v84, v12
v_cvt_pk_bf16_f32 v102, v68, v69
v_cvt_pk_bf16_f32 v104, v76, v77
v_cvt_pk_bf16_f32 v103, v70, v71
v_cvt_pk_bf16_f32 v105, v78, v79
v_cvt_pk_bf16_f32 v88, v72, 0
v_cvt_pk_bf16_f32 v106, v80, v81
v_cvt_pk_bf16_f32 v107, v82, v83
v_cvt_pk_bf16_f32 v92, v84, 0
v_mfma_f32_16x16x32_bf16 v[64:67], v[100:103], v[48:51], 0
v_mfma_f32_16x16x32_bf16 v[68:71], v[100:103], v[46:49], 0
v_mfma_f32_16x16x32_bf16 v[72:75], v[88:91], v[44:47], 0
v_mfma_f32_16x16x32_bf16 v[76:79], v[104:107], v[48:51], 0
v_mfma_f32_16x16x32_bf16 v[80:83], v[104:107], v[46:49], 0
v_mfma_f32_16x16x32_bf16 v[84:87], v[92:95], v[44:47], 0
s_nop 2
v_cvt_pk_bf16_f32 v20, v64, v65
v_cvt_pk_bf16_f32 v21, v66, v67
v_cvt_pk_bf16_f32 v24, v68, v69
v_cvt_pk_bf16_f32 v25, v70, v71
v_cvt_pk_bf16_f32 v28, v72, v73
v_cvt_pk_bf16_f32 v29, v74, v75
v_cvt_pk_bf16_f32 v22, v76, v77
v_cvt_pk_bf16_f32 v23, v78, v79
v_cvt_pk_bf16_f32 v26, v80, v81
v_cvt_pk_bf16_f32 v27, v82, v83
v_cvt_pk_bf16_f32 v30, v84, v85
v_cvt_pk_bf16_f32 v31, v86, v87
ds_write_b128 v10, v[20:23] offset:0
ds_write_b128 v10, v[24:27] offset:1024
ds_write_b128 v10, v[28:31] offset:2048
s_waitcnt lgkmcnt(3)
v_mfma_f32_16x16x32_bf16 v[64:67], v[32:35], v[54:57], 0
v_mfma_f32_16x16x32_bf16 v[68:71], v[36:39], v[54:57], 0
v_mfma_f32_16x16x32_bf16 v[72:75], v[40:43], v[54:57], 0
v_mfma_f32_16x16x32_bf16 v[76:79], v[32:35], v[60:63], 0
v_mfma_f32_16x16x32_bf16 v[80:83], v[36:39], v[60:63], 0
v_mfma_f32_16x16x32_bf16 v[84:87], v[40:43], v[60:63], 0
s_nop 2
v_max3_f32 v16, v64, v65, v66
v_max3_f32 v17, v67, v68, v69
v_max3_f32 v16, v16, v70, v71
v_max3_f32 v6, v76, v77, v78
v_max3_f32 v16, v16, v17, v72
v_max3_f32 v7, v79, v80, v81
v_mov_b32 v17, v16
v_max3_f32 v6, v6, v82, v83
s_nop 0
v_permlane16_swap_b32 v16, v17
v_max3_f32 v6, v6, v7, v84
v_max_f32 v16, v16, v17
v_mov_b32 v7, v6
v_mul_f32 v16, s83, v16
s_nop 0
v_permlane16_swap_b32 v6, v7
v_pk_fma_f32 v[64:65], v[64:65], s[82:83], v[16:17] op_sel_hi:[1,0,0]
v_max_f32 v6, v6, v7
v_pk_fma_f32 v[66:67], v[66:67], s[82:83], v[16:17] op_sel_hi:[1,0,0]
v_mul_f32 v6, s83, v6
v_pk_fma_f32 v[68:69], v[68:69], s[82:83], v[16:17] op_sel_hi:[1,0,0]
v_pk_fma_f32 v[76:77], v[76:77], s[82:83], v[6:7] op_sel_hi:[1,0,0]
v_pk_fma_f32 v[70:71], v[70:71], s[82:83], v[16:17] op_sel_hi:[1,0,0]
v_pk_fma_f32 v[78:79], v[78:79], s[82:83], v[6:7] op_sel_hi:[1,0,0]
v_fma_f32 v72, v72, s82, v16
v_pk_fma_f32 v[80:81], v[80:81], s[82:83], v[6:7] op_sel_hi:[1,0,0]
v_exp_f32 v64, v64
v_pk_fma_f32 v[82:83], v[82:83], s[82:83], v[6:7] op_sel_hi:[1,0,0]
v_exp_f32 v65, v65
v_fma_f32 v84, v84, s82, v6
v_exp_f32 v66, v66
v_exp_f32 v76, v76
v_exp_f32 v67, v67
v_exp_f32 v77, v77
v_exp_f32 v68, v68
v_exp_f32 v78, v78
v_exp_f32 v69, v69
v_exp_f32 v79, v79
v_exp_f32 v70, v70
v_exp_f32 v80, v80
v_exp_f32 v71, v71
v_exp_f32 v81, v81
v_exp_f32 v72, v72
v_exp_f32 v82, v82
v_pk_add_f32 v[16:17], v[64:65], v[66:67]
v_exp_f32 v83, v83
v_pk_add_f32 v[74:75], v[68:69], v[70:71]
v_exp_f32 v84, v84
v_pk_add_f32 v[16:17], v[16:17], v[74:75]
v_pk_add_f32 v[6:7], v[76:77], v[78:79]
v_add_f32 v18, v16, v72
v_pk_add_f32 v[86:87], v[80:81], v[82:83]
v_add_f32 v18, v18, v17
v_pk_add_f32 v[6:7], v[6:7], v[86:87]
v_mov_b32 v17, v18
v_add_f32 v12, v6, v84
s_nop 0
v_permlane16_swap_b32 v18, v17
v_add_f32 v12, v12, v7
v_add_f32 v18, v18, v17
v_mov_b32 v7, v12
v_rcp_f32 v18, v18
s_nop 0
v_permlane16_swap_b32 v12, v7
v_pk_mul_f32 v[64:65], v[64:65], v[18:19] op_sel_hi:[1,0]
v_add_f32 v12, v12, v7
v_pk_mul_f32 v[66:67], v[66:67], v[18:19] op_sel_hi:[1,0]
v_rcp_f32 v12, v12
v_pk_mul_f32 v[68:69], v[68:69], v[18:19] op_sel_hi:[1,0]
v_pk_mul_f32 v[76:77], v[76:77], v[12:13] op_sel_hi:[1,0]
v_pk_mul_f32 v[70:71], v[70:71], v[18:19] op_sel_hi:[1,0]
v_pk_mul_f32 v[78:79], v[78:79], v[12:13] op_sel_hi:[1,0]
v_mul_f32 v72, v72, v18
v_pk_mul_f32 v[80:81], v[80:81], v[12:13] op_sel_hi:[1,0]
v_cvt_pk_bf16_f32 v100, v64, v65
v_pk_mul_f32 v[82:83], v[82:83], v[12:13] op_sel_hi:[1,0]
v_cvt_pk_bf16_f32 v101, v66, v67
v_mul_f32 v84, v84, v12
v_cvt_pk_bf16_f32 v102, v68, v69
v_cvt_pk_bf16_f32 v104, v76, v77
v_cvt_pk_bf16_f32 v103, v70, v71
v_cvt_pk_bf16_f32 v105, v78, v79
v_cvt_pk_bf16_f32 v88, v72, 0
v_cvt_pk_bf16_f32 v106, v80, v81
v_cvt_pk_bf16_f32 v107, v82, v83
v_cvt_pk_bf16_f32 v92, v84, 0
v_mfma_f32_16x16x32_bf16 v[64:67], v[100:103], v[48:51], 0
v_mfma_f32_16x16x32_bf16 v[68:71], v[100:103], v[46:49], 0
v_mfma_f32_16x16x32_bf16 v[72:75], v[88:91], v[44:47], 0
v_mfma_f32_16x16x32_bf16 v[76:79], v[104:107], v[48:51], 0
v_mfma_f32_16x16x32_bf16 v[80:83], v[104:107], v[46:49], 0
v_mfma_f32_16x16x32_bf16 v[84:87], v[92:95], v[44:47], 0
s_nop 2
v_cvt_pk_bf16_f32 v32, v64, v65
v_cvt_pk_bf16_f32 v33, v66, v67
v_cvt_pk_bf16_f32 v36, v68, v69
v_cvt_pk_bf16_f32 v37, v70, v71
v_cvt_pk_bf16_f32 v40, v72, v73
v_cvt_pk_bf16_f32 v41, v74, v75
v_cvt_pk_bf16_f32 v34, v76, v77
v_cvt_pk_bf16_f32 v35, v78, v79
v_cvt_pk_bf16_f32 v38, v80, v81
v_cvt_pk_bf16_f32 v39, v82, v83
v_cvt_pk_bf16_f32 v42, v84, v85
v_cvt_pk_bf16_f32 v43, v86, v87
ds_write_b128 v10, v[32:35] offset:3072
ds_write_b128 v10, v[36:39] offset:4096
ds_write_b128 v10, v[40:43] offset:5120
v_lshlrev_b32 v13, 2, v0
v_add_u32 v13, v13, v3
v_add_u32 v13, 16, v13
v_and_b32 v13, 255, v13
v_cmp_eq_u32 vcc, 0, v0
s_nop 1
v_cndmask_b32 v15, 0, 3, vcc
s_cmp_ge_u32 s65, 63
s_cbranch_scc0 slow_48
bk_47:
ds_read_b64_tr_b16 v[88:89], v4 offset:12288
ds_read_b64_tr_b16 v[90:91], v4 offset:13056
ds_read_b64_tr_b16 v[92:93], v5 offset:12288
ds_read_b64_tr_b16 v[94:95], v5 offset:13056
ds_read_b64_tr_b16 v[96:97], v4 offset:12328
ds_read_b64_tr_b16 v[98:99], v4 offset:13096
ds_read_b64_tr_b16 v[100:101], v4 offset:15360
ds_read_b64_tr_b16 v[102:103], v4 offset:16128
ds_read_b64_tr_b16 v[104:105], v5 offset:15360
ds_read_b64_tr_b16 v[106:107], v5 offset:16128
ds_read_b64_tr_b16 v[108:109], v4 offset:15400
ds_read_b64_tr_b16 v[110:111], v4 offset:16168
s_waitcnt lgkmcnt(6)
v_mfma_f32_16x16x32_bf16 v[64:67], v[112:115], v[88:91], 0
ds_read_b64_tr_b16 v[52:53], v4 offset:18432
v_mfma_f32_16x16x32_bf16 v[68:71], v[116:119], v[88:91], 0
ds_read_b64_tr_b16 v[54:55], v4 offset:19200
v_mfma_f32_16x16x32_bf16 v[72:75], v[112:115], v[92:95], 0
ds_read_b64_tr_b16 v[56:57], v5 offset:18432
v_mfma_f32_16x16x32_bf16 v[76:79], v[116:119], v[92:95], 0
ds_read_b64_tr_b16 v[58:59], v5 offset:19200
v_mfma_f32_16x16x32_bf16 v[80:83], v[112:115], v[96:99], 0
ds_read_b64_tr_b16 v[60:61], v4 offset:18472
v_mfma_f32_16x16x32_bf16 v[84:87], v[116:119], v[96:99], 0
ds_read_b64_tr_b16 v[62:63], v4 offset:19240
s_lshl_b32 s72, s5, 2
s_add_u32 s72, s72, s67
s_mul_i32 s90, s72, 20480
s_and_b32 s72, s4, 3
s_mul_i32 s72, s72, 5120
s_add_u32 s8, s72, s90
s_add_u32 s95, s90, 20480
s_add_u32 s94, s90, 10240
s_add_u32 s9, s8, 1280
s_add_u32 s10, s9, 1280
s_add_u32 s11, s10, 1280
s_waitcnt lgkmcnt(6)
v_mfma_f32_16x16x32_bf16 v[64:67], v[120:123], v[100:103], v[64:67]
s_cmp_ge_u32 s65, 72
s_cbranch_scc0 slow_50
bk_49:
ds_read_b64_tr_b16 v[88:89], v4 offset:21504
v_mfma_f32_16x16x32_bf16 v[68:71], v[124:127], v[100:103], v[68:71]
ds_read_b64_tr_b16 v[90:91], v4 offset:22272
v_mfma_f32_16x16x32_bf16 v[72:75], v[120:123], v[104:107], v[72:75]
ds_read_b64_tr_b16 v[92:93], v5 offset:21504
v_mfma_f32_16x16x32_bf16 v[76:79], v[124:127], v[104:107], v[76:79]
ds_read_b64_tr_b16 v[94:95], v5 offset:22272
v_mfma_f32_16x16x32_bf16 v[80:83], v[120:123], v[108:111], v[80:83]
ds_read_b64_tr_b16 v[96:97], v4 offset:21544
v_mfma_f32_16x16x32_bf16 v[84:87], v[124:127], v[108:111], v[84:87]
ds_read_b64_tr_b16 v[98:99], v4 offset:22312
s_waitcnt lgkmcnt(6)
v_mfma_f32_16x16x32_bf16 v[64:67], v[128:131], v[52:55], v[64:67]
ds_read_b64_tr_b16 v[100:101], v4 offset:24576
v_mfma_f32_16x16x32_bf16 v[68:71], v[132:135], v[52:55], v[68:71]
ds_read_b64_tr_b16 v[102:103], v4 offset:25344
v_mfma_f32_16x16x32_bf16 v[72:75], v[128:131], v[56:59], v[72:75]
ds_read_b64_tr_b16 v[104:105], v5 offset:24576
ds_add_u32 v13, v15
v_mfma_f32_16x16x32_bf16 v[76:79], v[132:135], v[56:59], v[76:79]
ds_read_b64_tr_b16 v[106:107], v5 offset:25344
v_mfma_f32_16x16x32_bf16 v[80:83], v[128:131], v[60:63], v[80:83]
ds_read_b64_tr_b16 v[108:109], v4 offset:24616
v_mfma_f32_16x16x32_bf16 v[84:87], v[132:135], v[60:63], v[84:87]
ds_read_b64_tr_b16 v[110:111], v4 offset:25384
s_add_u32 s12, s11, 1280
s_cmp_eq_u32 s12, s95
s_cselect_b32 s12, s90, s12
s_add_u32 s13, s12, 1280
s_add_u32 s14, s13, 1280
s_add_u32 s15, s14, 1280
s_waitcnt lgkmcnt(7)
v_mfma_f32_16x16x32_bf16 v[64:67], v[136:139], v[88:91], v[64:67]
ds_read_b64_tr_b16 v[52:53], v4 offset:27648
v_mfma_f32_16x16x32_bf16 v[68:71], v[140:143], v[88:91], v[68:71]
ds_read_b64_tr_b16 v[54:55], v4 offset:28416
v_mfma_f32_16x16x32_bf16 v[72:75], v[136:139], v[92:95], v[72:75]
ds_read_b64_tr_b16 v[56:57], v5 offset:27648
v_mfma_f32_16x16x32_bf16 v[76:79], v[140:143], v[92:95], v[76:79]
ds_read_b64_tr_b16 v[58:59], v5 offset:28416
v_mfma_f32_16x16x32_bf16 v[80:83], v[136:139], v[96:99], v[80:83]
ds_read_b64_tr_b16 v[60:61], v4 offset:27688
v_mfma_f32_16x16x32_bf16 v[84:87], v[140:143], v[96:99], v[84:87]
ds_read_b64_tr_b16 v[62:63], v4 offset:28456
s_waitcnt lgkmcnt(6)
v_mfma_f32_16x16x32_bf16 v[64:67], v[144:147], v[100:103], v[64:67]
s_cmp_ge_u32 s65, 81
s_cbranch_scc0 slow_52
bk_51:
ds_read_b64_tr_b16 v[88:89], v4 offset:30720
v_mfma_f32_16x16x32_bf16 v[68:71], v[148:151], v[100:103], v[68:71]
ds_read_b64_tr_b16 v[90:91], v4 offset:31488
v_mfma_f32_16x16x32_bf16 v[72:75], v[144:147], v[104:107], v[72:75]
ds_read_b64_tr_b16 v[92:93], v5 offset:30720
v_mfma_f32_16x16x32_bf16 v[76:79], v[148:151], v[104:107], v[76:79]
ds_read_b64_tr_b16 v[94:95], v5 offset:31488
v_mfma_f32_16x16x32_bf16 v[80:83], v[144:147], v[108:111], v[80:83]
ds_read_b64_tr_b16 v[96:97], v4 offset:30760
v_mfma_f32_16x16x32_bf16 v[84:87], v[148:151], v[108:111], v[84:87]
ds_read_b64_tr_b16 v[98:99], v4 offset:31528
s_add_u32 s24, s15, 1280
s_cmp_eq_u32 s24, s95
s_cselect_b32 s24, s90, s24
s_add_u32 s25, s24, 1280
s_add_u32 s26, s25, 1280
s_add_u32 s27, s26, 1280
s_waitcnt lgkmcnt(6)
v_mfma_f32_16x16x32_bf16 v[64:67], v[152:155], v[52:55], v[64:67]
ds_read_b64_tr_b16 v[100:101], v4 offset:33792
v_mfma_f32_16x16x32_bf16 v[68:71], v[156:159], v[52:55], v[68:71]
ds_read_b64_tr_b16 v[102:103], v4 offset:34560
v_mfma_f32_16x16x32_bf16 v[72:75], v[152:155], v[56:59], v[72:75]
ds_read_b64_tr_b16 v[104:105], v5 offset:33792
ds_add_u32 v13, v15
v_mfma_f32_16x16x32_bf16 v[76:79], v[156:159], v[56:59], v[76:79]
ds_read_b64_tr_b16 v[106:107], v5 offset:34560
v_mfma_f32_16x16x32_bf16 v[80:83], v[152:155], v[60:63], v[80:83]
ds_read_b64_tr_b16 v[108:109], v4 offset:33832
v_mfma_f32_16x16x32_bf16 v[84:87], v[156:159], v[60:63], v[84:87]
ds_read_b64_tr_b16 v[110:111], v4 offset:34600
s_waitcnt lgkmcnt(7)
v_mfma_f32_16x16x32_bf16 v[64:67], v[160:163], v[88:91], v[64:67]
ds_read_b64_tr_b16 v[52:53], v4 offset:36864
v_mfma_f32_16x16x32_bf16 v[68:71], v[164:167], v[88:91], v[68:71]
ds_read_b64_tr_b16 v[54:55], v4 offset:37632
v_mfma_f32_16x16x32_bf16 v[72:75], v[160:163], v[92:95], v[72:75]
ds_read_b64_tr_b16 v[56:57], v5 offset:36864
v_mfma_f32_16x16x32_bf16 v[76:79], v[164:167], v[92:95], v[76:79]
ds_read_b64_tr_b16 v[58:59], v5 offset:37632
v_mfma_f32_16x16x32_bf16 v[80:83], v[160:163], v[96:99], v[80:83]
ds_read_b64_tr_b16 v[60:61], v4 offset:36904
v_mfma_f32_16x16x32_bf16 v[84:87], v[164:167], v[96:99], v[84:87]
ds_read_b64_tr_b16 v[62:63], v4 offset:37672
s_add_u32 s28, s27, 1280
s_cmp_eq_u32 s28, s95
s_cselect_b32 s28, s90, s28
s_add_u32 s29, s28, 1280
s_add_u32 s30, s29, 1280
s_add_u32 s31, s30, 1280
s_waitcnt lgkmcnt(6)
v_mfma_f32_16x16x32_bf16 v[64:67], v[168:171], v[100:103], v[64:67]
s_cmp_ge_u32 s65, 90
s_cbranch_scc0 slow_54
bk_53:
ds_read_b64_tr_b16 v[88:89], v4 offset:39936
v_mfma_f32_16x16x32_bf16 v[68:71], v[172:175], v[100:103], v[68:71]
ds_read_b64_tr_b16 v[90:91], v4 offset:40704
v_mfma_f32_16x16x32_bf16 v[72:75], v[168:171], v[104:107], v[72:75]
ds_read_b64_tr_b16 v[92:93], v5 offset:39936
v_mfma_f32_16x16x32_bf16 v[76:79], v[172:175], v[104:107], v[76:79]
ds_read_b64_tr_b16 v[94:95], v5 offset:40704
v_mfma_f32_16x16x32_bf16 v[80:83], v[168:171], v[108:111], v[80:83]
ds_read_b64_tr_b16 v[96:97], v4 offset:39976
v_mfma_f32_16x16x32_bf16 v[84:87], v[172:175], v[108:111], v[84:87]
ds_read_b64_tr_b16 v[98:99], v4 offset:40744
s_waitcnt lgkmcnt(6)
v_mfma_f32_16x16x32_bf16 v[64:67], v[176:179], v[52:55], v[64:67]
ds_read_b64_tr_b16 v[100:101], v4 offset:0
v_mfma_f32_16x16x32_bf16 v[68:71], v[180:183], v[52:55], v[68:71]
ds_read_b64_tr_b16 v[102:103], v4 offset:768
v_mfma_f32_16x16x32_bf16 v[72:75], v[176:179], v[56:59], v[72:75]
ds_read_b64_tr_b16 v[104:105], v5 offset:0
ds_add_u32 v13, v15
v_mfma_f32_16x16x32_bf16 v[76:79], v[180:183], v[56:59], v[76:79]
ds_read_b64_tr_b16 v[106:107], v5 offset:768
v_mfma_f32_16x16x32_bf16 v[80:83], v[176:179], v[60:63], v[80:83]
ds_read_b64_tr_b16 v[108:109], v4 offset:40
v_mfma_f32_16x16x32_bf16 v[84:87], v[180:183], v[60:63], v[84:87]
ds_read_b64_tr_b16 v[110:111], v4 offset:808
s_waitcnt lgkmcnt(7)
v_mfma_f32_16x16x32_bf16 v[64:67], v[184:187], v[88:91], v[64:67]
ds_read_b64_tr_b16 v[52:53], v4 offset:3072
v_mfma_f32_16x16x32_bf16 v[68:71], v[188:191], v[88:91], v[68:71]
ds_read_b64_tr_b16 v[54:55], v4 offset:3840
v_mfma_f32_16x16x32_bf16 v[72:75], v[184:187], v[92:95], v[72:75]
ds_read_b64_tr_b16 v[56:57], v5 offset:3072
v_mfma_f32_16x16x32_bf16 v[76:79], v[188:191], v[92:95], v[76:79]
ds_read_b64_tr_b16 v[58:59], v5 offset:3840
v_mfma_f32_16x16x32_bf16 v[80:83], v[184:187], v[96:99], v[80:83]
ds_read_b64_tr_b16 v[60:61], v4 offset:3112
v_mfma_f32_16x16x32_bf16 v[84:87], v[188:191], v[96:99], v[84:87]
ds_read_b64_tr_b16 v[62:63], v4 offset:3880
s_waitcnt lgkmcnt(6)
v_mfma_f32_16x16x32_bf16 v[64:67], v[192:195], v[100:103], v[64:67]
s_cmp_ge_u32 s65, 99
s_cbranch_scc0 slow_56
bk_55:
ds_read_b64_tr_b16 v[88:89], v4 offset:6144
v_mfma_f32_16x16x32_bf16 v[68:71], v[196:199], v[100:103], v[68:71]
ds_read_b64_tr_b16 v[90:91], v4 offset:6912
v_mfma_f32_16x16x32_bf16 v[72:75], v[192:195], v[104:107], v[72:75]
ds_read_b64_tr_b16 v[92:93], v5 offset:6144
v_mfma_f32_16x16x32_bf16 v[76:79], v[196:199], v[104:107], v[76:79]
ds_read_b64_tr_b16 v[94:95], v5 offset:6912
v_mfma_f32_16x16x32_bf16 v[80:83], v[192:195], v[108:111], v[80:83]
ds_read_b64_tr_b16 v[96:97], v4 offset:6184
v_mfma_f32_16x16x32_bf16 v[84:87], v[196:199], v[108:111], v[84:87]
ds_read_b64_tr_b16 v[98:99], v4 offset:6952
s_waitcnt lgkmcnt(6)
v_mfma_f32_16x16x32_bf16 v[64:67], v[200:203], v[52:55], v[64:67]
ds_read_b64_tr_b16 v[100:101], v4 offset:9216
v_mfma_f32_16x16x32_bf16 v[68:71], v[204:207], v[52:55], v[68:71]
ds_read_b64_tr_b16 v[102:103], v4 offset:9984
v_mfma_f32_16x16x32_bf16 v[72:75], v[200:203], v[56:59], v[72:75]
ds_read_b64_tr_b16 v[104:105], v5 offset:9216
ds_add_u32 v13, v15
v_mfma_f32_16x16x32_bf16 v[76:79], v[204:207], v[56:59], v[76:79]
ds_read_b64_tr_b16 v[106:107], v5 offset:9984
v_mfma_f32_16x16x32_bf16 v[80:83], v[200:203], v[60:63], v[80:83]
ds_read_b64_tr_b16 v[108:109], v4 offset:9256
v_mfma_f32_16x16x32_bf16 v[84:87], v[204:207], v[60:63], v[84:87]
ds_read_b64_tr_b16 v[110:111], v4 offset:10024
s_waitcnt lgkmcnt(7)
v_mfma_f32_16x16x32_bf16 v[64:67], v[208:211], v[88:91], v[64:67]
ds_read_b64_tr_b16 v[52:53], v4 offset:52224
v_mfma_f32_16x16x32_bf16 v[68:71], v[212:215], v[88:91], v[68:71]
ds_read_b64_tr_b16 v[54:55], v4 offset:52992
v_mfma_f32_16x16x32_bf16 v[72:75], v[208:211], v[92:95], v[72:75]
ds_read_b64_tr_b16 v[56:57], v5 offset:52224
v_mfma_f32_16x16x32_bf16 v[76:79], v[212:215], v[92:95], v[76:79]
ds_read_b64_tr_b16 v[58:59], v5 offset:52992
v_mfma_f32_16x16x32_bf16 v[80:83], v[208:211], v[96:99], v[80:83]
ds_read_b64_tr_b16 v[60:61], v4 offset:52264
v_mfma_f32_16x16x32_bf16 v[84:87], v[212:215], v[96:99], v[84:87]
ds_read_b64_tr_b16 v[62:63], v4 offset:53032
s_waitcnt lgkmcnt(6)
v_mfma_f32_16x16x32_bf16 v[64:67], v[216:219], v[100:103], v[64:67]
s_cmp_ge_u32 s65, 108
s_cbranch_scc0 slow_58
bk_57:
ds_read_b64_tr_b16 v[88:89], v4 offset:64512
v_mfma_f32_16x16x32_bf16 v[68:71], v[220:223], v[100:103], v[68:71]
ds_read_b64_tr_b16 v[90:91], v4 offset:65280
v_mfma_f32_16x16x32_bf16 v[72:75], v[216:219], v[104:107], v[72:75]
ds_read_b64_tr_b16 v[92:93], v5 offset:64512
v_mfma_f32_16x16x32_bf16 v[76:79], v[220:223], v[104:107], v[76:79]
ds_read_b64_tr_b16 v[94:95], v5 offset:65280
v_mfma_f32_16x16x32_bf16 v[80:83], v[216:219], v[108:111], v[80:83]
ds_read_b64_tr_b16 v[96:97], v4 offset:64552
v_mfma_f32_16x16x32_bf16 v[84:87], v[220:223], v[108:111], v[84:87]
ds_read_b64_tr_b16 v[98:99], v4 offset:65320
s_waitcnt lgkmcnt(6)
v_mfma_f32_16x16x32_bf16 v[64:67], v[224:227], v[52:55], v[64:67]
ds_read_b64_tr_b16 v[100:101], v8 offset:44032
v_mfma_f32_16x16x32_bf16 v[68:71], v[228:231], v[52:55], v[68:71]
ds_read_b64_tr_b16 v[102:103], v8 offset:44800
v_mfma_f32_16x16x32_bf16 v[72:75], v[224:227], v[56:59], v[72:75]
ds_read_b64_tr_b16 v[104:105], v9 offset:44032
ds_add_u32 v13, v15
v_mfma_f32_16x16x32_bf16 v[76:79], v[228:231], v[56:59], v[76:79]
ds_read_b64_tr_b16 v[106:107], v9 offset:44800
v_mfma_f32_16x16x32_bf16 v[80:83], v[224:227], v[60:63], v[80:83]
ds_read_b64_tr_b16 v[108:109], v8 offset:44072
v_mfma_f32_16x16x32_bf16 v[84:87], v[228:231], v[60:63], v[84:87]
ds_read_b64_tr_b16 v[110:111], v8 offset:44840
s_waitcnt lgkmcnt(7)
v_mfma_f32_16x16x32_bf16 v[64:67], v[232:235], v[88:91], v[64:67]
ds_read_b64_tr_b16 v[52:53], v8 offset:56320
v_mfma_f32_16x16x32_bf16 v[68:71], v[236:239], v[88:91], v[68:71]
ds_read_b64_tr_b16 v[54:55], v8 offset:57088
v_mfma_f32_16x16x32_bf16 v[72:75], v[232:235], v[92:95], v[72:75]
ds_read_b64_tr_b16 v[56:57], v9 offset:56320
v_mfma_f32_16x16x32_bf16 v[76:79], v[236:239], v[92:95], v[76:79]
ds_read_b64_tr_b16 v[58:59], v9 offset:57088
v_mfma_f32_16x16x32_bf16 v[80:83], v[232:235], v[96:99], v[80:83]
ds_read_b64_tr_b16 v[60:61], v8 offset:56360
v_mfma_f32_16x16x32_bf16 v[84:87], v[236:239], v[96:99], v[84:87]
ds_read_b64_tr_b16 v[62:63], v8 offset:57128
s_waitcnt lgkmcnt(6)
v_mfma_f32_16x16x32_bf16 v[64:67], v[240:243], v[100:103], v[64:67]
v_mfma_f32_16x16x32_bf16 v[68:71], v[244:247], v[100:103], v[68:71]
v_mfma_f32_16x16x32_bf16 v[72:75], v[240:243], v[104:107], v[72:75]
v_mfma_f32_16x16x32_bf16 v[76:79], v[244:247], v[104:107], v[76:79]
v_mfma_f32_16x16x32_bf16 v[80:83], v[240:243], v[108:111], v[80:83]
v_mfma_f32_16x16x32_bf16 v[84:87], v[244:247], v[108:111], v[84:87]
s_waitcnt lgkmcnt(0)
v_mfma_f32_16x16x32_bf16 v[64:67], v[248:251], v[52:55], v[64:67]
v_mfma_f32_16x16x32_bf16 v[68:71], v[252:255], v[52:55], v[68:71]
v_mfma_f32_16x16x32_bf16 v[72:75], v[248:251], v[56:59], v[72:75]
ds_add_u32 v13, v15
v_mfma_f32_16x16x32_bf16 v[76:79], v[252:255], v[56:59], v[76:79]
v_mfma_f32_16x16x32_bf16 v[80:83], v[248:251], v[60:63], v[80:83]
v_mfma_f32_16x16x32_bf16 v[84:87], v[252:255], v[60:63], v[84:87]
v_min_u32 v15, 1, v15
s_nop 0
v_cvt_pk_bf16_f32 v52, v64, v65
v_cvt_pk_bf16_f32 v53, v66, v67
v_cvt_pk_bf16_f32 v54, v68, v69
v_cvt_pk_bf16_f32 v55, v70, v71
v_cvt_pk_bf16_f32 v56, v72, v73
v_cvt_pk_bf16_f32 v57, v74, v75
v_cvt_pk_bf16_f32 v58, v76, v77
v_cvt_pk_bf16_f32 v59, v78, v79
v_cvt_pk_bf16_f32 v60, v80, v81
v_cvt_pk_bf16_f32 v61, v82, v83
v_cvt_pk_bf16_f32 v62, v84, v85
v_cvt_pk_bf16_f32 v63, v86, v87
v_cmp_eq_u32 vcc, 4, v1
v_mov_b32 v11, 0x3f803f80
s_nop 0
v_cndmask_b32 v56, v56, v11, vcc
v_cndmask_b32 v57, v57, v11, vcc
v_cndmask_b32 v58, v58, v11, vcc
v_cndmask_b32 v59, v59, v11, vcc
ds_write_b128 v10, v[52:55] offset:6144
ds_write_b128 v10, v[56:59] offset:7168
ds_write_b128 v10, v[60:63] offset:8192
s_lshr_b32 s72, s67, 1
s_mul_i32 s73, s72, 3072
s_lshl_b32 s74, s72, 11
s_bitcmp1_b32 s67, 0
s_cselect_b32 s74, 1024, s74
s_add_u32 s74, s74, 6144
v_lshlrev_b32 v10, 4, v0
v_add_u32 v10, 43264, v10
v_add_u32 v11, s73, v10
v_add_u32 v12, s74, v10
s_waitcnt lgkmcnt(0)
v_mov_b32 v16, 1
ds_write_b32 v3, v16 offset:32
s_mov_b32 s68, 0
s_cmp_ge_u32 s68, 1
s_cbranch_scc1 ok_59
poll_60:
ds_read_b128 v[16:19], v45 offset:32
s_waitcnt lgkmcnt(0)
v_min_u32 v16, v16, v17
v_min3_u32 v16, v16, v18, v19
s_nop 0
v_readfirstlane_b32 s68, v16
s_cmp_ge_u32 s68, 1
s_cbranch_scc1 ok_59
s_sub_u32 s64, s64, 1
s_cbranch_scc0 poll_60
s_mov_b32 s64, 0
ok_59:
ds_read_b128 v[88:91], v11 offset:0
ds_read_b128 v[92:95], v11 offset:1024
ds_read_b128 v[96:99], v11 offset:2048
ds_read_b128 v[100:103], v12 offset:0
ds_read_b128 v[20:23], v11 offset:12288
ds_read_b128 v[24:27], v11 offset:13312
ds_read_b128 v[28:31], v11 offset:14336
ds_read_b128 v[32:35], v12 offset:12288
s_bitcmp1_b32 s67, 0
s_cbranch_scc0 kve_61
v_cmp_eq_u32 vcc, 4, v1
v_and_b32 v16, 1, v1
v_mul_u32_u24 v17, 3, v2
v_cndmask_b32 v16, v16, 2, vcc
v_add_u32 v16, v16, v17
v_lshrrev_b32 v17, 1, v1
s_lshr_b32 s75, s67, 1
v_cmp_eq_u32 s[76:77], s75, v17
s_or_b64 s[92:93], vcc, s[76:77]
v_mov_b32 v18, 0x40000000
v_lshlrev_b32 v17, 4, v16
v_cndmask_b32 v6, v18, v17, s[92:93]
v_lshrrev_b32 v17, 2, v0
v_cmp_eq_u32 vcc, 2, v17
v_lshlrev_b32 v17, 1, v1
v_add_u32 v17, 200, v17
v_cndmask_b32 v17, v18, v17, vcc
v_lshlrev_b32 v16, 1, v16
v_add_u32 v16, 192, v16
v_cndmask_b32 v7, v17, v16, s[92:93]
s_branch kvd_62
kve_61:
v_lshlrev_b32 v6, 4, v0
v_lshlrev_b32 v7, 1, v0
v_add_u32 v7, 1024, v7
s_mov_b64 s[92:93], -1
kvd_62:
s_waitcnt lgkmcnt(4)
v_mfma_f32_16x16x32_bf16 v[64:67], v[88:91], v[100:103], 0
v_mfma_f32_16x16x32_bf16 v[68:71], v[92:95], v[100:103], 0
v_mfma_f32_16x16x32_bf16 v[72:75], v[96:99], v[100:103], 0
s_waitcnt lgkmcnt(0)
v_mfma_f32_16x16x32_bf16 v[64:67], v[20:23], v[32:35], v[64:67]
v_mfma_f32_16x16x32_bf16 v[68:71], v[24:27], v[32:35], v[68:71]
v_mfma_f32_16x16x32_bf16 v[72:75], v[28:31], v[32:35], v[72:75]
ds_read_b128 v[88:91], v11 offset:24576
ds_read_b128 v[92:95], v11 offset:25600
ds_read_b128 v[96:99], v11 offset:26624
ds_read_b128 v[100:103], v12 offset:24576
ds_read_b128 v[20:23], v11 offset:36864
ds_read_b128 v[24:27], v11 offset:37888
ds_read_b128 v[28:31], v11 offset:38912
ds_read_b128 v[32:35], v12 offset:36864
s_waitcnt lgkmcnt(4)
v_mfma_f32_16x16x32_bf16 v[64:67], v[88:91], v[100:103], v[64:67]
v_mfma_f32_16x16x32_bf16 v[68:71], v[92:95], v[100:103], v[68:71]
v_mfma_f32_16x16x32_bf16 v[72:75], v[96:99], v[100:103], v[72:75]
s_waitcnt lgkmcnt(0)
v_mfma_f32_16x16x32_bf16 v[64:67], v[20:23], v[32:35], v[64:67]
v_mfma_f32_16x16x32_bf16 v[68:71], v[24:27], v[32:35], v[68:71]
v_mfma_f32_16x16x32_bf16 v[72:75], v[28:31], v[32:35], v[72:75]
s_lshl_b32 s72, s5, 2
s_add_u32 s72, s72, s67
s_lshl_b32 s73, s72, 4
s_add_u32 s73, s73, s4
s_mul_i32 s74, s73, 1280
s_nop 0
v_cvt_pk_bf16_f32 v12, v64, v65
v_cvt_pk_bf16_f32 v13, v66, v67
v_cvt_pk_bf16_f32 v14, v68, v69
v_cvt_pk_bf16_f32 v15, v70, v71
v_cvt_pk_bf16_f32 v16, v72, v72
buffer_store_dwordx4 v[12:15], v6, s[16:19], s74 offen sc1
v_cndmask_b32 v16, 0, v16, s[92:93]
buffer_store_short v16, v7, s[16:19], s74 offen sc1
s_lshl_b32 s74, s73, 7
s_add_u32 s74, s74, 0xc00000
v_mov_b32 v20, s74
v_mov_b32 v21, s66
s_lshl_b32 s73, s72, 11
s_add_u32 s73, s73, 0xc00000
v_and_b32 v22, 15, v0
v_lshlrev_b32 v22, 7, v22
v_add_u32 v22, s73, v22
v_lshlrev_b32 v13, 2, v0
v_add_u32 v13, v13, v3
v_add_u32 v13, 16, v13
v_and_b32 v13, 255, v13
v_cmp_eq_u32 vcc, 0, v0
s_nop 1
v_cndmask_b32 v15, 0, 3, vcc
s_cmp_ge_u32 s65, 117
s_cbranch_scc0 slow_64
bk_63:
ds_read_b64_tr_b16 v[88:89], v4 offset:12288
ds_read_b64_tr_b16 v[90:91], v4 offset:13056
ds_read_b64_tr_b16 v[92:93], v4 offset:12320
ds_read_b64_tr_b16 v[94:95], v4 offset:13088
ds_read_b64_tr_b16 v[96:97], v4 offset:12352
ds_read_b64_tr_b16 v[98:99], v4 offset:13120
ds_read_b64_tr_b16 v[100:101], v4 offset:15360
ds_read_b64_tr_b16 v[102:103], v4 offset:16128
ds_read_b64_tr_b16 v[104:105], v4 offset:15392
ds_read_b64_tr_b16 v[106:107], v4 offset:16160
ds_read_b64_tr_b16 v[108:109], v4 offset:15424
ds_read_b64_tr_b16 v[110:111], v4 offset:16192
s_waitcnt lgkmcnt(6)
v_mfma_f32_16x16x32_bf16 v[64:67], v[88:91], v[112:115], 0
ds_read_b64_tr_b16 v[52:53], v4 offset:18432
v_mfma_f32_16x16x32_bf16 v[68:71], v[88:91], v[116:119], 0
ds_read_b64_tr_b16 v[54:55], v4 offset:19200
v_mfma_f32_16x16x32_bf16 v[72:75], v[92:95], v[112:115], 0
ds_read_b64_tr_b16 v[56:57], v4 offset:18464
v_mfma_f32_16x16x32_bf16 v[76:79], v[92:95], v[116:119], 0
ds_read_b64_tr_b16 v[58:59], v4 offset:19232
v_mfma_f32_16x16x32_bf16 v[80:83], v[96:99], v[112:115], 0
ds_read_b64_tr_b16 v[60:61], v4 offset:18496
v_mfma_f32_16x16x32_bf16 v[84:87], v[96:99], v[116:119], 0
ds_read_b64_tr_b16 v[62:63], v4 offset:19264
s_waitcnt lgkmcnt(6)
v_mfma_f32_16x16x32_bf16 v[64:67], v[100:103], v[120:123], v[64:67]
s_cmp_ge_u32 s65, 126
s_cbranch_scc0 slow_66
bk_65:
ds_read_b64_tr_b16 v[88:89], v4 offset:21504
v_mfma_f32_16x16x32_bf16 v[68:71], v[100:103], v[124:127], v[68:71]
ds_read_b64_tr_b16 v[90:91], v4 offset:22272
v_and_b32 v39, 1, v1
v_mfma_f32_16x16x32_bf16 v[72:75], v[104:107], v[120:123], v[72:75]
ds_read_b64_tr_b16 v[92:93], v4 offset:21536
v_lshlrev_b32 v39, 4, v39
v_mfma_f32_16x16x32_bf16 v[76:79], v[104:107], v[124:127], v[76:79]
ds_read_b64_tr_b16 v[94:95], v4 offset:22304
v_mov_b32 v40, 0x3f80
v_mfma_f32_16x16x32_bf16 v[80:83], v[108:111], v[120:123], v[80:83]
ds_read_b64_tr_b16 v[96:97], v4 offset:21568
v_lshlrev_b32 v40, v39, v40
v_mfma_f32_16x16x32_bf16 v[84:87], v[108:111], v[124:127], v[84:87]
ds_read_b64_tr_b16 v[98:99], v4 offset:22336
v_lshrrev_b32 v39, 1, v1
s_waitcnt lgkmcnt(6)
v_mfma_f32_16x16x32_bf16 v[64:67], v[52:55], v[128:131], v[64:67]
ds_read_b64_tr_b16 v[100:101], v4 offset:24576
v_mfma_f32_16x16x32_bf16 v[68:71], v[52:55], v[132:135], v[68:71]
ds_read_b64_tr_b16 v[102:103], v4 offset:25344
v_cmp_eq_u32 vcc, 0, v39
v_mfma_f32_16x16x32_bf16 v[72:75], v[56:59], v[128:131], v[72:75]
ds_read_b64_tr_b16 v[104:105], v4 offset:24608
ds_add_u32 v13, v15
v_mfma_f32_16x16x32_bf16 v[76:79], v[56:59], v[132:135], v[76:79]
ds_read_b64_tr_b16 v[106:107], v4 offset:25376
v_cndmask_b32 v24, 0, v40, vcc
v_mfma_f32_16x16x32_bf16 v[80:83], v[60:63], v[128:131], v[80:83]
ds_read_b64_tr_b16 v[108:109], v4 offset:24640
v_cmp_eq_u32 vcc, 1, v39
v_mfma_f32_16x16x32_bf16 v[84:87], v[60:63], v[132:135], v[84:87]
ds_read_b64_tr_b16 v[110:111], v4 offset:25408
v_cndmask_b32 v25, 0, v40, vcc
s_waitcnt lgkmcnt(7)
v_mfma_f32_16x16x32_bf16 v[64:67], v[88:91], v[136:139], v[64:67]
ds_read_b64_tr_b16 v[52:53], v4 offset:27648
v_mfma_f32_16x16x32_bf16 v[68:71], v[88:91], v[140:143], v[68:71]
ds_read_b64_tr_b16 v[54:55], v4 offset:28416
v_cmp_eq_u32 vcc, 2, v39
v_mfma_f32_16x16x32_bf16 v[72:75], v[92:95], v[136:139], v[72:75]
ds_read_b64_tr_b16 v[56:57], v4 offset:27680
v_cndmask_b32 v26, 0, v40, vcc
v_mfma_f32_16x16x32_bf16 v[76:79], v[92:95], v[140:143], v[76:79]
ds_read_b64_tr_b16 v[58:59], v4 offset:28448
v_cmp_eq_u32 vcc, 3, v39
v_mfma_f32_16x16x32_bf16 v[80:83], v[96:99], v[136:139], v[80:83]
ds_read_b64_tr_b16 v[60:61], v4 offset:27712
v_cndmask_b32 v27, 0, v40, vcc
v_mfma_f32_16x16x32_bf16 v[84:87], v[96:99], v[140:143], v[84:87]
ds_read_b64_tr_b16 v[62:63], v4 offset:28480
s_and_b32 s72, s67, 1
s_waitcnt lgkmcnt(6)
v_mfma_f32_16x16x32_bf16 v[64:67], v[100:103], v[144:147], v[64:67]
s_cmp_ge_u32 s65, 135
s_cbranch_scc0 slow_68
bk_67:
ds_read_b64_tr_b16 v[88:89], v4 offset:30720
v_mfma_f32_16x16x32_bf16 v[68:71], v[100:103], v[148:151], v[68:71]
ds_read_b64_tr_b16 v[90:91], v4 offset:31488
s_add_u32 s73, s72, 3
v_mfma_f32_16x16x32_bf16 v[72:75], v[104:107], v[144:147], v[72:75]
ds_read_b64_tr_b16 v[92:93], v4 offset:30752
v_lshrrev_b32 v39, s73, v0
v_mfma_f32_16x16x32_bf16 v[76:79], v[104:107], v[148:151], v[76:79]
ds_read_b64_tr_b16 v[94:95], v4 offset:31520
v_mul_u32_u24 v40, 1280, v39
v_mfma_f32_16x16x32_bf16 v[80:83], v[108:111], v[144:147], v[80:83]
ds_read_b64_tr_b16 v[96:97], v4 offset:30784
v_lshlrev_b32 v39, s73, v39
v_mfma_f32_16x16x32_bf16 v[84:87], v[108:111], v[148:151], v[84:87]
ds_read_b64_tr_b16 v[98:99], v4 offset:31552
v_sub_u32 v39, v0, v39
s_waitcnt lgkmcnt(6)
v_mfma_f32_16x16x32_bf16 v[64:67], v[52:55], v[152:155], v[64:67]
ds_read_b64_tr_b16 v[100:101], v4 offset:33792
v_mfma_f32_16x16x32_bf16 v[68:71], v[52:55], v[156:159], v[68:71]
ds_read_b64_tr_b16 v[102:103], v4 offset:34560
v_lshl_add_u32 v40, v39, 4, v40
v_mfma_f32_16x16x32_bf16 v[72:75], v[56:59], v[152:155], v[72:75]
ds_read_b64_tr_b16 v[104:105], v4 offset:33824
ds_add_u32 v13, v15
v_mfma_f32_16x16x32_bf16 v[76:79], v[56:59], v[156:159], v[76:79]
ds_read_b64_tr_b16 v[106:107], v4 offset:34592
s_xor_b32 s73, s72, 1
v_mfma_f32_16x16x32_bf16 v[80:83], v[60:63], v[152:155], v[80:83]
ds_read_b64_tr_b16 v[108:109], v4 offset:33856
s_lshl_b32 s73, s73, 10
v_mfma_f32_16x16x32_bf16 v[84:87], v[60:63], v[156:159], v[84:87]
ds_read_b64_tr_b16 v[110:111], v4 offset:34624
v_add_u32 v40, s73, v40
s_waitcnt lgkmcnt(7)
v_mfma_f32_16x16x32_bf16 v[64:67], v[88:91], v[160:163], v[64:67]
ds_read_b64_tr_b16 v[52:53], v4 offset:36864
v_mfma_f32_16x16x32_bf16 v[68:71], v[88:91], v[164:167], v[68:71]
ds_read_b64_tr_b16 v[54:55], v4 offset:37632
s_mul_i32 s73, s72, 14
v_mfma_f32_16x16x32_bf16 v[72:75], v[92:95], v[160:163], v[72:75]
ds_read_b64_tr_b16 v[56:57], v4 offset:36896
s_sub_u32 s73, 0x1e, s73
v_mfma_f32_16x16x32_bf16 v[76:79], v[92:95], v[164:167], v[76:79]
ds_read_b64_tr_b16 v[58:59], v4 offset:37664
s_sub_u32 s73, s73, s72
v_mfma_f32_16x16x32_bf16 v[80:83], v[96:99], v[160:163], v[80:83]
ds_read_b64_tr_b16 v[60:61], v4 offset:36928
s_sub_u32 s73, s73, s72
v_mfma_f32_16x16x32_bf16 v[84:87], v[96:99], v[164:167], v[84:87]
ds_read_b64_tr_b16 v[62:63], v4 offset:37696
v_cmp_gt_u32 vcc, s73, v1
s_waitcnt lgkmcnt(6)
v_mfma_f32_16x16x32_bf16 v[64:67], v[100:103], v[168:171], v[64:67]
s_cmp_ge_u32 s65, 144
s_cbranch_scc0 slow_70
bk_69:
ds_read_b64_tr_b16 v[88:89], v4 offset:39936
v_mfma_f32_16x16x32_bf16 v[68:71], v[100:103], v[172:175], v[68:71]
ds_read_b64_tr_b16 v[90:91], v4 offset:40704
v_mov_b32 v39, 0x40000000
v_mfma_f32_16x16x32_bf16 v[72:75], v[104:107], v[168:171], v[72:75]
ds_read_b64_tr_b16 v[92:93], v4 offset:39968
v_cndmask_b32 v23, v39, v40, vcc
v_mfma_f32_16x16x32_bf16 v[76:79], v[104:107], v[172:175], v[76:79]
ds_read_b64_tr_b16 v[94:95], v4 offset:40736
s_lshl_b32 s73, s67, 10
v_mfma_f32_16x16x32_bf16 v[80:83], v[108:111], v[168:171], v[80:83]
ds_read_b64_tr_b16 v[96:97], v4 offset:40000
s_add_u32 s73, s73, 92416
v_mfma_f32_16x16x32_bf16 v[84:87], v[108:111], v[172:175], v[84:87]
ds_read_b64_tr_b16 v[98:99], v4 offset:40768
s_mul_i32 s74, s72, 248
s_waitcnt vmcnt(0)
s_mov_b64 exec, 1
buffer_store_dword v21, v20, s[16:19], 0 offen sc1
s_mov_b64 exec, -1
s_waitcnt lgkmcnt(6)
v_mfma_f32_16x16x32_bf16 v[64:67], v[52:55], v[176:179], v[64:67]
ds_read_b64_tr_b16 v[100:101], v4 offset:0
v_mfma_f32_16x16x32_bf16 v[68:71], v[52:55], v[180:183], v[68:71]
ds_read_b64_tr_b16 v[102:103], v4 offset:768
s_sub_u32 s74, 256, s74
v_mfma_f32_16x16x32_bf16 v[72:75], v[56:59], v[176:179], v[72:75]
ds_read_b64_tr_b16 v[104:105], v4 offset:32
ds_add_u32 v13, v15
v_mfma_f32_16x16x32_bf16 v[76:79], v[56:59], v[180:183], v[76:79]
ds_read_b64_tr_b16 v[106:107], v4 offset:800
v_mul_u32_u24 v39, s74, v2
v_mfma_f32_16x16x32_bf16 v[80:83], v[60:63], v[176:179], v[80:83]
ds_read_b64_tr_b16 v[108:109], v4 offset:64
v_lshl_add_u32 v39, v1, 4, v39
v_mfma_f32_16x16x32_bf16 v[84:87], v[60:63], v[180:183], v[84:87]
ds_read_b64_tr_b16 v[110:111], v4 offset:832
v_add_u32 v28, s73, v39
s_waitcnt lgkmcnt(7)
v_mfma_f32_16x16x32_bf16 v[64:67], v[88:91], v[184:187], v[64:67]
ds_read_b64_tr_b16 v[52:53], v4 offset:3072
v_mfma_f32_16x16x32_bf16 v[68:71], v[88:91], v[188:191], v[68:71]
ds_read_b64_tr_b16 v[54:55], v4 offset:3840
s_lshl_b32 s73, s67, 8
v_mfma_f32_16x16x32_bf16 v[72:75], v[92:95], v[184:187], v[72:75]
ds_read_b64_tr_b16 v[56:57], v4 offset:3104
s_mul_i32 s74, s72, 384
v_mfma_f32_16x16x32_bf16 v[76:79], v[92:95], v[188:191], v[76:79]
ds_read_b64_tr_b16 v[58:59], v4 offset:3872
s_sub_u32 s73, s73, s74
v_mfma_f32_16x16x32_bf16 v[80:83], v[96:99], v[184:187], v[80:83]
ds_read_b64_tr_b16 v[60:61], v4 offset:3136
s_add_u32 s73, s73, 96512
v_mfma_f32_16x16x32_bf16 v[84:87], v[96:99], v[188:191], v[84:87]
ds_read_b64_tr_b16 v[62:63], v4 offset:3904
v_lshlrev_b32 v39, 5, v1
s_waitcnt lgkmcnt(6)
v_mfma_f32_16x16x32_bf16 v[64:67], v[100:103], v[192:195], v[64:67]
s_cmp_ge_u32 s65, 153
s_cbranch_scc0 slow_72
bk_71:
ds_read_b64_tr_b16 v[88:89], v4 offset:6144
v_mfma_f32_16x16x32_bf16 v[68:71], v[100:103], v[196:199], v[68:71]
ds_read_b64_tr_b16 v[90:91], v4 offset:6912
v_lshl_add_u32 v39, v2, 4, v39
v_mfma_f32_16x16x32_bf16 v[72:75], v[104:107], v[192:195], v[72:75]
ds_read_b64_tr_b16 v[92:93], v4 offset:6176
v_add_u32 v29, s73, v39
v_mfma_f32_16x16x32_bf16 v[76:79], v[104:107], v[196:199], v[76:79]
ds_read_b64_tr_b16 v[94:95], v4 offset:6944
v_lshrrev_b32 v10, 2, v1
v_mfma_f32_16x16x32_bf16 v[80:83], v[108:111], v[192:195], v[80:83]
ds_read_b64_tr_b16 v[96:97], v4 offset:6208
v_and_b32 v11, 3, v1
v_mfma_f32_16x16x32_bf16 v[84:87], v[108:111], v[196:199], v[84:87]
ds_read_b64_tr_b16 v[98:99], v4 offset:6976
v_mul_u32_u24 v12, 3, v10
s_waitcnt lgkmcnt(6)
v_mfma_f32_16x16x32_bf16 v[64:67], v[52:55], v[200:203], v[64:67]
ds_read_b64_tr_b16 v[100:101], v4 offset:9216
v_mfma_f32_16x16x32_bf16 v[68:71], v[52:55], v[204:207], v[68:71]
ds_read_b64_tr_b16 v[102:103], v4 offset:9984
v_add_u32 v12, v12, v11
v_mfma_f32_16x16x32_bf16 v[72:75], v[56:59], v[200:203], v[72:75]
ds_read_b64_tr_b16 v[104:105], v4 offset:9248
ds_add_u32 v13, v15
v_mfma_f32_16x16x32_bf16 v[76:79], v[56:59], v[204:207], v[76:79]
ds_read_b64_tr_b16 v[106:107], v4 offset:10016
v_cmp_eq_u32 s[74:75], 3, v11
v_mfma_f32_16x16x32_bf16 v[80:83], v[60:63], v[200:203], v[80:83]
ds_read_b64_tr_b16 v[108:109], v4 offset:9280
v_mul_u32_u24 v17, 3, v2
v_mfma_f32_16x16x32_bf16 v[84:87], v[60:63], v[204:207], v[84:87]
ds_read_b64_tr_b16 v[110:111], v4 offset:10048
v_lshlrev_b32 v18, 4, v2
s_waitcnt lgkmcnt(7)
v_mfma_f32_16x16x32_bf16 v[64:67], v[88:91], v[208:211], v[64:67]
ds_read_b64_tr_b16 v[52:53], v4 offset:52224
v_mfma_f32_16x16x32_bf16 v[68:71], v[88:91], v[212:215], v[68:71]
ds_read_b64_tr_b16 v[54:55], v4 offset:52992
v_add_u32 v40, v12, v18
v_mfma_f32_16x16x32_bf16 v[72:75], v[92:95], v[208:211], v[72:75]
ds_read_b64_tr_b16 v[56:57], v4 offset:52256
v_add_u32 v39, 66, v17
v_mfma_f32_16x16x32_bf16 v[76:79], v[92:95], v[212:215], v[76:79]
ds_read_b64_tr_b16 v[58:59], v4 offset:53024
v_cndmask_b32 v40, v40, v39, s[74:75]
v_mfma_f32_16x16x32_bf16 v[80:83], v[96:99], v[208:211], v[80:83]
ds_read_b64_tr_b16 v[60:61], v4 offset:52288
v_lshlrev_b32 v30, 4, v40
v_mfma_f32_16x16x32_bf16 v[84:87], v[96:99], v[212:215], v[84:87]
ds_read_b64_tr_b16 v[62:63], v4 offset:53056
v_add_u32 v30, 92416, v30
s_waitcnt lgkmcnt(6)
v_mfma_f32_16x16x32_bf16 v[64:67], v[100:103], v[216:219], v[64:67]
s_cmp_ge_u32 s65, 162
s_cbranch_scc0 slow_74
bk_73:
ds_read_b64_tr_b16 v[88:89], v4 offset:64512
v_mfma_f32_16x16x32_bf16 v[68:71], v[100:103], v[220:223], v[68:71]
ds_read_b64_tr_b16 v[90:91], v4 offset:65280
v_lshlrev_b32 v34, 2, v40
v_mfma_f32_16x16x32_bf16 v[72:75], v[104:107], v[216:219], v[72:75]
ds_read_b64_tr_b16 v[92:93], v4 offset:64544
v_add_u32 v34, 96512, v34
v_mfma_f32_16x16x32_bf16 v[76:79], v[104:107], v[220:223], v[76:79]
ds_read_b64_tr_b16 v[94:95], v4 offset:65312
v_add_u32 v40, v12, v18
v_mfma_f32_16x16x32_bf16 v[80:83], v[108:111], v[216:219], v[80:83]
ds_read_b64_tr_b16 v[96:97], v4 offset:64576
v_add_u32 v40, 126, v40
v_mfma_f32_16x16x32_bf16 v[84:87], v[108:111], v[220:223], v[84:87]
ds_read_b64_tr_b16 v[98:99], v4 offset:65344
v_add_u32 v39, v12, v17
s_waitcnt lgkmcnt(6)
v_mfma_f32_16x16x32_bf16 v[64:67], v[52:55], v[224:227], v[64:67]
ds_read_b64_tr_b16 v[100:101], v8 offset:44032
v_mfma_f32_16x16x32_bf16 v[68:71], v[52:55], v[228:231], v[68:71]
ds_read_b64_tr_b16 v[102:103], v8 offset:44800
v_add_u32 v39, 192, v39
v_mfma_f32_16x16x32_bf16 v[72:75], v[56:59], v[224:227], v[72:75]
ds_read_b64_tr_b16 v[104:105], v8 offset:44064
ds_add_u32 v13, v15
v_mfma_f32_16x16x32_bf16 v[76:79], v[56:59], v[228:231], v[76:79]
ds_read_b64_tr_b16 v[106:107], v8 offset:44832
v_cmp_gt_u32 vcc, 2, v12
v_mfma_f32_16x16x32_bf16 v[80:83], v[60:63], v[224:227], v[80:83]
ds_read_b64_tr_b16 v[108:109], v8 offset:44096
v_cndmask_b32 v40, v40, v39, vcc
v_mfma_f32_16x16x32_bf16 v[84:87], v[60:63], v[228:231], v[84:87]
ds_read_b64_tr_b16 v[110:111], v8 offset:44864
v_add_u32 v39, 194, v17
s_waitcnt lgkmcnt(7)
v_mfma_f32_16x16x32_bf16 v[64:67], v[88:91], v[232:235], v[64:67]
ds_read_b64_tr_b16 v[52:53], v8 offset:56320
v_mfma_f32_16x16x32_bf16 v[68:71], v[88:91], v[236:239], v[68:71]
ds_read_b64_tr_b16 v[54:55], v8 offset:57088
v_cndmask_b32 v40, v40, v39, s[74:75]
v_mfma_f32_16x16x32_bf16 v[72:75], v[92:95], v[232:235], v[72:75]
ds_read_b64_tr_b16 v[56:57], v8 offset:56352
v_lshlrev_b32 v32, 4, v40
v_mfma_f32_16x16x32_bf16 v[76:79], v[92:95], v[236:239], v[76:79]
ds_read_b64_tr_b16 v[58:59], v8 offset:57120
v_add_u32 v32, 92416, v32
v_mfma_f32_16x16x32_bf16 v[80:83], v[96:99], v[232:235], v[80:83]
ds_read_b64_tr_b16 v[60:61], v8 offset:56384
v_lshlrev_b32 v36, 2, v40
v_mfma_f32_16x16x32_bf16 v[84:87], v[96:99], v[236:239], v[84:87]
ds_read_b64_tr_b16 v[62:63], v8 offset:57152
v_add_u32 v36, 96512, v36
s_waitcnt lgkmcnt(6)
v_mfma_f32_16x16x32_bf16 v[64:67], v[100:103], v[240:243], v[64:67]
v_mfma_f32_16x16x32_bf16 v[68:71], v[100:103], v[244:247], v[68:71]
v_and_b32 v11, 1, v11
v_mfma_f32_16x16x32_bf16 v[72:75], v[104:107], v[240:243], v[72:75]
v_lshl_add_u32 v12, v10, 1, v11
v_mfma_f32_16x16x32_bf16 v[76:79], v[104:107], v[244:247], v[76:79]
v_add3_u32 v40, v12, v18, 12
v_mfma_f32_16x16x32_bf16 v[80:83], v[108:111], v[240:243], v[80:83]
v_add_u32 v39, v10, v17
v_mfma_f32_16x16x32_bf16 v[84:87], v[108:111], v[244:247], v[84:87]
v_add_u32 v39, 62, v39
s_waitcnt lgkmcnt(0)
v_mfma_f32_16x16x32_bf16 v[64:67], v[52:55], v[248:251], v[64:67]
v_mfma_f32_16x16x32_bf16 v[68:71], v[52:55], v[252:255], v[68:71]
v_cmp_gt_u32 vcc, 2, v10
v_mfma_f32_16x16x32_bf16 v[72:75], v[56:59], v[248:251], v[72:75]
ds_add_u32 v13, v15
v_mfma_f32_16x16x32_bf16 v[76:79], v[56:59], v[252:255], v[76:79]
v_cndmask_b32 v40, v39, v40, vcc
v_mfma_f32_16x16x32_bf16 v[80:83], v[60:63], v[248:251], v[80:83]
v_lshlrev_b32 v31, 4, v40
v_mfma_f32_16x16x32_bf16 v[84:87], v[60:63], v[252:255], v[84:87]
v_add_u32 v31, 92416, v31
v_lshlrev_b32 v35, 2, v40
v_add_u32 v35, 96512, v35
v_add_u32 v40, 138, v10
v_add_u32 v39, 136, v12
v_cndmask_b32 v40, v39, v40, vcc
v_add_u32 v40, v40, v18
v_lshlrev_b32 v33, 4, v40
v_add_u32 v33, 92416, v33
v_lshlrev_b32 v37, 2, v40
v_add_u32 v37, 96512, v37
v_min_u32 v15, 1, v15
buffer_load_dword v205, v22, s[16:19], 0 offen sc1
v_cvt_pk_bf16_f32 v52, v64, v65
v_cvt_pk_bf16_f32 v53, v66, v67
v_cvt_pk_bf16_f32 v54, v72, v73
v_cvt_pk_bf16_f32 v55, v74, v75
v_cvt_pk_bf16_f32 v56, v80, v81
v_cvt_pk_bf16_f32 v57, v82, v83
v_cvt_pk_bf16_f32 v58, v68, v69
v_cvt_pk_bf16_f32 v59, v70, v71
v_cvt_pk_bf16_f32 v60, v76, v77
v_cvt_pk_bf16_f32 v61, v78, v79
v_cvt_pk_bf16_f32 v62, v84, v85
v_cvt_pk_bf16_f32 v63, v86, v87
v_lshlrev_b32 v19, 4, v0
v_add_u32 v19, 92416, v19
ds_read_b128 v[88:91], v19 offset:0
ds_read_b128 v[92:95], v19 offset:1024
ds_read_b128 v[96:99], v19 offset:2048
v_lshlrev_b32 v19, 4, v0
v_add_u32 v19, 92416, v19
ds_read_b128 v[192:195], v19 offset:3072
ds_read_b128 v[196:199], v19 offset:4096
ds_read_b128 v[200:203], v19 offset:5120
s_waitcnt lgkmcnt(0)
ds_add_u32 v13, v15
v_mfma_f32_16x16x32_bf16 v[64:67], v[88:91], v[52:55], 0
v_mfma_f32_16x16x32_bf16 v[68:71], v[92:95], v[52:55], 0
v_mfma_f32_16x16x32_bf16 v[72:75], v[96:99], v[52:55], 0
v_mfma_f32_16x16x32_bf16 v[76:79], v[88:91], v[58:61], 0
v_mfma_f32_16x16x32_bf16 v[80:83], v[92:95], v[58:61], 0
v_mfma_f32_16x16x32_bf16 v[84:87], v[96:99], v[58:61], 0
s_nop 2
v_max3_f32 v16, v64, v65, v66
v_max3_f32 v17, v67, v68, v69
v_max3_f32 v16, v16, v70, v71
v_max3_f32 v10, v76, v77, v78
v_max3_f32 v16, v16, v17, v72
v_max3_f32 v11, v79, v80, v81
v_mov_b32 v17, v16
v_max3_f32 v10, v10, v82, v83
s_nop 0
v_permlane16_swap_b32 v16, v17
v_max3_f32 v10, v10, v11, v84
v_max_f32 v16, v16, v17
v_mov_b32 v11, v10
v_mul_f32 v16, s83, v16
s_nop 0
v_permlane16_swap_b32 v10, v11
v_fma_f32 v64, v64, s82, v16
v_max_f32 v10, v10, v11
v_fma_f32 v65, v65, s82, v16
v_mul_f32 v10, s83, v10
v_fma_f32 v66, v66, s82, v16
v_fma_f32 v76, v76, s82, v10
v_fma_f32 v67, v67, s82, v16
v_fma_f32 v77, v77, s82, v10
v_fma_f32 v68, v68, s82, v16
v_fma_f32 v78, v78, s82, v10
v_fma_f32 v69, v69, s82, v16
v_fma_f32 v79, v79, s82, v10
v_fma_f32 v70, v70, s82, v16
v_fma_f32 v80, v80, s82, v10
v_fma_f32 v71, v71, s82, v16
v_fma_f32 v81, v81, s82, v10
v_fma_f32 v72, v72, s82, v16
v_fma_f32 v82, v82, s82, v10
v_exp_f32 v64, v64
v_fma_f32 v83, v83, s82, v10
v_exp_f32 v65, v65
v_fma_f32 v84, v84, s82, v10
v_exp_f32 v66, v66
v_exp_f32 v76, v76
v_exp_f32 v67, v67
v_exp_f32 v77, v77
v_exp_f32 v68, v68
v_exp_f32 v78, v78
v_exp_f32 v69, v69
v_exp_f32 v79, v79
v_exp_f32 v70, v70
v_exp_f32 v80, v80
v_exp_f32 v71, v71
v_exp_f32 v81, v81
v_exp_f32 v72, v72
v_exp_f32 v82, v82
v_add_f32 v18, v64, v65
v_exp_f32 v83, v83
v_add_f32 v17, v66, v67
v_exp_f32 v84, v84
v_add_f32 v18, v18, v68
v_add_f32 v12, v76, v77
v_add_f32 v17, v17, v69
v_add_f32 v11, v78, v79
v_add_f32 v18, v18, v70
v_add_f32 v12, v12, v80
v_add_f32 v17, v17, v71
v_add_f32 v11, v11, v81
v_add_f32 v18, v18, v72
v_add_f32 v12, v12, v82
v_add_f32 v18, v18, v17
v_add_f32 v11, v11, v83
v_mov_b32 v17, v18
v_add_f32 v12, v12, v84
s_nop 0
v_permlane16_swap_b32 v18, v17
v_add_f32 v12, v12, v11
v_add_f32 v18, v18, v17
v_mov_b32 v11, v12
v_rcp_f32 v18, v18
s_nop 0
v_permlane16_swap_b32 v12, v11
v_mul_f32 v64, v64, v18
v_add_f32 v12, v12, v11
v_mul_f32 v65, v65, v18
v_rcp_f32 v12, v12
v_mul_f32 v66, v66, v18
v_mul_f32 v76, v76, v12
v_mul_f32 v67, v67, v18
v_mul_f32 v77, v77, v12
v_mul_f32 v68, v68, v18
v_mul_f32 v78, v78, v12
v_mul_f32 v69, v69, v18
v_mul_f32 v79, v79, v12
v_mul_f32 v70, v70, v18
v_mul_f32 v80, v80, v12
v_mul_f32 v71, v71, v18
v_mul_f32 v81, v81, v12
v_mul_f32 v72, v72, v18
v_mul_f32 v82, v82, v12
v_cvt_pk_bf16_f32 v230, v64, v65
v_mul_f32 v83, v83, v12
v_cvt_pk_bf16_f32 v231, v66, v67
v_mul_f32 v84, v84, v12
v_cvt_pk_bf16_f32 v232, v68, v69
v_cvt_pk_bf16_f32 v236, v76, v77
v_cvt_pk_bf16_f32 v233, v70, v71
v_cvt_pk_bf16_f32 v237, v78, v79
v_cvt_pk_bf16_f32 v234, v72, 0
v_cvt_pk_bf16_f32 v238, v80, v81
v_mov_b32 v235, 0
v_cvt_pk_bf16_f32 v239, v82, v83
v_cvt_pk_bf16_f32 v240, v84, 0
v_mov_b32 v241, 0
s_waitcnt vmcnt(0)
v_cmp_ne_u32 vcc, s66, v205
s_mov_b32 s91, 1
s_cmp_eq_u64 vcc, 0
s_cbranch_scc1 kvh_78
s_mov_b32 s91, 0
buffer_load_dword v205, v22, s[16:19], 0 offen sc1
kvh_78:
s_bitcmp1_b32 s67, 0
s_cbranch_scc1 kvo_76
s_cmp_lg_u32 s91, 0
s_cbranch_scc0 kvsk_79
buffer_load_dwordx4 v[176:179], v23, s[16:19], s90 offen sc1
buffer_load_dwordx4 v[180:183], v23, s[16:19], s94 offen sc1
buffer_load_dwordx4 v[112:115], v6, s[16:19], s8 offen sc1
buffer_load_dwordx4 v[116:119], v6, s[16:19], s9 offen sc1
buffer_load_dwordx4 v[120:123], v6, s[16:19], s10 offen sc1
buffer_load_dwordx4 v[124:127], v6, s[16:19], s11 offen sc1
buffer_load_dwordx4 v[128:131], v6, s[16:19], s12 offen sc1
buffer_load_dwordx4 v[132:135], v6, s[16:19], s13 offen sc1
buffer_load_dwordx4 v[136:139], v6, s[16:19], s14 offen sc1
buffer_load_dwordx4 v[140:143], v6, s[16:19], s15 offen sc1
buffer_load_dwordx4 v[144:147], v6, s[16:19], s24 offen sc1
buffer_load_dwordx4 v[148:151], v6, s[16:19], s25 offen sc1
buffer_load_dwordx4 v[152:155], v6, s[16:19], s26 offen sc1
buffer_load_dwordx4 v[156:159], v6, s[16:19], s27 offen sc1
buffer_load_dwordx4 v[160:163], v6, s[16:19], s28 offen sc1
buffer_load_dwordx4 v[164:167], v6, s[16:19], s29 offen sc1
buffer_load_dwordx4 v[168:171], v6, s[16:19], s30 offen sc1
buffer_load_dwordx4 v[172:175], v6, s[16:19], s31 offen sc1
kvsk_79:
v_mfma_f32_16x16x32_bf16 v[64:67], v[192:195], v[54:57], 0
v_mfma_f32_16x16x32_bf16 v[68:71], v[196:199], v[54:57], 0
v_mfma_f32_16x16x32_bf16 v[72:75], v[200:203], v[54:57], 0
v_mfma_f32_16x16x32_bf16 v[76:79], v[192:195], v[60:63], 0
v_mfma_f32_16x16x32_bf16 v[80:83], v[196:199], v[60:63], 0
v_mfma_f32_16x16x32_bf16 v[84:87], v[200:203], v[60:63], 0
s_nop 2
v_max3_f32 v16, v64, v65, v66
v_max3_f32 v17, v67, v68, v69
v_max3_f32 v16, v16, v70, v71
v_max3_f32 v10, v76, v77, v78
v_max3_f32 v16, v16, v17, v72
v_max3_f32 v11, v79, v80, v81
v_mov_b32 v17, v16
v_max3_f32 v10, v10, v82, v83
s_nop 0
v_permlane16_swap_b32 v16, v17
v_max3_f32 v10, v10, v11, v84
v_max_f32 v16, v16, v17
v_mov_b32 v11, v10
v_mul_f32 v16, s83, v16
s_nop 0
v_permlane16_swap_b32 v10, v11
v_fma_f32 v64, v64, s82, v16
v_max_f32 v10, v10, v11
v_fma_f32 v65, v65, s82, v16
v_mul_f32 v10, s83, v10
v_fma_f32 v66, v66, s82, v16
v_fma_f32 v76, v76, s82, v10
v_fma_f32 v67, v67, s82, v16
v_fma_f32 v77, v77, s82, v10
v_fma_f32 v68, v68, s82, v16
v_fma_f32 v78, v78, s82, v10
v_fma_f32 v69, v69, s82, v16
v_fma_f32 v79, v79, s82, v10
v_fma_f32 v70, v70, s82, v16
v_fma_f32 v80, v80, s82, v10
v_fma_f32 v71, v71, s82, v16
v_fma_f32 v81, v81, s82, v10
v_fma_f32 v72, v72, s82, v16
v_fma_f32 v82, v82, s82, v10
v_exp_f32 v64, v64
v_fma_f32 v83, v83, s82, v10
v_exp_f32 v65, v65
v_fma_f32 v84, v84, s82, v10
v_exp_f32 v66, v66
v_exp_f32 v76, v76
v_exp_f32 v67, v67
v_exp_f32 v77, v77
v_exp_f32 v68, v68
v_exp_f32 v78, v78
v_exp_f32 v69, v69
v_exp_f32 v79, v79
v_exp_f32 v70, v70
v_exp_f32 v80, v80
v_exp_f32 v71, v71
v_exp_f32 v81, v81
v_exp_f32 v72, v72
v_exp_f32 v82, v82
v_add_f32 v18, v64, v65
v_exp_f32 v83, v83
v_add_f32 v17, v66, v67
v_exp_f32 v84, v84
v_add_f32 v18, v18, v68
v_add_f32 v12, v76, v77
v_add_f32 v17, v17, v69
v_add_f32 v11, v78, v79
v_add_f32 v18, v18, v70
v_add_f32 v12, v12, v80
v_add_f32 v17, v17, v71
v_add_f32 v11, v11, v81
v_add_f32 v18, v18, v72
v_add_f32 v12, v12, v82
v_add_f32 v18, v18, v17
v_add_f32 v11, v11, v83
v_mov_b32 v17, v18
v_add_f32 v12, v12, v84
s_nop 0
v_permlane16_swap_b32 v18, v17
v_add_f32 v12, v12, v11
v_add_f32 v18, v18, v17
v_mov_b32 v11, v12
v_rcp_f32 v18, v18
s_nop 0
v_permlane16_swap_b32 v12, v11
v_mul_f32 v64, v64, v18
v_add_f32 v12, v12, v11
v_mul_f32 v65, v65, v18
v_rcp_f32 v12, v12
v_mul_f32 v66, v66, v18
v_mul_f32 v76, v76, v12
v_mul_f32 v67, v67, v18
v_mul_f32 v77, v77, v12
v_mul_f32 v68, v68, v18
v_mul_f32 v78, v78, v12
v_mul_f32 v69, v69, v18
v_mul_f32 v79, v79, v12
v_mul_f32 v70, v70, v18
v_mul_f32 v80, v80, v12
v_mul_f32 v71, v71, v18
v_mul_f32 v81, v81, v12
v_mul_f32 v72, v72, v18
v_mul_f32 v82, v82, v12
v_cvt_pk_bf16_f32 v242, v64, v65
v_mul_f32 v83, v83, v12
v_cvt_pk_bf16_f32 v243, v66, v67
v_mul_f32 v84, v84, v12
v_cvt_pk_bf16_f32 v244, v68, v69
v_cvt_pk_bf16_f32 v248, v76, v77
v_cvt_pk_bf16_f32 v245, v70, v71
v_cvt_pk_bf16_f32 v249, v78, v79
v_cvt_pk_bf16_f32 v246, v72, 0
v_cvt_pk_bf16_f32 v250, v80, v81
v_mov_b32 v247, 0
v_cvt_pk_bf16_f32 v251, v82, v83
v_cvt_pk_bf16_f32 v252, v84, 0
v_mov_b32 v253, 0
s_cmp_lg_u32 s91, 0
s_cbranch_scc0 kvag_81
kvhave_80:
s_waitcnt lgkmcnt(0)
s_waitcnt vmcnt(16)
v_mfma_f32_16x16x32_bf16 v[72:75], v[24:27], v[176:179], 0
v_mfma_f32_16x16x32_bf16 v[72:75], v[24:27], v[180:183], v[72:75]
s_waitcnt vmcnt(15)
v_mfma_f32_16x16x32_bf16 v[64:67], v[48:51], v[112:115], 0
v_mfma_f32_16x16x32_bf16 v[68:71], v[46:49], v[112:115], 0
s_waitcnt vmcnt(14)
v_mfma_f32_16x16x32_bf16 v[64:67], v[48:51], v[116:119], v[64:67]
v_mfma_f32_16x16x32_bf16 v[68:71], v[46:49], v[116:119], v[68:71]
s_waitcnt vmcnt(13)
v_mfma_f32_16x16x32_bf16 v[64:67], v[48:51], v[120:123], v[64:67]
v_mfma_f32_16x16x32_bf16 v[68:71], v[46:49], v[120:123], v[68:71]
v_add_f32_dpp v12, v72, v72 row_ror:8 row_mask:0xf bank_mask:0xf
v_add_f32_dpp v13, v73, v73 row_ror:8 row_mask:0xf bank_mask:0xf
v_add_f32_dpp v14, v74, v74 row_ror:8 row_mask:0xf bank_mask:0xf
v_add_f32_dpp v15, v75, v75 row_ror:8 row_mask:0xf bank_mask:0xf
s_waitcnt vmcnt(12)
v_mfma_f32_16x16x32_bf16 v[64:67], v[48:51], v[124:127], v[64:67]
v_mfma_f32_16x16x32_bf16 v[68:71], v[46:49], v[124:127], v[68:71]
v_cvt_pk_bf16_f32 v12, v12, 0
v_cvt_pk_bf16_f32 v13, v13, 0
v_cvt_pk_bf16_f32 v14, v14, 0
v_cvt_pk_bf16_f32 v15, v15, 0
s_waitcnt vmcnt(11)
v_mfma_f32_16x16x32_bf16 v[64:67], v[48:51], v[128:131], v[64:67]
v_mfma_f32_16x16x32_bf16 v[68:71], v[46:49], v[128:131], v[68:71]
s_waitcnt vmcnt(10)
v_mfma_f32_16x16x32_bf16 v[64:67], v[48:51], v[132:135], v[64:67]
v_mfma_f32_16x16x32_bf16 v[68:71], v[46:49], v[132:135], v[68:71]
s_waitcnt vmcnt(9)
v_mfma_f32_16x16x32_bf16 v[64:67], v[48:51], v[136:139], v[64:67]
v_mfma_f32_16x16x32_bf16 v[68:71], v[46:49], v[136:139], v[68:71]
s_waitcnt vmcnt(8)
v_mfma_f32_16x16x32_bf16 v[64:67], v[48:51], v[140:143], v[64:67]
v_mfma_f32_16x16x32_bf16 v[68:71], v[46:49], v[140:143], v[68:71]
s_waitcnt vmcnt(7)
v_mfma_f32_16x16x32_bf16 v[64:67], v[48:51], v[144:147], v[64:67]
v_mfma_f32_16x16x32_bf16 v[68:71], v[46:49], v[144:147], v[68:71]
s_waitcnt vmcnt(6)
v_mfma_f32_16x16x32_bf16 v[64:67], v[48:51], v[148:151], v[64:67]
v_mfma_f32_16x16x32_bf16 v[68:71], v[46:49], v[148:151], v[68:71]
s_waitcnt vmcnt(5)
v_mfma_f32_16x16x32_bf16 v[64:67], v[48:51], v[152:155], v[64:67]
v_mfma_f32_16x16x32_bf16 v[68:71], v[46:49], v[152:155], v[68:71]
s_waitcnt vmcnt(4)
v_mfma_f32_16x16x32_bf16 v[64:67], v[48:51], v[156:159], v[64:67]
v_mfma_f32_16x16x32_bf16 v[68:71], v[46:49], v[156:159], v[68:71]
s_waitcnt vmcnt(3)
v_mfma_f32_16x16x32_bf16 v[64:67], v[48:51], v[160:163], v[64:67]
v_mfma_f32_16x16x32_bf16 v[68:71], v[46:49], v[160:163], v[68:71]
s_waitcnt vmcnt(2)
v_mfma_f32_16x16x32_bf16 v[64:67], v[48:51], v[164:167], v[64:67]
v_mfma_f32_16x16x32_bf16 v[68:71], v[46:49], v[164:167], v[68:71]
s_waitcnt vmcnt(1)
v_mfma_f32_16x16x32_bf16 v[64:67], v[48:51], v[168:171], v[64:67]
v_mfma_f32_16x16x32_bf16 v[68:71], v[46:49], v[168:171], v[68:71]
s_waitcnt vmcnt(0)
v_mfma_f32_16x16x32_bf16 v[64:67], v[48:51], v[172:175], v[64:67]
v_mfma_f32_16x16x32_bf16 v[68:71], v[46:49], v[172:175], v[68:71]
s_mov_b32 s75, 0
s_cmp_ge_u32 s75, 55
s_cbranch_scc1 ok_85
poll_86:
ds_read_b128 v[16:19], v45 offset:16
s_waitcnt lgkmcnt(0)
v_min_u32 v16, v16, v17
v_min3_u32 v16, v16, v18, v19
s_nop 0
v_readfirstlane_b32 s75, v16
s_cmp_ge_u32 s75, 55
s_cbranch_scc1 ok_85
s_sub_u32 s64, s64, 1
s_cbranch_scc0 poll_86
s_mov_b32 s64, 0
ok_85:
s_mov_b32 exec_lo, 0x00ff00ff
s_mov_b32 exec_hi, 0
ds_write_b128 v29, v[12:15]
s_mov_b64 exec, -1
v_cvt_pk_bf16_f32 v16, v64, v65
v_cvt_pk_bf16_f32 v17, v66, v67
v_cvt_pk_bf16_f32 v18, v68, v69
v_cvt_pk_bf16_f32 v19, v70, v71
ds_write_b128 v28, v[16:19]
s_branch kvd_77
kvo_76:
s_cmp_lg_u32 s91, 0
s_cbranch_scc0 kvsk_87
buffer_load_dwordx4 v[112:115], v23, s[16:19], s8 offen sc1
buffer_load_dwordx4 v[116:119], v23, s[16:19], s12 offen sc1
buffer_load_dwordx4 v[120:123], v23, s[16:19], s24 offen sc1
buffer_load_dwordx4 v[124:127], v23, s[16:19], s28 offen sc1
kvsk_87:
v_mfma_f32_16x16x32_bf16 v[64:67], v[192:195], v[54:57], 0
v_mfma_f32_16x16x32_bf16 v[68:71], v[196:199], v[54:57], 0
v_mfma_f32_16x16x32_bf16 v[72:75], v[200:203], v[54:57], 0
v_mfma_f32_16x16x32_bf16 v[76:79], v[192:195], v[60:63], 0
v_mfma_f32_16x16x32_bf16 v[80:83], v[196:199], v[60:63], 0
v_mfma_f32_16x16x32_bf16 v[84:87], v[200:203], v[60:63], 0
s_nop 2
v_max3_f32 v16, v64, v65, v66
v_max3_f32 v17, v67, v68, v69
v_max3_f32 v16, v16, v70, v71
v_max3_f32 v10, v76, v77, v78
v_max3_f32 v16, v16, v17, v72
v_max3_f32 v11, v79, v80, v81
v_mov_b32 v17, v16
v_max3_f32 v10, v10, v82, v83
s_nop 0
v_permlane16_swap_b32 v16, v17
v_max3_f32 v10, v10, v11, v84
v_max_f32 v16, v16, v17
v_mov_b32 v11, v10
v_mul_f32 v16, s83, v16
s_nop 0
v_permlane16_swap_b32 v10, v11
v_fma_f32 v64, v64, s82, v16
v_max_f32 v10, v10, v11
v_fma_f32 v65, v65, s82, v16
v_mul_f32 v10, s83, v10
v_fma_f32 v66, v66, s82, v16
v_fma_f32 v76, v76, s82, v10
v_fma_f32 v67, v67, s82, v16
v_fma_f32 v77, v77, s82, v10
v_fma_f32 v68, v68, s82, v16
v_fma_f32 v78, v78, s82, v10
v_fma_f32 v69, v69, s82, v16
v_fma_f32 v79, v79, s82, v10
v_fma_f32 v70, v70, s82, v16
v_fma_f32 v80, v80, s82, v10
v_fma_f32 v71, v71, s82, v16
v_fma_f32 v81, v81, s82, v10
v_fma_f32 v72, v72, s82, v16
v_fma_f32 v82, v82, s82, v10
v_exp_f32 v64, v64
v_fma_f32 v83, v83, s82, v10
v_exp_f32 v65, v65
v_fma_f32 v84, v84, s82, v10
v_exp_f32 v66, v66
v_exp_f32 v76, v76
v_exp_f32 v67, v67
v_exp_f32 v77, v77
v_exp_f32 v68, v68
v_exp_f32 v78, v78
v_exp_f32 v69, v69
v_exp_f32 v79, v79
v_exp_f32 v70, v70
v_exp_f32 v80, v80
v_exp_f32 v71, v71
v_exp_f32 v81, v81
v_exp_f32 v72, v72
v_exp_f32 v82, v82
v_add_f32 v18, v64, v65
v_exp_f32 v83, v83
v_add_f32 v17, v66, v67
v_exp_f32 v84, v84
v_add_f32 v18, v18, v68
v_add_f32 v12, v76, v77
v_add_f32 v17, v17, v69
v_add_f32 v11, v78, v79
v_add_f32 v18, v18, v70
v_add_f32 v12, v12, v80
v_add_f32 v17, v17, v71
v_add_f32 v11, v11, v81
v_add_f32 v18, v18, v72
v_add_f32 v12, v12, v82
v_add_f32 v18, v18, v17
v_add_f32 v11, v11, v83
v_mov_b32 v17, v18
v_add_f32 v12, v12, v84
s_nop 0
v_permlane16_swap_b32 v18, v17
v_add_f32 v12, v12, v11
v_add_f32 v18, v18, v17
v_mov_b32 v11, v12
v_rcp_f32 v18, v18
s_nop 0
v_permlane16_swap_b32 v12, v11
v_mul_f32 v64, v64, v18
v_add_f32 v12, v12, v11
v_mul_f32 v65, v65, v18
v_rcp_f32 v12, v12
v_mul_f32 v66, v66, v18
v_mul_f32 v76, v76, v12
v_mul_f32 v67, v67, v18
v_mul_f32 v77, v77, v12
v_mul_f32 v68, v68, v18
v_mul_f32 v78, v78, v12
v_mul_f32 v69, v69, v18
v_mul_f32 v79, v79, v12
v_mul_f32 v70, v70, v18
v_mul_f32 v80, v80, v12
v_mul_f32 v71, v71, v18
v_mul_f32 v81, v81, v12
v_mul_f32 v72, v72, v18
v_mul_f32 v82, v82, v12
v_cvt_pk_bf16_f32 v242, v64, v65
v_mul_f32 v83, v83, v12
v_cvt_pk_bf16_f32 v243, v66, v67
v_mul_f32 v84, v84, v12
v_cvt_pk_bf16_f32 v244, v68, v69
v_cvt_pk_bf16_f32 v248, v76, v77
v_cvt_pk_bf16_f32 v245, v70, v71
v_cvt_pk_bf16_f32 v249, v78, v79
v_cvt_pk_bf16_f32 v246, v72, 0
v_cvt_pk_bf16_f32 v250, v80, v81
v_mov_b32 v247, 0
v_cvt_pk_bf16_f32 v251, v82, v83
v_cvt_pk_bf16_f32 v252, v84, 0
v_mov_b32 v253, 0
s_cmp_lg_u32 s91, 0
s_cbranch_scc0 kvag_89
kvhave_88:
s_waitcnt lgkmcnt(0)
s_waitcnt vmcnt(3)
v_mfma_f32_16x16x32_bf16 v[64:67], v[24:27], v[112:115], 0
s_waitcnt vmcnt(2)
v_mfma_f32_16x16x32_bf16 v[64:67], v[24:27], v[116:119], v[64:67]
s_waitcnt vmcnt(1)
v_mfma_f32_16x16x32_bf16 v[64:67], v[24:27], v[120:123], v[64:67]
s_waitcnt vmcnt(0)
v_mfma_f32_16x16x32_bf16 v[64:67], v[24:27], v[124:127], v[64:67]
s_mov_b32 s75, 0
s_cmp_ge_u32 s75, 55
s_cbranch_scc1 ok_93
poll_94:
ds_read_b128 v[16:19], v45 offset:16
s_waitcnt lgkmcnt(0)
v_min_u32 v16, v16, v17
v_min3_u32 v16, v16, v18, v19
s_nop 0
v_readfirstlane_b32 s75, v16
s_cmp_ge_u32 s75, 55
s_cbranch_scc1 ok_93
s_sub_u32 s64, s64, 1
s_cbranch_scc0 poll_94
s_mov_b32 s64, 0
ok_93:
v_cvt_pk_bf16_f32 v16, v64, v65
v_cvt_pk_bf16_f32 v17, v66, v67
v_cvt_pk_bf16_f32 v12, v64, 0
v_cvt_pk_bf16_f32 v13, v65, 0
v_cvt_pk_bf16_f32 v14, v66, 0
v_cvt_pk_bf16_f32 v15, v67, 0
s_mov_b32 exec_hi, 0
s_mov_b32 exec_lo, 0x0fff0fff
ds_write_b64 v28, v[16:17]
s_mov_b32 exec_lo, 0x30003000
ds_write_b128 v29, v[12:15]
s_mov_b64 exec, -1
kvd_77:
s_waitcnt lgkmcnt(0)
v_mov_b32 v16, 2
ds_write_b32 v3, v16 offset:32
s_mov_b32 s68, 0
s_cmp_ge_u32 s68, 2
s_cbranch_scc1 ok_95
poll_96:
ds_read_b128 v[16:19], v45 offset:32
s_waitcnt lgkmcnt(0)
v_min_u32 v16, v16, v17
v_min3_u32 v16, v16, v18, v19
s_nop 0
v_readfirstlane_b32 s68, v16
s_cmp_ge_u32 s68, 2
s_cbranch_scc1 ok_95
s_sub_u32 s64, s64, 1
s_cbranch_scc0 poll_96
s_mov_b32 s64, 0
ok_95:
ds_read_b128 v[88:91], v30
ds_read_b32 v64, v34
ds_read_b128 v[92:95], v31
ds_read_b32 v68, v35
ds_read_b128 v[96:99], v32
ds_read_b32 v72, v36
ds_read_b128 v[100:103], v33
ds_read_b32 v76, v37
v_mov_b32 v65, 0
v_mov_b32 v66, 0
v_mov_b32 v67, 0
v_mov_b32 v69, 0
v_mov_b32 v70, 0
v_mov_b32 v71, 0
v_mov_b32 v73, 0
v_mov_b32 v74, 0
v_mov_b32 v75, 0
v_mov_b32 v77, 0
v_mov_b32 v78, 0
v_mov_b32 v79, 0
s_waitcnt lgkmcnt(0)
v_mfma_f32_16x16x32_bf16 v[112:115], v[88:91], v[230:233], 0
v_mfma_f32_16x16x32_bf16 v[112:115], v[64:67], v[234:237], v[112:115]
v_mfma_f32_16x16x32_bf16 v[120:123], v[92:95], v[230:233], 0
v_mfma_f32_16x16x32_bf16 v[120:123], v[68:71], v[234:237], v[120:123]
v_mfma_f32_16x16x32_bf16 v[116:119], v[88:91], v[236:239], 0
v_mfma_f32_16x16x32_bf16 v[116:119], v[64:67], v[240:243], v[116:119]
v_mfma_f32_16x16x32_bf16 v[124:127], v[92:95], v[236:239], 0
v_mfma_f32_16x16x32_bf16 v[124:127], v[68:71], v[240:243], v[124:127]
v_mfma_f32_16x16x32_bf16 v[128:131], v[96:99], v[242:245], 0
v_mfma_f32_16x16x32_bf16 v[128:131], v[72:75], v[246:249], v[128:131]
v_mfma_f32_16x16x32_bf16 v[136:139], v[100:103], v[242:245], 0
v_mfma_f32_16x16x32_bf16 v[136:139], v[76:79], v[246:249], v[136:139]
v_mfma_f32_16x16x32_bf16 v[132:135], v[96:99], v[248:251], 0
v_mfma_f32_16x16x32_bf16 v[132:135], v[72:75], v[252:255], v[132:135]
v_mfma_f32_16x16x32_bf16 v[140:143], v[100:103], v[248:251], 0
v_mfma_f32_16x16x32_bf16 v[140:143], v[76:79], v[252:255], v[140:143]
v_add_f32 v10, 0x358637bd, v115
v_rcp_f32 v10, v10
s_nop 0
v_mul_f32 v112, v112, v10
v_mul_f32 v113, v113, v10
v_mul_f32 v114, v114, v10
v_mul_f32 v120, v120, v10
v_mul_f32 v121, v121, v10
v_add_f32 v11, 0x358637bd, v131
v_rcp_f32 v11, v11
s_nop 0
v_mul_f32 v128, v128, v11
v_mul_f32 v129, v129, v11
v_mul_f32 v130, v130, v11
v_mul_f32 v136, v136, v11
v_mul_f32 v137, v137, v11
v_cvt_pk_bf16_f32 v104, v112, v113
v_cvt_pk_bf16_f32 v105, v114, v120
v_cvt_pk_bf16_f32 v106, v128, v129
v_cvt_pk_bf16_f32 v107, v130, v136
v_add_f32 v10, 0x358637bd, v119
v_rcp_f32 v10, v10
s_nop 0
v_mul_f32 v116, v116, v10
v_mul_f32 v117, v117, v10
v_mul_f32 v118, v118, v10
v_mul_f32 v124, v124, v10
v_mul_f32 v125, v125, v10
v_add_f32 v11, 0x358637bd, v135
v_rcp_f32 v11, v11
s_nop 0
v_mul_f32 v132, v132, v11
v_mul_f32 v133, v133, v11
v_mul_f32 v134, v134, v11
v_mul_f32 v140, v140, v11
v_mul_f32 v141, v141, v11
v_cvt_pk_bf16_f32 v108, v116, v117
v_cvt_pk_bf16_f32 v109, v118, v124
v_cvt_pk_bf16_f32 v110, v132, v133
v_cvt_pk_bf16_f32 v111, v134, v140
v_cmp_gt_u32 vcc, 2, v2
s_nop 1
v_cndmask_b32 v12, v137, v121, vcc
v_cndmask_b32 v13, v141, v125, vcc
v_cvt_pk_bf16_f32 v12, v12, v13
v_mov_b32 v13, v12
v_and_b32 v14, 1, v2
s_nop 0
v_permlane16_swap_b32 v12, v13
v_cmp_eq_u32 vcc, 1, v14
v_mov_b32 v15, s85
v_mov_b32 v16, s86
v_cndmask_b32 v15, v15, v16, vcc
v_perm_b32 v12, v13, v12, v15
s_lshl_b32 s72, s4, 2
s_add_u32 s72, s72, s3
s_lshl_b32 s73, s72, 4
s_add_u32 s73, s73, s5
s_lshl_b32 s74, s73, 11
s_add_u32 s74, s74, 0x200000
s_lshl_b32 s75, s73, 8
s_add_u32 s75, s75, 0x400000
v_lshlrev_b32 v10, 4, v0
v_lshlrev_b32 v11, 7, v14
v_lshl_add_u32 v11, v1, 3, v11
v_lshrrev_b32 v14, 1, v2
v_lshl_add_u32 v11, v14, 2, v11
buffer_store_dwordx4 v[104:107], v10, s[16:19], s74 offen offset:0 sc1
buffer_store_dwordx4 v[108:111], v10, s[16:19], s74 offen offset:1024 sc1
buffer_store_dword v12, v11, s[16:19], s75 offen sc1
s_lshl_b32 s74, s73, 7
s_add_u32 s74, s74, 0xc40000
v_mov_b32 v17, s74
s_waitcnt vmcnt(0)
v_mov_b32 v16, s66
s_mov_b64 exec, 1
buffer_store_dword v16, v17, s[16:19], 0 offen sc1
s_mov_b64 exec, -1
v_mov_b32 v18, 0
v_mov_b32 v19, 1
s_mov_b64 exec, 1
ds_add_u32 v18, v19 offset:96
s_mov_b64 exec, -1
s_and_b32 s72, s5, 1
s_lshl_b32 s72, s72, 1
s_lshr_b32 s73, s3, 1
s_add_u32 s84, s72, s73
s_lshl_b32 s72, s4, 2
s_add_u32 s72, s72, s84
s_lshl_b32 s73, s72, 11
s_add_u32 s73, s73, 0xc40000
v_lshlrev_b32 v12, 7, v0
v_add_u32 v12, s73, v12
s_and_b32 s75, s3, 1
s_lshl_b32 s73, s72, 15
s_lshl_b32 s74, s75, 10
s_add_u32 s73, s73, s74
s_add_u32 s73, s73, 0x200000
v_add_u32 v14, s73, v10
s_lshl_b32 s74, s72, 12
s_add_u32 s74, s74, 0x400000
s_lshl_b32 s73, s75, 7
s_add_u32 s74, s74, s73
v_lshlrev_b32 v16, 3, v1
v_add_u32 v16, s74, v16
v_lshl_add_u32 v17, v2, 1, s99
v_and_b32 v17, 15, v17
v_lshlrev_b32 v17, 8, v17
v_add_u32 v206, v16, v17
v_xor_b32 v17, 2048, v17
v_add_u32 v208, v16, v17
v_lshl_add_u32 v17, v2, 1, s99
v_add_u32 v17, 1, v17
v_and_b32 v17, 15, v17
v_lshlrev_b32 v17, 8, v17
v_add_u32 v207, v16, v17
v_xor_b32 v17, 2048, v17
v_add_u32 v209, v16, v17
v_lshrrev_b32 v16, 1, v2
v_lshlrev_b32 v16, 4, v16
v_and_b32 v17, 1, v2
v_lshlrev_b32 v17, 2, v17
v_add_u32 v16, v16, v17
v_lshrrev_b32 v17, 2, v1
v_add_u32 v16, v16, v17
v_mul_u32_u24 v16, 160, v16
v_and_b32 v17, 3, v1
v_lshlrev_b32 v17, 3, v17
v_add_u32 v16, v16, v17
v_add_u32 v8, 256, v16
v_lshlrev_b32 v8, 4, v0
v_add_u32 v8, 256, v8
v_add_u32 v9, 46080, v8
s_lshl_b32 s72, s4, 7
s_lshl_b32 s73, s84, 5
s_add_u32 s72, s72, s73
s_lshl_b32 s73, s75, 4
s_add_u32 s72, s72, s73
s_mul_i32 s72, s72, 2304
s_lshr_b32 s73, s5, 1
s_mul_i32 s73, s73, 144
s_add_u32 s90, s72, s73
v_mul_u32_u24 v6, 2304, v1
v_and_b32 v16, 1, v2
v_lshlrev_b32 v16, 5, v16
v_lshrrev_b32 v17, 1, v2
v_lshlrev_b32 v17, 4, v17
v_add3_u32 v7, v6, v16, v17
v_lshlrev_b32 v16, 3, v2
v_add_u32 v6, v6, v16
s_add_u32 s8, s99, 0
s_and_b32 s8, s8, 15
s_lshl_b32 s8, s8, 11
s_add_u32 s9, s99, 1
s_and_b32 s9, s9, 15
s_lshl_b32 s9, s9, 11
s_add_u32 s10, s99, 2
s_and_b32 s10, s10, 15
s_lshl_b32 s10, s10, 11
s_add_u32 s11, s99, 3
s_and_b32 s11, s11, 15
s_lshl_b32 s11, s11, 11
s_add_u32 s12, s99, 4
s_and_b32 s12, s12, 15
s_lshl_b32 s12, s12, 11
s_add_u32 s13, s99, 5
s_and_b32 s13, s13, 15
s_lshl_b32 s13, s13, 11
s_add_u32 s14, s99, 6
s_and_b32 s14, s14, 15
s_lshl_b32 s14, s14, 11
s_add_u32 s15, s99, 7
s_and_b32 s15, s15, 15
s_lshl_b32 s15, s15, 11
s_add_u32 s24, s99, 8
s_and_b32 s24, s24, 15
s_lshl_b32 s24, s24, 11
s_add_u32 s25, s99, 9
s_and_b32 s25, s25, 15
s_lshl_b32 s25, s25, 11
s_add_u32 s26, s99, 10
s_and_b32 s26, s26, 15
s_lshl_b32 s26, s26, 11
s_add_u32 s27, s99, 11
s_and_b32 s27, s27, 15
s_lshl_b32 s27, s27, 11
s_add_u32 s28, s99, 12
s_and_b32 s28, s28, 15
s_lshl_b32 s28, s28, 11
s_add_u32 s29, s99, 13
s_and_b32 s29, s29, 15
s_lshl_b32 s29, s29, 11
s_add_u32 s30, s99, 14
s_and_b32 s30, s30, 15
s_lshl_b32 s30, s30, 11
s_add_u32 s31, s99, 15
s_and_b32 s31, s31, 15
s_lshl_b32 s31, s31, 11
s_sleep 18
s_mov_b64 s[70:71], exec
s_mov_b64 exec, 0xffff
poll_98:
buffer_load_dword v13, v12, s[16:19], 0 offen sc1
s_waitcnt vmcnt(0)
v_cmp_ne_u32 vcc, s66, v13
s_cmp_eq_u64 vcc, 0
s_cbranch_scc1 ok_97
s_sleep 2
s_sub_u32 s64, s64, 64
s_cbranch_scc0 poll_98
s_mov_b32 s64, 0
ok_97:
s_mov_b64 exec, s[70:71]
buffer_load_dwordx4 v[112:115], v14, s[16:19], s8 offen sc1
buffer_load_dwordx4 v[116:119], v14, s[16:19], s9 offen sc1
buffer_load_dwordx4 v[120:123], v14, s[16:19], s10 offen sc1
buffer_load_dwordx4 v[124:127], v14, s[16:19], s11 offen sc1
buffer_load_dwordx4 v[128:131], v14, s[16:19], s12 offen sc1
buffer_load_dwordx4 v[132:135], v14, s[16:19], s13 offen sc1
buffer_load_dwordx4 v[136:139], v14, s[16:19], s14 offen sc1
buffer_load_dwordx4 v[140:143], v14, s[16:19], s15 offen sc1
buffer_load_dwordx4 v[144:147], v14, s[16:19], s24 offen sc1
buffer_load_dwordx4 v[148:151], v14, s[16:19], s25 offen sc1
buffer_load_dwordx4 v[152:155], v14, s[16:19], s26 offen sc1
buffer_load_dwordx4 v[156:159], v14, s[16:19], s27 offen sc1
buffer_load_dwordx4 v[160:163], v14, s[16:19], s28 offen sc1
buffer_load_dwordx4 v[164:167], v14, s[16:19], s29 offen sc1
buffer_load_dwordx4 v[168:171], v14, s[16:19], s30 offen sc1
buffer_load_dwordx4 v[172:175], v14, s[16:19], s31 offen sc1
s_mov_b32 s75, 0
s_cmp_ge_u32 s75, 300
s_cbranch_scc1 ok_102
poll_103:
ds_read_b32 v13, v45 offset:0
s_waitcnt lgkmcnt(0)
v_readfirstlane_b32 s75, v13
s_cmp_ge_u32 s75, 300
s_cbranch_scc1 ok_102
s_sub_u32 s64, s64, 1
s_cbranch_scc0 poll_103
s_mov_b32 s64, 0
ok_102:
ds_read_b128 v[64:67], v8 offset:0
ds_read_b128 v[68:71], v8 offset:1024
ds_read_b128 v[72:75], v8 offset:2048
ds_read_b128 v[76:79], v8 offset:3072
ds_read_b128 v[80:83], v8 offset:4096
ds_read_b128 v[84:87], v8 offset:5120
ds_read_b128 v[88:91], v8 offset:6144
ds_read_b128 v[92:95], v8 offset:7168
ds_read_b128 v[96:99], v8 offset:8192
ds_read_b128 v[100:103], v8 offset:9216
s_waitcnt vmcnt(15) lgkmcnt(5)
v_mfma_f32_16x16x32_bf16 v[20:23], v[64:67], v[112:115], 0
ds_read_b128 v[40:43], v8 offset:10240
v_mfma_f32_16x16x32_bf16 v[24:27], v[68:71], v[112:115], 0
ds_read_b128 v[44:47], v8 offset:11264
v_mfma_f32_16x16x32_bf16 v[28:31], v[72:75], v[112:115], 0
ds_read_b128 v[48:51], v8 offset:12288
buffer_load_dwordx2 v[176:177], v206, s[16:19], 0 offen sc1
v_mfma_f32_16x16x32_bf16 v[32:35], v[76:79], v[112:115], 0
ds_read_b128 v[52:55], v8 offset:13312
v_mfma_f32_16x16x32_bf16 v[36:39], v[80:83], v[112:115], 0
ds_read_b128 v[56:59], v8 offset:14336
s_waitcnt vmcnt(15) lgkmcnt(5)
v_mfma_f32_16x16x32_bf16 v[20:23], v[84:87], v[116:119], v[20:23]
ds_read_b128 v[64:67], v8 offset:15360
v_mfma_f32_16x16x32_bf16 v[24:27], v[88:91], v[116:119], v[24:27]
ds_read_b128 v[68:71], v8 offset:16384
v_mfma_f32_16x16x32_bf16 v[28:31], v[92:95], v[116:119], v[28:31]
ds_read_b128 v[72:75], v8 offset:17408
buffer_load_dwordx2 v[178:179], v207, s[16:19], 0 offen sc1
v_mfma_f32_16x16x32_bf16 v[32:35], v[96:99], v[116:119], v[32:35]
ds_read_b128 v[76:79], v8 offset:18432
v_mfma_f32_16x16x32_bf16 v[36:39], v[100:103], v[116:119], v[36:39]
ds_read_b128 v[80:83], v8 offset:19456
s_waitcnt vmcnt(15) lgkmcnt(5)
v_mfma_f32_16x16x32_bf16 v[20:23], v[40:43], v[120:123], v[20:23]
ds_read_b128 v[84:87], v8 offset:20480
v_mfma_f32_16x16x32_bf16 v[24:27], v[44:47], v[120:123], v[24:27]
ds_read_b128 v[88:91], v8 offset:21504
v_mfma_f32_16x16x32_bf16 v[28:31], v[48:51], v[120:123], v[28:31]
ds_read_b128 v[92:95], v8 offset:22528
buffer_load_dwordx2 v[180:181], v208, s[16:19], 0 offen sc1
v_mfma_f32_16x16x32_bf16 v[32:35], v[52:55], v[120:123], v[32:35]
ds_read_b128 v[96:99], v8 offset:23552
v_mfma_f32_16x16x32_bf16 v[36:39], v[56:59], v[120:123], v[36:39]
ds_read_b128 v[100:103], v8 offset:24576
s_waitcnt vmcnt(15) lgkmcnt(5)
v_mfma_f32_16x16x32_bf16 v[20:23], v[64:67], v[124:127], v[20:23]
ds_read_b128 v[40:43], v8 offset:25600
v_mfma_f32_16x16x32_bf16 v[24:27], v[68:71], v[124:127], v[24:27]
ds_read_b128 v[44:47], v8 offset:26624
v_mfma_f32_16x16x32_bf16 v[28:31], v[72:75], v[124:127], v[28:31]
ds_read_b128 v[48:51], v8 offset:27648
buffer_load_dwordx2 v[182:183], v209, s[16:19], 0 offen sc1
v_mfma_f32_16x16x32_bf16 v[32:35], v[76:79], v[124:127], v[32:35]
ds_read_b128 v[52:55], v8 offset:28672
v_mfma_f32_16x16x32_bf16 v[36:39], v[80:83], v[124:127], v[36:39]
ds_read_b128 v[56:59], v8 offset:29696
s_waitcnt vmcnt(15) lgkmcnt(5)
v_mfma_f32_16x16x32_bf16 v[20:23], v[84:87], v[128:131], v[20:23]
ds_read_b128 v[64:67], v8 offset:30720
v_mfma_f32_16x16x32_bf16 v[24:27], v[88:91], v[128:131], v[24:27]
ds_read_b128 v[68:71], v8 offset:31744
v_mfma_f32_16x16x32_bf16 v[28:31], v[92:95], v[128:131], v[28:31]
ds_read_b128 v[72:75], v8 offset:32768
v_mfma_f32_16x16x32_bf16 v[32:35], v[96:99], v[128:131], v[32:35]
ds_read_b128 v[76:79], v8 offset:33792
v_mfma_f32_16x16x32_bf16 v[36:39], v[100:103], v[128:131], v[36:39]
ds_read_b128 v[80:83], v8 offset:34816
s_waitcnt vmcnt(14) lgkmcnt(5)
v_mfma_f32_16x16x32_bf16 v[20:23], v[40:43], v[132:135], v[20:23]
ds_read_b128 v[84:87], v8 offset:35840
v_mfma_f32_16x16x32_bf16 v[24:27], v[44:47], v[132:135], v[24:27]
ds_read_b128 v[88:91], v8 offset:36864
v_mfma_f32_16x16x32_bf16 v[28:31], v[48:51], v[132:135], v[28:31]
ds_read_b128 v[92:95], v8 offset:37888
v_mfma_f32_16x16x32_bf16 v[32:35], v[52:55], v[132:135], v[32:35]
ds_read_b128 v[96:99], v8 offset:38912
v_mfma_f32_16x16x32_bf16 v[36:39], v[56:59], v[132:135], v[36:39]
ds_read_b128 v[100:103], v8 offset:39936
s_waitcnt vmcnt(13) lgkmcnt(5)
v_mfma_f32_16x16x32_bf16 v[20:23], v[64:67], v[136:139], v[20:23]
ds_read_b128 v[40:43], v8 offset:40960
v_mfma_f32_16x16x32_bf16 v[24:27], v[68:71], v[136:139], v[24:27]
ds_read_b128 v[44:47], v8 offset:41984
v_mfma_f32_16x16x32_bf16 v[28:31], v[72:75], v[136:139], v[28:31]
ds_read_b128 v[48:51], v8 offset:43008
v_mfma_f32_16x16x32_bf16 v[32:35], v[76:79], v[136:139], v[32:35]
ds_read_b128 v[52:55], v8 offset:44032
v_mfma_f32_16x16x32_bf16 v[36:39], v[80:83], v[136:139], v[36:39]
ds_read_b128 v[56:59], v8 offset:45056
s_waitcnt vmcnt(12) lgkmcnt(5)
v_mfma_f32_16x16x32_bf16 v[20:23], v[84:87], v[140:143], v[20:23]
ds_read_b128 v[64:67], v9 offset:0
v_mfma_f32_16x16x32_bf16 v[24:27], v[88:91], v[140:143], v[24:27]
ds_read_b128 v[68:71], v9 offset:1024
v_mfma_f32_16x16x32_bf16 v[28:31], v[92:95], v[140:143], v[28:31]
ds_read_b128 v[72:75], v9 offset:2048
v_mfma_f32_16x16x32_bf16 v[32:35], v[96:99], v[140:143], v[32:35]
ds_read_b128 v[76:79], v9 offset:3072
v_mfma_f32_16x16x32_bf16 v[36:39], v[100:103], v[140:143], v[36:39]
ds_read_b128 v[80:83], v9 offset:4096
s_waitcnt vmcnt(11) lgkmcnt(5)
v_mfma_f32_16x16x32_bf16 v[20:23], v[40:43], v[144:147], v[20:23]
ds_read_b128 v[84:87], v9 offset:5120
v_mfma_f32_16x16x32_bf16 v[24:27], v[44:47], v[144:147], v[24:27]
ds_read_b128 v[88:91], v9 offset:6144
v_mfma_f32_16x16x32_bf16 v[28:31], v[48:51], v[144:147], v[28:31]
ds_read_b128 v[92:95], v9 offset:7168
v_mfma_f32_16x16x32_bf16 v[32:35], v[52:55], v[144:147], v[32:35]
ds_read_b128 v[96:99], v9 offset:8192
v_mfma_f32_16x16x32_bf16 v[36:39], v[56:59], v[144:147], v[36:39]
ds_read_b128 v[100:103], v9 offset:9216
s_waitcnt vmcnt(10) lgkmcnt(5)
v_mfma_f32_16x16x32_bf16 v[20:23], v[64:67], v[148:151], v[20:23]
ds_read_b128 v[40:43], v9 offset:10240
v_mfma_f32_16x16x32_bf16 v[24:27], v[68:71], v[148:151], v[24:27]
ds_read_b128 v[44:47], v9 offset:11264
v_mfma_f32_16x16x32_bf16 v[28:31], v[72:75], v[148:151], v[28:31]
ds_read_b128 v[48:51], v9 offset:12288
v_mfma_f32_16x16x32_bf16 v[32:35], v[76:79], v[148:151], v[32:35]
ds_read_b128 v[52:55], v9 offset:13312
v_mfma_f32_16x16x32_bf16 v[36:39], v[80:83], v[148:151], v[36:39]
ds_read_b128 v[56:59], v9 offset:14336
s_waitcnt vmcnt(9) lgkmcnt(5)
v_mfma_f32_16x16x32_bf16 v[20:23], v[84:87], v[152:155], v[20:23]
ds_read_b128 v[64:67], v9 offset:15360
v_mfma_f32_16x16x32_bf16 v[24:27], v[88:91], v[152:155], v[24:27]
ds_read_b128 v[68:71], v9 offset:16384
v_mfma_f32_16x16x32_bf16 v[28:31], v[92:95], v[152:155], v[28:31]
ds_read_b128 v[72:75], v9 offset:17408
v_mfma_f32_16x16x32_bf16 v[32:35], v[96:99], v[152:155], v[32:35]
ds_read_b128 v[76:79], v9 offset:18432
v_mfma_f32_16x16x32_bf16 v[36:39], v[100:103], v[152:155], v[36:39]
ds_read_b128 v[80:83], v9 offset:19456
s_waitcnt vmcnt(8) lgkmcnt(5)
v_mfma_f32_16x16x32_bf16 v[20:23], v[40:43], v[156:159], v[20:23]
ds_read_b128 v[84:87], v9 offset:20480
v_mfma_f32_16x16x32_bf16 v[24:27], v[44:47], v[156:159], v[24:27]
ds_read_b128 v[88:91], v9 offset:21504
v_mfma_f32_16x16x32_bf16 v[28:31], v[48:51], v[156:159], v[28:31]
ds_read_b128 v[92:95], v9 offset:22528
v_mfma_f32_16x16x32_bf16 v[32:35], v[52:55], v[156:159], v[32:35]
ds_read_b128 v[96:99], v9 offset:23552
v_mfma_f32_16x16x32_bf16 v[36:39], v[56:59], v[156:159], v[36:39]
ds_read_b128 v[100:103], v9 offset:24576
s_waitcnt vmcnt(7) lgkmcnt(5)
v_mfma_f32_16x16x32_bf16 v[20:23], v[64:67], v[160:163], v[20:23]
ds_read_b128 v[40:43], v9 offset:25600
v_mfma_f32_16x16x32_bf16 v[24:27], v[68:71], v[160:163], v[24:27]
ds_read_b128 v[44:47], v9 offset:26624
v_mfma_f32_16x16x32_bf16 v[28:31], v[72:75], v[160:163], v[28:31]
ds_read_b128 v[48:51], v9 offset:27648
v_mfma_f32_16x16x32_bf16 v[32:35], v[76:79], v[160:163], v[32:35]
ds_read_b128 v[52:55], v9 offset:28672
v_mfma_f32_16x16x32_bf16 v[36:39], v[80:83], v[160:163], v[36:39]
ds_read_b128 v[56:59], v9 offset:29696
s_waitcnt vmcnt(6) lgkmcnt(5)
v_mfma_f32_16x16x32_bf16 v[20:23], v[84:87], v[164:167], v[20:23]
ds_read_b128 v[64:67], v9 offset:30720
v_mfma_f32_16x16x32_bf16 v[24:27], v[88:91], v[164:167], v[24:27]
ds_read_b128 v[68:71], v9 offset:31744
v_mfma_f32_16x16x32_bf16 v[28:31], v[92:95], v[164:167], v[28:31]
ds_read_b128 v[72:75], v9 offset:32768
v_mfma_f32_16x16x32_bf16 v[32:35], v[96:99], v[164:167], v[32:35]
ds_read_b128 v[76:79], v9 offset:33792
v_mfma_f32_16x16x32_bf16 v[36:39], v[100:103], v[164:167], v[36:39]
ds_read_b128 v[80:83], v9 offset:34816
s_waitcnt vmcnt(5) lgkmcnt(5)
v_mfma_f32_16x16x32_bf16 v[20:23], v[40:43], v[168:171], v[20:23]
ds_read_b128 v[84:87], v9 offset:35840
v_mfma_f32_16x16x32_bf16 v[24:27], v[44:47], v[168:171], v[24:27]
ds_read_b128 v[88:91], v9 offset:36864
v_mfma_f32_16x16x32_bf16 v[28:31], v[48:51], v[168:171], v[28:31]
ds_read_b128 v[92:95], v9 offset:37888
v_mfma_f32_16x16x32_bf16 v[32:35], v[52:55], v[168:171], v[32:35]
ds_read_b128 v[96:99], v9 offset:38912
v_mfma_f32_16x16x32_bf16 v[36:39], v[56:59], v[168:171], v[36:39]
ds_read_b128 v[100:103], v9 offset:39936
s_waitcnt vmcnt(4) lgkmcnt(5)
v_mfma_f32_16x16x32_bf16 v[20:23], v[64:67], v[172:175], v[20:23]
ds_read_b128 v[40:43], v9 offset:40960
v_mfma_f32_16x16x32_bf16 v[24:27], v[68:71], v[172:175], v[24:27]
ds_read_b128 v[44:47], v9 offset:41984
v_mfma_f32_16x16x32_bf16 v[28:31], v[72:75], v[172:175], v[28:31]
ds_read_b128 v[48:51], v9 offset:43008
v_mfma_f32_16x16x32_bf16 v[32:35], v[76:79], v[172:175], v[32:35]
ds_read_b128 v[52:55], v9 offset:44032
v_mfma_f32_16x16x32_bf16 v[36:39], v[80:83], v[172:175], v[36:39]
ds_read_b128 v[56:59], v9 offset:45056
s_waitcnt vmcnt(2) lgkmcnt(5)
v_mfma_f32_16x16x32_bf16 v[20:23], v[84:87], v[176:179], v[20:23]
v_mfma_f32_16x16x32_bf16 v[24:27], v[88:91], v[176:179], v[24:27]
v_mfma_f32_16x16x32_bf16 v[28:31], v[92:95], v[176:179], v[28:31]
v_mfma_f32_16x16x32_bf16 v[32:35], v[96:99], v[176:179], v[32:35]
v_mfma_f32_16x16x32_bf16 v[36:39], v[100:103], v[176:179], v[36:39]
s_waitcnt vmcnt(0) lgkmcnt(0)
v_mfma_f32_16x16x32_bf16 v[20:23], v[40:43], v[180:183], v[20:23]
v_mfma_f32_16x16x32_bf16 v[24:27], v[44:47], v[180:183], v[24:27]
v_mfma_f32_16x16x32_bf16 v[28:31], v[48:51], v[180:183], v[28:31]
v_mfma_f32_16x16x32_bf16 v[32:35], v[52:55], v[180:183], v[32:35]
v_mfma_f32_16x16x32_bf16 v[36:39], v[56:59], v[180:183], v[36:39]
s_nop 3
v_cvt_pk_bf16_f32 v64, v20, v21
v_cvt_pk_bf16_f32 v65, v22, v23
v_cvt_pk_bf16_f32 v66, v24, v25
v_cvt_pk_bf16_f32 v67, v26, v27
v_cvt_pk_bf16_f32 v68, v28, v29
v_cvt_pk_bf16_f32 v69, v30, v31
v_cvt_pk_bf16_f32 v70, v32, v33
v_cvt_pk_bf16_f32 v71, v34, v35
v_cvt_pk_bf16_f32 v72, v36, v37
v_cvt_pk_bf16_f32 v73, v38, v39
v_permlane16_swap_b32 v64, v66
v_permlane16_swap_b32 v65, v67
v_permlane16_swap_b32 v68, v70
v_permlane16_swap_b32 v69, v71
buffer_store_dwordx4 v[64:67], v7, s[20:23], s90 offen offset:0 nt
buffer_store_dwordx4 v[68:71], v7, s[20:23], s90 offen offset:64 nt
s_mov_b32 exec_hi, 0
buffer_store_dwordx2 v[72:73], v6, s[20:23], s90 offen offset:128 nt
s_mov_b32 exec_hi, -1
s_endpgm
slow_7:
ds_read_b32 v16, v45 offset:0
s_waitcnt lgkmcnt(0)
v_readfirstlane_b32 s65, v16
s_cmp_ge_u32 s65, 3
s_cbranch_scc1 bk_6
s_sub_u32 s64, s64, 1
s_cbranch_scc0 slow_7
s_mov_b32 s64, 0
s_branch bk_6
slow_9:
ds_read_b32 v16, v45 offset:0
s_waitcnt lgkmcnt(0)
v_readfirstlane_b32 s65, v16
s_cmp_ge_u32 s65, 6
s_cbranch_scc1 bk_8
s_sub_u32 s64, s64, 1
s_cbranch_scc0 slow_9
s_mov_b32 s64, 0
s_branch bk_8
slow_11:
ds_read_b32 v16, v45 offset:0
s_waitcnt lgkmcnt(0)
v_readfirstlane_b32 s65, v16
s_cmp_ge_u32 s65, 9
s_cbranch_scc1 bk_10
s_sub_u32 s64, s64, 1
s_cbranch_scc0 slow_11
s_mov_b32 s64, 0
s_branch bk_10
slow_13:
ds_read_b32 v16, v45 offset:0
s_waitcnt lgkmcnt(0)
v_readfirstlane_b32 s65, v16
s_cmp_ge_u32 s65, 12
s_cbranch_scc1 bk_12
s_sub_u32 s64, s64, 1
s_cbranch_scc0 slow_13
s_mov_b32 s64, 0
s_branch bk_12
slow_15:
ds_read_b32 v16, v45 offset:0
s_waitcnt lgkmcnt(0)
v_readfirstlane_b32 s65, v16
s_cmp_ge_u32 s65, 15
s_cbranch_scc1 bk_14
s_sub_u32 s64, s64, 1
s_cbranch_scc0 slow_15
s_mov_b32 s64, 0
s_branch bk_14
slow_17:
ds_read_b32 v16, v45 offset:0
s_waitcnt lgkmcnt(0)
v_readfirstlane_b32 s65, v16
s_cmp_ge_u32 s65, 18
s_cbranch_scc1 bk_16
s_sub_u32 s64, s64, 1
s_cbranch_scc0 slow_17
s_mov_b32 s64, 0
s_branch bk_16
slow_19:
ds_read_b32 v16, v45 offset:0
s_waitcnt lgkmcnt(0)
v_readfirstlane_b32 s65, v16
s_cmp_ge_u32 s65, 21
s_cbranch_scc1 bk_18
s_sub_u32 s64, s64, 1
s_cbranch_scc0 slow_19
s_mov_b32 s64, 0
s_branch bk_18
slow_21:
ds_read_b32 v16, v45 offset:0
s_waitcnt lgkmcnt(0)
v_readfirstlane_b32 s65, v16
s_cmp_ge_u32 s65, 24
s_cbranch_scc1 bk_20
s_sub_u32 s64, s64, 1
s_cbranch_scc0 slow_21
s_mov_b32 s64, 0
s_branch bk_20
slow_23:
ds_read_b32 v16, v45 offset:0
s_waitcnt lgkmcnt(0)
v_readfirstlane_b32 s65, v16
s_cmp_ge_u32 s65, 27
s_cbranch_scc1 bk_22
s_sub_u32 s64, s64, 1
s_cbranch_scc0 slow_23
s_mov_b32 s64, 0
s_branch bk_22
slow_25:
ds_read_b32 v16, v45 offset:0
s_waitcnt lgkmcnt(0)
v_readfirstlane_b32 s65, v16
s_cmp_ge_u32 s65, 30
s_cbranch_scc1 bk_24
s_sub_u32 s64, s64, 1
s_cbranch_scc0 slow_25
s_mov_b32 s64, 0
s_branch bk_24
slow_27:
ds_read_b32 v16, v45 offset:0
s_waitcnt lgkmcnt(0)
v_readfirstlane_b32 s65, v16
s_cmp_ge_u32 s65, 33
s_cbranch_scc1 bk_26
s_sub_u32 s64, s64, 1
s_cbranch_scc0 slow_27
s_mov_b32 s64, 0
s_branch bk_26
slow_29:
ds_read_b32 v16, v45 offset:0
s_waitcnt lgkmcnt(0)
v_readfirstlane_b32 s65, v16
s_cmp_ge_u32 s65, 36
s_cbranch_scc1 bk_28
s_sub_u32 s64, s64, 1
s_cbranch_scc0 slow_29
s_mov_b32 s64, 0
s_branch bk_28
slow_31:
ds_read_b32 v16, v45 offset:0
s_waitcnt lgkmcnt(0)
v_readfirstlane_b32 s65, v16
s_cmp_ge_u32 s65, 39
s_cbranch_scc1 bk_30
s_sub_u32 s64, s64, 1
s_cbranch_scc0 slow_31
s_mov_b32 s64, 0
s_branch bk_30
slow_33:
ds_read_b32 v16, v45 offset:0
s_waitcnt lgkmcnt(0)
v_readfirstlane_b32 s65, v16
s_cmp_ge_u32 s65, 42
s_cbranch_scc1 bk_32
s_sub_u32 s64, s64, 1
s_cbranch_scc0 slow_33
s_mov_b32 s64, 0
s_branch bk_32
slow_35:
ds_read_b32 v16, v45 offset:0
s_waitcnt lgkmcnt(0)
v_readfirstlane_b32 s65, v16
s_cmp_ge_u32 s65, 45
s_cbranch_scc1 bk_34
s_sub_u32 s64, s64, 1
s_cbranch_scc0 slow_35
s_mov_b32 s64, 0
s_branch bk_34
slow_37:
ds_read_b32 v16, v45 offset:0
s_waitcnt lgkmcnt(0)
v_readfirstlane_b32 s65, v16
s_cmp_ge_u32 s65, 48
s_cbranch_scc1 bk_36
s_sub_u32 s64, s64, 1
s_cbranch_scc0 slow_37
s_mov_b32 s64, 0
s_branch bk_36
slow_39:
ds_read_b32 v16, v45 offset:0
s_waitcnt lgkmcnt(0)
v_readfirstlane_b32 s65, v16
s_cmp_ge_u32 s65, 51
s_cbranch_scc1 bk_38
s_sub_u32 s64, s64, 1
s_cbranch_scc0 slow_39
s_mov_b32 s64, 0
s_branch bk_38
slow_41:
ds_read_b32 v16, v45 offset:0
s_waitcnt lgkmcnt(0)
v_readfirstlane_b32 s65, v16
s_cmp_ge_u32 s65, 54
s_cbranch_scc1 bk_40
s_sub_u32 s64, s64, 1
s_cbranch_scc0 slow_41
s_mov_b32 s64, 0
s_branch bk_40
slow_48:
ds_read_b32 v16, v45 offset:0
s_waitcnt lgkmcnt(0)
v_readfirstlane_b32 s65, v16
s_cmp_ge_u32 s65, 63
s_cbranch_scc1 bk_47
s_sub_u32 s64, s64, 1
s_cbranch_scc0 slow_48
s_mov_b32 s64, 0
s_branch bk_47
slow_50:
ds_read_b32 v16, v45 offset:0
s_waitcnt lgkmcnt(0)
v_readfirstlane_b32 s65, v16
s_cmp_ge_u32 s65, 72
s_cbranch_scc1 bk_49
s_sub_u32 s64, s64, 1
s_cbranch_scc0 slow_50
s_mov_b32 s64, 0
s_branch bk_49
slow_52:
ds_read_b32 v16, v45 offset:0
s_waitcnt lgkmcnt(0)
v_readfirstlane_b32 s65, v16
s_cmp_ge_u32 s65, 81
s_cbranch_scc1 bk_51
s_sub_u32 s64, s64, 1
s_cbranch_scc0 slow_52
s_mov_b32 s64, 0
s_branch bk_51
slow_54:
ds_read_b32 v16, v45 offset:0
s_waitcnt lgkmcnt(0)
v_readfirstlane_b32 s65, v16
s_cmp_ge_u32 s65, 90
s_cbranch_scc1 bk_53
s_sub_u32 s64, s64, 1
s_cbranch_scc0 slow_54
s_mov_b32 s64, 0
s_branch bk_53
slow_56:
ds_read_b32 v16, v45 offset:0
s_waitcnt lgkmcnt(0)
v_readfirstlane_b32 s65, v16
s_cmp_ge_u32 s65, 99
s_cbranch_scc1 bk_55
s_sub_u32 s64, s64, 1
s_cbranch_scc0 slow_56
s_mov_b32 s64, 0
s_branch bk_55
slow_58:
ds_read_b32 v16, v45 offset:0
s_waitcnt lgkmcnt(0)
v_readfirstlane_b32 s65, v16
s_cmp_ge_u32 s65, 108
s_cbranch_scc1 bk_57
s_sub_u32 s64, s64, 1
s_cbranch_scc0 slow_58
s_mov_b32 s64, 0
s_branch bk_57
slow_64:
ds_read_b32 v16, v45 offset:0
s_waitcnt lgkmcnt(0)
v_readfirstlane_b32 s65, v16
s_cmp_ge_u32 s65, 117
s_cbranch_scc1 bk_63
s_sub_u32 s64, s64, 1
s_cbranch_scc0 slow_64
s_mov_b32 s64, 0
s_branch bk_63
slow_66:
ds_read_b32 v16, v45 offset:0
s_waitcnt lgkmcnt(0)
v_readfirstlane_b32 s65, v16
s_cmp_ge_u32 s65, 126
s_cbranch_scc1 bk_65
s_sub_u32 s64, s64, 1
s_cbranch_scc0 slow_66
s_mov_b32 s64, 0
s_branch bk_65
slow_68:
ds_read_b32 v16, v45 offset:0
s_waitcnt lgkmcnt(0)
v_readfirstlane_b32 s65, v16
s_cmp_ge_u32 s65, 135
s_cbranch_scc1 bk_67
s_sub_u32 s64, s64, 1
s_cbranch_scc0 slow_68
s_mov_b32 s64, 0
s_branch bk_67
slow_70:
ds_read_b32 v16, v45 offset:0
s_waitcnt lgkmcnt(0)
v_readfirstlane_b32 s65, v16
s_cmp_ge_u32 s65, 144
s_cbranch_scc1 bk_69
s_sub_u32 s64, s64, 1
s_cbranch_scc0 slow_70
s_mov_b32 s64, 0
s_branch bk_69
slow_72:
ds_read_b32 v16, v45 offset:0
s_waitcnt lgkmcnt(0)
v_readfirstlane_b32 s65, v16
s_cmp_ge_u32 s65, 153
s_cbranch_scc1 bk_71
s_sub_u32 s64, s64, 1
s_cbranch_scc0 slow_72
s_mov_b32 s64, 0
s_branch bk_71
slow_74:
ds_read_b32 v16, v45 offset:0
s_waitcnt lgkmcnt(0)
v_readfirstlane_b32 s65, v16
s_cmp_ge_u32 s65, 162
s_cbranch_scc1 bk_73
s_sub_u32 s64, s64, 1
s_cbranch_scc0 slow_74
s_mov_b32 s64, 0
s_branch bk_73
kvag_81:
s_waitcnt vmcnt(0)
v_cmp_ne_u32 vcc, s66, v205
s_cmp_eq_u64 vcc, 0
s_cbranch_scc1 kvok_82
s_mov_b64 s[70:71], exec
poll_84:
buffer_load_dword v205, v22, s[16:19], 0 offen sc1
s_waitcnt vmcnt(0)
v_cmp_ne_u32 vcc, s66, v205
s_cmp_eq_u64 vcc, 0
s_cbranch_scc1 ok_83
s_sleep 1
s_sub_u32 s64, s64, 64
s_cbranch_scc0 poll_84
s_mov_b32 s64, 0
ok_83:
s_mov_b64 exec, s[70:71]
kvok_82:
buffer_load_dwordx4 v[176:179], v23, s[16:19], s90 offen sc1
buffer_load_dwordx4 v[180:183], v23, s[16:19], s94 offen sc1
buffer_load_dwordx4 v[112:115], v6, s[16:19], s8 offen sc1
buffer_load_dwordx4 v[116:119], v6, s[16:19], s9 offen sc1
buffer_load_dwordx4 v[120:123], v6, s[16:19], s10 offen sc1
buffer_load_dwordx4 v[124:127], v6, s[16:19], s11 offen sc1
buffer_load_dwordx4 v[128:131], v6, s[16:19], s12 offen sc1
buffer_load_dwordx4 v[132:135], v6, s[16:19], s13 offen sc1
buffer_load_dwordx4 v[136:139], v6, s[16:19], s14 offen sc1
buffer_load_dwordx4 v[140:143], v6, s[16:19], s15 offen sc1
buffer_load_dwordx4 v[144:147], v6, s[16:19], s24 offen sc1
buffer_load_dwordx4 v[148:151], v6, s[16:19], s25 offen sc1
buffer_load_dwordx4 v[152:155], v6, s[16:19], s26 offen sc1
buffer_load_dwordx4 v[156:159], v6, s[16:19], s27 offen sc1
buffer_load_dwordx4 v[160:163], v6, s[16:19], s28 offen sc1
buffer_load_dwordx4 v[164:167], v6, s[16:19], s29 offen sc1
buffer_load_dwordx4 v[168:171], v6, s[16:19], s30 offen sc1
buffer_load_dwordx4 v[172:175], v6, s[16:19], s31 offen sc1
s_branch kvhave_80
kvag_89:
s_waitcnt vmcnt(0)
v_cmp_ne_u32 vcc, s66, v205
s_cmp_eq_u64 vcc, 0
s_cbranch_scc1 kvok_90
s_mov_b64 s[70:71], exec
poll_92:
buffer_load_dword v205, v22, s[16:19], 0 offen sc1
s_waitcnt vmcnt(0)
v_cmp_ne_u32 vcc, s66, v205
s_cmp_eq_u64 vcc, 0
s_cbranch_scc1 ok_91
s_sleep 1
s_sub_u32 s64, s64, 64
s_cbranch_scc0 poll_92
s_mov_b32 s64, 0
ok_91:
s_mov_b64 exec, s[70:71]
kvok_90:
buffer_load_dwordx4 v[112:115], v23, s[16:19], s8 offen sc1
buffer_load_dwordx4 v[116:119], v23, s[16:19], s12 offen sc1
buffer_load_dwordx4 v[120:123], v23, s[16:19], s24 offen sc1
buffer_load_dwordx4 v[124:127], v23, s[16:19], s28 offen sc1
s_branch kvhave_88
L_loader:
v_add_u32 v2, 0, v0
v_mul_u32_u24 v3, 10923, v2
v_lshrrev_b32 v3, 16, v3
v_mul_u32_u24 v4, 6, v3
v_sub_u32 v4, v2, v4
v_lshrrev_b32 v6, 2, v3
v_lshrrev_b32 v5, 3, v3
v_xor_b32 v6, v6, v5
v_and_b32 v6, 1, v6
v_mul_u32_u24 v6, 12, v6
v_xor_b32 v5, v3, v6
v_mul_u32_u24 v5, 3456, v5
v_lshlrev_b32 v6, 4, v4
v_add_u32 v5, v5, v6
v_add_u32 v5, 2048, v5
v_mov_b32 v6, 0x40000000
v_cmp_gt_u32 vcc, 5, v4
s_nop 1
v_cndmask_b32 v8, v6, v5, vcc
v_add_u32 v2, 64, v0
v_mul_u32_u24 v3, 10923, v2
v_lshrrev_b32 v3, 16, v3
v_mul_u32_u24 v4, 6, v3
v_sub_u32 v4, v2, v4
v_lshrrev_b32 v6, 2, v3
v_lshrrev_b32 v5, 3, v3
v_xor_b32 v6, v6, v5
v_and_b32 v6, 1, v6
v_mul_u32_u24 v6, 12, v6
v_xor_b32 v5, v3, v6
v_mul_u32_u24 v5, 3456, v5
v_lshlrev_b32 v6, 4, v4
v_add_u32 v5, v5, v6
v_add_u32 v5, 1024, v5
v_mov_b32 v6, 0x40000000
v_cmp_gt_u32 vcc, 5, v4
s_nop 1
v_cndmask_b32 v9, v6, v5, vcc
v_add_u32 v2, 128, v0
v_mul_u32_u24 v3, 10923, v2
v_lshrrev_b32 v3, 16, v3
v_mul_u32_u24 v4, 6, v3
v_sub_u32 v4, v2, v4
v_lshrrev_b32 v6, 2, v3
v_lshrrev_b32 v5, 3, v3
v_xor_b32 v6, v6, v5
v_and_b32 v6, 1, v6
v_mul_u32_u24 v6, 12, v6
v_xor_b32 v5, v3, v6
v_mul_u32_u24 v5, 3456, v5
v_lshlrev_b32 v6, 4, v4
v_add_u32 v5, v5, v6
v_add_u32 v5, 0, v5
v_mov_b32 v6, 0x40000000
v_cmp_gt_u32 vcc, 5, v4
s_nop 1
v_cndmask_b32 v10, v6, v5, vcc
v_mov_b32 v30, 0
s_mul_i32 s80, s5, 72
s_mul_i32 s88, s98, 221184
s_add_u32 s89, s80, 1152
s_add_u32 s88, s88, s89
s_add_u32 s87, s89, 1990656
s_lshr_b32 s81, s5, 1
s_mul_i32 s81, s81, 144
s_mov_b32 s65, 0
s_waitcnt lgkmcnt(0)
s_barrier
s_mov_b32 s16, s62
s_mov_b32 s17, s63
s_mov_b32 s18, 0x2000000
s_mov_b32 s19, 0x20000
s_mov_b32 s20, s58
s_mov_b32 s21, s59
s_mov_b32 s22, 0x480000
s_mov_b32 s23, 0x20000
s_sub_u32 s8, s38, 2048
s_subb_u32 s9, s39, 0
s_mov_b32 s10, 0x1e6800
s_mov_b32 s11, 0x20000
s_mov_b32 s24, s42
s_mov_b32 s25, s43
s_mov_b32 s26, 0xa2000
s_mov_b32 s27, 0x20000
s_mov_b32 m0, 256
s_nop 0
buffer_load_dwordx4 v8, s[8:11], s88 offen offset:0 lds
buffer_load_dwordx4 v9, s[8:11], s88 offen offset:1024 lds
buffer_load_dwordx4 v10, s[8:11], s88 offen offset:2048 lds
s_add_u32 s88, s88, 110592
s_mov_b32 m0, 3328
s_nop 0
buffer_load_dwordx4 v8, s[8:11], s88 offen offset:0 lds
buffer_load_dwordx4 v9, s[8:11], s88 offen offset:1024 lds
buffer_load_dwordx4 v10, s[8:11], s88 offen offset:2048 lds
s_add_u32 s88, s88, 110592
s_cmp_eq_u32 s88, s87
s_cselect_b32 s88, s89, s88
s_mov_b32 m0, 6400
s_nop 0
buffer_load_dwordx4 v8, s[8:11], s88 offen offset:0 lds
buffer_load_dwordx4 v9, s[8:11], s88 offen offset:1024 lds
buffer_load_dwordx4 v10, s[8:11], s88 offen offset:2048 lds
s_add_u32 s88, s88, 110592
s_mov_b32 m0, 9472
s_getreg_b32 s69, hwreg(HW_REG_IB_STS)
buffer_load_dwordx4 v8, s[8:11], s88 offen offset:0 lds
s_and_b32 s70, s69, 15
buffer_load_dwordx4 v9, s[8:11], s88 offen offset:1024 lds
s_bfe_u32 s71, s69, 0x20016
buffer_load_dwordx4 v10, s[8:11], s88 offen offset:2048 lds
s_add_u32 s88, s88, 110592
s_cmp_eq_u32 s88, s87
s_cselect_b32 s88, s89, s88
s_lshl4_add_u32 s70, s71, s70
s_sub_u32 s70, 9, s70
v_mov_b32 v40, s70
ds_write_b32 v30, v40 offset:0
s_mov_b32 m0, 12544
s_getreg_b32 s69, hwreg(HW_REG_IB_STS)
buffer_load_dwordx4 v8, s[8:11], s88 offen offset:0 lds
s_and_b32 s70, s69, 15
buffer_load_dwordx4 v9, s[8:11], s88 offen offset:1024 lds
s_bfe_u32 s71, s69, 0x20016
buffer_load_dwordx4 v10, s[8:11], s88 offen offset:2048 lds
s_add_u32 s88, s88, 110592
s_lshl4_add_u32 s70, s71, s70
s_sub_u32 s70, 12, s70
v_mov_b32 v40, s70
ds_write_b32 v30, v40 offset:0
s_mov_b32 m0, 15616
s_getreg_b32 s69, hwreg(HW_REG_IB_STS)
buffer_load_dwordx4 v8, s[8:11], s88 offen offset:0 lds
s_and_b32 s70, s69, 15
buffer_load_dwordx4 v9, s[8:11], s88 offen offset:1024 lds
s_bfe_u32 s71, s69, 0x20016
buffer_load_dwordx4 v10, s[8:11], s88 offen offset:2048 lds
s_add_u32 s88, s88, 110592
s_cmp_eq_u32 s88, s87
s_cselect_b32 s88, s89, s88
s_lshl4_add_u32 s70, s71, s70
s_sub_u32 s70, 15, s70
v_mov_b32 v40, s70
ds_write_b32 v30, v40 offset:0
s_mov_b32 m0, 18688
s_getreg_b32 s69, hwreg(HW_REG_IB_STS)
buffer_load_dwordx4 v8, s[8:11], s88 offen offset:0 lds
s_and_b32 s70, s69, 15
buffer_load_dwordx4 v9, s[8:11], s88 offen offset:1024 lds
s_bfe_u32 s71, s69, 0x20016
buffer_load_dwordx4 v10, s[8:11], s88 offen offset:2048 lds
s_add_u32 s88, s88, 110592
s_lshl4_add_u32 s70, s71, s70
s_sub_u32 s70, 18, s70
v_mov_b32 v40, s70
ds_write_b32 v30, v40 offset:0
s_cmp_ge_u32 s65, 1
s_cbranch_scc0 slow_105
bk_104:
s_mov_b32 m0, 21760
s_getreg_b32 s69, hwreg(HW_REG_IB_STS)
buffer_load_dwordx4 v8, s[8:11], s88 offen offset:0 lds
s_and_b32 s70, s69, 15
buffer_load_dwordx4 v9, s[8:11], s88 offen offset:1024 lds
s_bfe_u32 s71, s69, 0x20016
buffer_load_dwordx4 v10, s[8:11], s88 offen offset:2048 lds
s_add_u32 s88, s88, 110592
s_cmp_eq_u32 s88, s87
s_cselect_b32 s88, s89, s88
s_lshl4_add_u32 s70, s71, s70
s_sub_u32 s70, 21, s70
v_mov_b32 v40, s70
ds_write_b32 v30, v40 offset:0
s_cmp_ge_u32 s65, 2
s_cbranch_scc0 slow_107
bk_106:
s_mov_b32 m0, 24832
s_getreg_b32 s69, hwreg(HW_REG_IB_STS)
buffer_load_dwordx4 v8, s[8:11], s88 offen offset:0 lds
s_and_b32 s70, s69, 15
buffer_load_dwordx4 v9, s[8:11], s88 offen offset:1024 lds
s_bfe_u32 s71, s69, 0x20016
buffer_load_dwordx4 v10, s[8:11], s88 offen offset:2048 lds
s_add_u32 s88, s88, 110592
s_lshl4_add_u32 s70, s71, s70
s_sub_u32 s70, 24, s70
v_mov_b32 v40, s70
ds_write_b32 v30, v40 offset:0
s_cmp_ge_u32 s65, 3
s_cbranch_scc0 slow_109
bk_108:
s_mov_b32 m0, 27904
s_getreg_b32 s69, hwreg(HW_REG_IB_STS)
buffer_load_dwordx4 v8, s[8:11], s88 offen offset:0 lds
s_and_b32 s70, s69, 15
buffer_load_dwordx4 v9, s[8:11], s88 offen offset:1024 lds
s_bfe_u32 s71, s69, 0x20016
buffer_load_dwordx4 v10, s[8:11], s88 offen offset:2048 lds
s_add_u32 s88, s88, 110592
s_cmp_eq_u32 s88, s87
s_cselect_b32 s88, s89, s88
s_lshl4_add_u32 s70, s71, s70
s_sub_u32 s70, 27, s70
v_mov_b32 v40, s70
ds_write_b32 v30, v40 offset:0
s_cmp_ge_u32 s65, 4
s_cbranch_scc0 slow_111
bk_110:
s_mov_b32 m0, 30976
s_getreg_b32 s69, hwreg(HW_REG_IB_STS)
buffer_load_dwordx4 v8, s[8:11], s88 offen offset:0 lds
s_and_b32 s70, s69, 15
buffer_load_dwordx4 v9, s[8:11], s88 offen offset:1024 lds
s_bfe_u32 s71, s69, 0x20016
buffer_load_dwordx4 v10, s[8:11], s88 offen offset:2048 lds
s_add_u32 s88, s88, 110592
s_lshl4_add_u32 s70, s71, s70
s_sub_u32 s70, 30, s70
v_mov_b32 v40, s70
ds_write_b32 v30, v40 offset:0
s_cmp_ge_u32 s65, 5
s_cbranch_scc0 slow_113
bk_112:
s_mov_b32 m0, 34048
s_getreg_b32 s69, hwreg(HW_REG_IB_STS)
buffer_load_dwordx4 v8, s[8:11], s88 offen offset:0 lds
s_and_b32 s70, s69, 15
buffer_load_dwordx4 v9, s[8:11], s88 offen offset:1024 lds
s_bfe_u32 s71, s69, 0x20016
buffer_load_dwordx4 v10, s[8:11], s88 offen offset:2048 lds
s_add_u32 s88, s88, 110592
s_cmp_eq_u32 s88, s87
s_cselect_b32 s88, s89, s88
s_lshl4_add_u32 s70, s71, s70
s_sub_u32 s70, 33, s70
v_mov_b32 v40, s70
ds_write_b32 v30, v40 offset:0
s_cmp_ge_u32 s65, 6
s_cbranch_scc0 slow_115
bk_114:
s_mov_b32 m0, 37120
s_getreg_b32 s69, hwreg(HW_REG_IB_STS)
buffer_load_dwordx4 v8, s[8:11], s88 offen offset:0 lds
s_and_b32 s70, s69, 15
buffer_load_dwordx4 v9, s[8:11], s88 offen offset:1024 lds
s_bfe_u32 s71, s69, 0x20016
buffer_load_dwordx4 v10, s[8:11], s88 offen offset:2048 lds
s_add_u32 s88, s88, 110592
s_lshl4_add_u32 s70, s71, s70
s_sub_u32 s70, 36, s70
v_mov_b32 v40, s70
ds_write_b32 v30, v40 offset:0
s_cmp_ge_u32 s65, 7
s_cbranch_scc0 slow_117
bk_116:
s_mov_b32 m0, 40192
s_getreg_b32 s69, hwreg(HW_REG_IB_STS)
buffer_load_dwordx4 v8, s[8:11], s88 offen offset:0 lds
s_and_b32 s70, s69, 15
buffer_load_dwordx4 v9, s[8:11], s88 offen offset:1024 lds
s_bfe_u32 s71, s69, 0x20016
buffer_load_dwordx4 v10, s[8:11], s88 offen offset:2048 lds
s_add_u32 s88, s88, 110592
s_cmp_eq_u32 s88, s87
s_cselect_b32 s88, s89, s88
s_lshl4_add_u32 s70, s71, s70
s_sub_u32 s70, 39, s70
v_mov_b32 v40, s70
ds_write_b32 v30, v40 offset:0
s_cmp_ge_u32 s65, 8
s_cbranch_scc0 slow_119
bk_118:
s_mov_b32 m0, 256
s_getreg_b32 s69, hwreg(HW_REG_IB_STS)
buffer_load_dwordx4 v8, s[8:11], s88 offen offset:0 lds
s_and_b32 s70, s69, 15
buffer_load_dwordx4 v9, s[8:11], s88 offen offset:1024 lds
s_bfe_u32 s71, s69, 0x20016
buffer_load_dwordx4 v10, s[8:11], s88 offen offset:2048 lds
s_add_u32 s88, s88, 110592
s_lshl4_add_u32 s70, s71, s70
s_sub_u32 s70, 42, s70
v_mov_b32 v40, s70
ds_write_b32 v30, v40 offset:0
s_cmp_ge_u32 s65, 9
s_cbranch_scc0 slow_121
bk_120:
s_mov_b32 m0, 3328
s_getreg_b32 s69, hwreg(HW_REG_IB_STS)
buffer_load_dwordx4 v8, s[8:11], s88 offen offset:0 lds
s_and_b32 s70, s69, 15
buffer_load_dwordx4 v9, s[8:11], s88 offen offset:1024 lds
s_bfe_u32 s71, s69, 0x20016
buffer_load_dwordx4 v10, s[8:11], s88 offen offset:2048 lds
s_add_u32 s88, s88, 110592
s_cmp_eq_u32 s88, s87
s_cselect_b32 s88, s89, s88
s_lshl4_add_u32 s70, s71, s70
s_sub_u32 s70, 45, s70
v_mov_b32 v40, s70
ds_write_b32 v30, v40 offset:0
s_cmp_ge_u32 s65, 10
s_cbranch_scc0 slow_123
bk_122:
s_mov_b32 m0, 6400
s_getreg_b32 s69, hwreg(HW_REG_IB_STS)
buffer_load_dwordx4 v8, s[8:11], s88 offen offset:0 lds
s_and_b32 s70, s69, 15
buffer_load_dwordx4 v9, s[8:11], s88 offen offset:1024 lds
s_bfe_u32 s71, s69, 0x20016
buffer_load_dwordx4 v10, s[8:11], s88 offen offset:2048 lds
s_add_u32 s88, s88, 110592
s_lshl4_add_u32 s70, s71, s70
s_sub_u32 s70, 48, s70
v_mov_b32 v40, s70
ds_write_b32 v30, v40 offset:0
s_cmp_ge_u32 s65, 11
s_cbranch_scc0 slow_125
bk_124:
s_mov_b32 m0, 9472
s_getreg_b32 s69, hwreg(HW_REG_IB_STS)
buffer_load_dwordx4 v8, s[8:11], s88 offen offset:0 lds
s_and_b32 s70, s69, 15
buffer_load_dwordx4 v9, s[8:11], s88 offen offset:1024 lds
s_bfe_u32 s71, s69, 0x20016
buffer_load_dwordx4 v10, s[8:11], s88 offen offset:2048 lds
s_add_u32 s88, s88, 110592
s_cmp_eq_u32 s88, s87
s_cselect_b32 s88, s89, s88
s_lshl4_add_u32 s70, s71, s70
s_sub_u32 s70, 51, s70
v_mov_b32 v40, s70
ds_write_b32 v30, v40 offset:0
s_cmp_ge_u32 s65, 5
s_cbranch_scc0 slow_127
bk_126:
s_add_u32 s88, s88, 1152
s_add_u32 s87, s87, 1152
s_add_u32 s89, s89, 1152
s_mov_b32 m0, 12544
s_nop 0
buffer_load_dwordx4 v8, s[8:11], s88 offen offset:0 lds
buffer_load_dwordx4 v9, s[8:11], s88 offen offset:1024 lds
buffer_load_dwordx4 v10, s[8:11], s88 offen offset:2048 lds
s_add_u32 s88, s88, 110592
s_cmp_ge_u32 s65, 6
s_cbranch_scc0 slow_129
bk_128:
s_mov_b32 m0, 15616
s_nop 0
buffer_load_dwordx4 v8, s[8:11], s88 offen offset:0 lds
buffer_load_dwordx4 v9, s[8:11], s88 offen offset:1024 lds
buffer_load_dwordx4 v10, s[8:11], s88 offen offset:2048 lds
s_add_u32 s88, s88, 110592
s_cmp_eq_u32 s88, s87
s_cselect_b32 s88, s89, s88
s_cmp_ge_u32 s65, 7
s_cbranch_scc0 slow_131
bk_130:
s_mov_b32 m0, 18688
s_getreg_b32 s69, hwreg(HW_REG_IB_STS)
buffer_load_dwordx4 v8, s[8:11], s88 offen offset:0 lds
s_and_b32 s70, s69, 15
buffer_load_dwordx4 v9, s[8:11], s88 offen offset:1024 lds
s_bfe_u32 s71, s69, 0x20016
buffer_load_dwordx4 v10, s[8:11], s88 offen offset:2048 lds
s_add_u32 s88, s88, 110592
s_lshl4_add_u32 s70, s71, s70
s_sub_u32 s70, 60, s70
v_mov_b32 v40, s70
ds_write_b32 v30, v40 offset:0
s_cmp_ge_u32 s65, 8
s_cbranch_scc0 slow_133
bk_132:
s_mov_b32 m0, 21760
s_nop 0
buffer_load_dwordx4 v8, s[8:11], s88 offen offset:0 lds
buffer_load_dwordx4 v9, s[8:11], s88 offen offset:1024 lds
buffer_load_dwordx4 v10, s[8:11], s88 offen offset:2048 lds
s_add_u32 s88, s88, 110592
s_cmp_eq_u32 s88, s87
s_cselect_b32 s88, s89, s88
s_cmp_ge_u32 s65, 9
s_cbranch_scc0 slow_135
bk_134:
s_mov_b32 m0, 24832
s_nop 0
buffer_load_dwordx4 v8, s[8:11], s88 offen offset:0 lds
buffer_load_dwordx4 v9, s[8:11], s88 offen offset:1024 lds
buffer_load_dwordx4 v10, s[8:11], s88 offen offset:2048 lds
s_add_u32 s88, s88, 110592
s_cmp_ge_u32 s65, 10
s_cbranch_scc0 slow_137
bk_136:
s_mov_b32 m0, 27904
s_getreg_b32 s69, hwreg(HW_REG_IB_STS)
buffer_load_dwordx4 v8, s[8:11], s88 offen offset:0 lds
s_and_b32 s70, s69, 15
buffer_load_dwordx4 v9, s[8:11], s88 offen offset:1024 lds
s_bfe_u32 s71, s69, 0x20016
buffer_load_dwordx4 v10, s[8:11], s88 offen offset:2048 lds
s_add_u32 s88, s88, 110592
s_cmp_eq_u32 s88, s87
s_cselect_b32 s88, s89, s88
s_lshl4_add_u32 s70, s71, s70
s_sub_u32 s70, 69, s70
v_mov_b32 v40, s70
ds_write_b32 v30, v40 offset:0
s_cmp_ge_u32 s65, 11
s_cbranch_scc0 slow_139
bk_138:
s_mov_b32 m0, 30976
s_nop 0
buffer_load_dwordx4 v8, s[8:11], s88 offen offset:0 lds
buffer_load_dwordx4 v9, s[8:11], s88 offen offset:1024 lds
buffer_load_dwordx4 v10, s[8:11], s88 offen offset:2048 lds
s_add_u32 s88, s88, 110592
s_cmp_ge_u32 s65, 12
s_cbranch_scc0 slow_141
bk_140:
s_mov_b32 m0, 34048
s_nop 0
buffer_load_dwordx4 v8, s[8:11], s88 offen offset:0 lds
buffer_load_dwordx4 v9, s[8:11], s88 offen offset:1024 lds
buffer_load_dwordx4 v10, s[8:11], s88 offen offset:2048 lds
s_add_u32 s88, s88, 110592
s_cmp_eq_u32 s88, s87
s_cselect_b32 s88, s89, s88
s_cmp_ge_u32 s65, 13
s_cbranch_scc0 slow_143
bk_142:
s_mov_b32 m0, 37120
s_getreg_b32 s69, hwreg(HW_REG_IB_STS)
buffer_load_dwordx4 v8, s[8:11], s88 offen offset:0 lds
s_and_b32 s70, s69, 15
buffer_load_dwordx4 v9, s[8:11], s88 offen offset:1024 lds
s_bfe_u32 s71, s69, 0x20016
buffer_load_dwordx4 v10, s[8:11], s88 offen offset:2048 lds
s_add_u32 s88, s88, 110592
s_lshl4_add_u32 s70, s71, s70
s_sub_u32 s70, 78, s70
v_mov_b32 v40, s70
ds_write_b32 v30, v40 offset:0
s_cmp_ge_u32 s65, 14
s_cbranch_scc0 slow_145
bk_144:
s_mov_b32 m0, 40192
s_nop 0
buffer_load_dwordx4 v8, s[8:11], s88 offen offset:0 lds
buffer_load_dwordx4 v9, s[8:11], s88 offen offset:1024 lds
buffer_load_dwordx4 v10, s[8:11], s88 offen offset:2048 lds
s_add_u32 s88, s88, 110592
s_cmp_eq_u32 s88, s87
s_cselect_b32 s88, s89, s88
s_cmp_ge_u32 s65, 15
s_cbranch_scc0 slow_147
bk_146:
s_mov_b32 m0, 256
s_nop 0
buffer_load_dwordx4 v8, s[8:11], s88 offen offset:0 lds
buffer_load_dwordx4 v9, s[8:11], s88 offen offset:1024 lds
buffer_load_dwordx4 v10, s[8:11], s88 offen offset:2048 lds
s_add_u32 s88, s88, 110592
s_cmp_ge_u32 s65, 16
s_cbranch_scc0 slow_149
bk_148:
s_mov_b32 m0, 3328
s_getreg_b32 s69, hwreg(HW_REG_IB_STS)
buffer_load_dwordx4 v8, s[8:11], s88 offen offset:0 lds
s_and_b32 s70, s69, 15
buffer_load_dwordx4 v9, s[8:11], s88 offen offset:1024 lds
s_bfe_u32 s71, s69, 0x20016
buffer_load_dwordx4 v10, s[8:11], s88 offen offset:2048 lds
s_add_u32 s88, s88, 110592
s_cmp_eq_u32 s88, s87
s_cselect_b32 s88, s89, s88
s_lshl4_add_u32 s70, s71, s70
s_sub_u32 s70, 87, s70
v_mov_b32 v40, s70
ds_write_b32 v30, v40 offset:0
s_cmp_ge_u32 s65, 17
s_cbranch_scc0 slow_151
bk_150:
s_mov_b32 m0, 6400
s_nop 0
buffer_load_dwordx4 v8, s[8:11], s88 offen offset:0 lds
buffer_load_dwordx4 v9, s[8:11], s88 offen offset:1024 lds
buffer_load_dwordx4 v10, s[8:11], s88 offen offset:2048 lds
s_add_u32 s88, s88, 110592
s_cmp_ge_u32 s65, 18
s_cbranch_scc0 slow_153
bk_152:
s_mov_b32 m0, 9472
s_nop 0
buffer_load_dwordx4 v8, s[8:11], s88 offen offset:0 lds
buffer_load_dwordx4 v9, s[8:11], s88 offen offset:1024 lds
buffer_load_dwordx4 v10, s[8:11], s88 offen offset:2048 lds
s_add_u32 s88, s88, 110592
s_cmp_eq_u32 s88, s87
s_cselect_b32 s88, s89, s88
s_cmp_ge_u32 s65, 17
s_cbranch_scc0 slow_155
bk_154:
s_mov_b32 m0, 52480
s_getreg_b32 s69, hwreg(HW_REG_IB_STS)
buffer_load_dwordx4 v8, s[8:11], s88 offen offset:0 lds
s_and_b32 s70, s69, 15
buffer_load_dwordx4 v9, s[8:11], s88 offen offset:1024 lds
s_bfe_u32 s71, s69, 0x20016
buffer_load_dwordx4 v10, s[8:11], s88 offen offset:2048 lds
s_add_u32 s88, s88, 110592
s_lshl4_add_u32 s70, s71, s70
s_sub_u32 s70, 96, s70
v_mov_b32 v40, s70
ds_write_b32 v30, v40 offset:0
s_cmp_ge_u32 s65, 17
s_cbranch_scc0 slow_157
bk_156:
s_mov_b32 m0, 64768
s_nop 0
buffer_load_dwordx4 v8, s[8:11], s88 offen offset:0 lds
buffer_load_dwordx4 v9, s[8:11], s88 offen offset:1024 lds
buffer_load_dwordx4 v10, s[8:11], s88 offen offset:2048 lds
s_add_u32 s88, s88, 110592
s_cmp_eq_u32 s88, s87
s_cselect_b32 s88, s89, s88
s_cmp_ge_u32 s65, 17
s_cbranch_scc0 slow_159
bk_158:
s_mov_b32 m0, 77056
s_nop 0
buffer_load_dwordx4 v8, s[8:11], s88 offen offset:0 lds
buffer_load_dwordx4 v9, s[8:11], s88 offen offset:1024 lds
buffer_load_dwordx4 v10, s[8:11], s88 offen offset:2048 lds
s_add_u32 s88, s88, 110592
s_cmp_ge_u32 s65, 17
s_cbranch_scc0 slow_161
bk_160:
s_mov_b32 m0, 89344
s_getreg_b32 s69, hwreg(HW_REG_IB_STS)
buffer_load_dwordx4 v8, s[8:11], s88 offen offset:0 lds
s_and_b32 s70, s69, 15
buffer_load_dwordx4 v9, s[8:11], s88 offen offset:1024 lds
s_bfe_u32 s71, s69, 0x20016
buffer_load_dwordx4 v10, s[8:11], s88 offen offset:2048 lds
s_add_u32 s88, s88, 110592
s_cmp_eq_u32 s88, s87
s_cselect_b32 s88, s89, s88
s_lshl4_add_u32 s70, s71, s70
s_sub_u32 s70, 105, s70
v_mov_b32 v40, s70
ds_write_b32 v30, v40 offset:0
s_cmp_ge_u32 s65, 19
s_cbranch_scc0 slow_163
bk_162:
s_sub_u32 s88, s88, 2304
s_sub_u32 s87, s87, 2304
s_sub_u32 s89, s89, 2304
s_mov_b32 m0, 12544
s_nop 0
buffer_load_dwordx4 v8, s[8:11], s88 offen offset:0 lds
buffer_load_dwordx4 v9, s[8:11], s88 offen offset:1024 lds
buffer_load_dwordx4 v10, s[8:11], s88 offen offset:2048 lds
s_add_u32 s88, s88, 110592
s_cmp_ge_u32 s65, 20
s_cbranch_scc0 slow_165
bk_164:
s_mov_b32 m0, 15616
s_nop 0
buffer_load_dwordx4 v8, s[8:11], s88 offen offset:0 lds
buffer_load_dwordx4 v9, s[8:11], s88 offen offset:1024 lds
buffer_load_dwordx4 v10, s[8:11], s88 offen offset:2048 lds
s_add_u32 s88, s88, 110592
s_cmp_eq_u32 s88, s87
s_cselect_b32 s88, s89, s88
s_cmp_ge_u32 s65, 21
s_cbranch_scc0 slow_167
bk_166:
s_mov_b32 m0, 18688
s_getreg_b32 s69, hwreg(HW_REG_IB_STS)
buffer_load_dwordx4 v8, s[8:11], s88 offen offset:0 lds
s_and_b32 s70, s69, 15
buffer_load_dwordx4 v9, s[8:11], s88 offen offset:1024 lds
s_bfe_u32 s71, s69, 0x20016
buffer_load_dwordx4 v10, s[8:11], s88 offen offset:2048 lds
s_add_u32 s88, s88, 110592
s_lshl4_add_u32 s70, s71, s70
s_sub_u32 s70, 114, s70
v_mov_b32 v40, s70
ds_write_b32 v30, v40 offset:0
s_cmp_ge_u32 s65, 22
s_cbranch_scc0 slow_169
bk_168:
s_mov_b32 m0, 21760
s_nop 0
buffer_load_dwordx4 v8, s[8:11], s88 offen offset:0 lds
buffer_load_dwordx4 v9, s[8:11], s88 offen offset:1024 lds
buffer_load_dwordx4 v10, s[8:11], s88 offen offset:2048 lds
s_add_u32 s88, s88, 110592
s_cmp_eq_u32 s88, s87
s_cselect_b32 s88, s89, s88
s_cmp_ge_u32 s65, 23
s_cbranch_scc0 slow_171
bk_170:
s_mov_b32 m0, 24832
s_nop 0
buffer_load_dwordx4 v8, s[8:11], s88 offen offset:0 lds
buffer_load_dwordx4 v9, s[8:11], s88 offen offset:1024 lds
buffer_load_dwordx4 v10, s[8:11], s88 offen offset:2048 lds
s_add_u32 s88, s88, 110592
s_cmp_ge_u32 s65, 24
s_cbranch_scc0 slow_173
bk_172:
s_mov_b32 m0, 27904
s_getreg_b32 s69, hwreg(HW_REG_IB_STS)
buffer_load_dwordx4 v8, s[8:11], s88 offen offset:0 lds
s_and_b32 s70, s69, 15
buffer_load_dwordx4 v9, s[8:11], s88 offen offset:1024 lds
s_bfe_u32 s71, s69, 0x20016
buffer_load_dwordx4 v10, s[8:11], s88 offen offset:2048 lds
s_add_u32 s88, s88, 110592
s_cmp_eq_u32 s88, s87
s_cselect_b32 s88, s89, s88
s_lshl4_add_u32 s70, s71, s70
s_sub_u32 s70, 123, s70
v_mov_b32 v40, s70
ds_write_b32 v30, v40 offset:0
s_cmp_ge_u32 s65, 25
s_cbranch_scc0 slow_175
bk_174:
s_mov_b32 m0, 30976
s_nop 0
buffer_load_dwordx4 v8, s[8:11], s88 offen offset:0 lds
buffer_load_dwordx4 v9, s[8:11], s88 offen offset:1024 lds
buffer_load_dwordx4 v10, s[8:11], s88 offen offset:2048 lds
s_add_u32 s88, s88, 110592
s_cmp_ge_u32 s65, 26
s_cbranch_scc0 slow_177
bk_176:
s_mov_b32 m0, 34048
s_nop 0
buffer_load_dwordx4 v8, s[8:11], s88 offen offset:0 lds
buffer_load_dwordx4 v9, s[8:11], s88 offen offset:1024 lds
buffer_load_dwordx4 v10, s[8:11], s88 offen offset:2048 lds
s_add_u32 s88, s88, 110592
s_cmp_eq_u32 s88, s87
s_cselect_b32 s88, s89, s88
s_cmp_ge_u32 s65, 27
s_cbranch_scc0 slow_179
bk_178:
s_mov_b32 m0, 37120
s_getreg_b32 s69, hwreg(HW_REG_IB_STS)
buffer_load_dwordx4 v8, s[8:11], s88 offen offset:0 lds
s_and_b32 s70, s69, 15
buffer_load_dwordx4 v9, s[8:11], s88 offen offset:1024 lds
s_bfe_u32 s71, s69, 0x20016
buffer_load_dwordx4 v10, s[8:11], s88 offen offset:2048 lds
s_add_u32 s88, s88, 110592
s_lshl4_add_u32 s70, s71, s70
s_sub_u32 s70, 132, s70
v_mov_b32 v40, s70
ds_write_b32 v30, v40 offset:0
s_cmp_ge_u32 s65, 28
s_cbranch_scc0 slow_181
bk_180:
s_mov_b32 m0, 40192
s_nop 0
buffer_load_dwordx4 v8, s[8:11], s88 offen offset:0 lds
buffer_load_dwordx4 v9, s[8:11], s88 offen offset:1024 lds
buffer_load_dwordx4 v10, s[8:11], s88 offen offset:2048 lds
s_add_u32 s88, s88, 110592
s_cmp_eq_u32 s88, s87
s_cselect_b32 s88, s89, s88
s_cmp_ge_u32 s65, 29
s_cbranch_scc0 slow_183
bk_182:
s_mov_b32 m0, 256
s_nop 0
buffer_load_dwordx4 v8, s[8:11], s88 offen offset:0 lds
buffer_load_dwordx4 v9, s[8:11], s88 offen offset:1024 lds
buffer_load_dwordx4 v10, s[8:11], s88 offen offset:2048 lds
s_add_u32 s88, s88, 110592
s_cmp_ge_u32 s65, 30
s_cbranch_scc0 slow_185
bk_184:
s_mov_b32 m0, 3328
s_getreg_b32 s69, hwreg(HW_REG_IB_STS)
buffer_load_dwordx4 v8, s[8:11], s88 offen offset:0 lds
s_and_b32 s70, s69, 15
buffer_load_dwordx4 v9, s[8:11], s88 offen offset:1024 lds
s_bfe_u32 s71, s69, 0x20016
buffer_load_dwordx4 v10, s[8:11], s88 offen offset:2048 lds
s_add_u32 s88, s88, 110592
s_cmp_eq_u32 s88, s87
s_cselect_b32 s88, s89, s88
s_lshl4_add_u32 s70, s71, s70
s_sub_u32 s70, 141, s70
v_mov_b32 v40, s70
ds_write_b32 v30, v40 offset:0
s_cmp_ge_u32 s65, 31
s_cbranch_scc0 slow_187
bk_186:
s_mov_b32 m0, 6400
s_nop 0
buffer_load_dwordx4 v8, s[8:11], s88 offen offset:0 lds
buffer_load_dwordx4 v9, s[8:11], s88 offen offset:1024 lds
buffer_load_dwordx4 v10, s[8:11], s88 offen offset:2048 lds
s_add_u32 s88, s88, 110592
s_cmp_ge_u32 s65, 32
s_cbranch_scc0 slow_189
bk_188:
s_mov_b32 m0, 9472
s_nop 0
buffer_load_dwordx4 v8, s[8:11], s88 offen offset:0 lds
buffer_load_dwordx4 v9, s[8:11], s88 offen offset:1024 lds
buffer_load_dwordx4 v10, s[8:11], s88 offen offset:2048 lds
s_add_u32 s88, s88, 110592
s_cmp_eq_u32 s88, s87
s_cselect_b32 s88, s89, s88
s_cmp_ge_u32 s65, 33
s_cbranch_scc0 slow_191
bk_190:
s_mov_b32 m0, 52480
s_getreg_b32 s69, hwreg(HW_REG_IB_STS)
buffer_load_dwordx4 v8, s[8:11], s88 offen offset:0 lds
s_and_b32 s70, s69, 15
buffer_load_dwordx4 v9, s[8:11], s88 offen offset:1024 lds
s_bfe_u32 s71, s69, 0x20016
buffer_load_dwordx4 v10, s[8:11], s88 offen offset:2048 lds
s_add_u32 s88, s88, 110592
s_lshl4_add_u32 s70, s71, s70
s_sub_u32 s70, 150, s70
v_mov_b32 v40, s70
ds_write_b32 v30, v40 offset:0
s_cmp_ge_u32 s65, 34
s_cbranch_scc0 slow_193
bk_192:
s_mov_b32 m0, 64768
s_nop 0
buffer_load_dwordx4 v8, s[8:11], s88 offen offset:0 lds
buffer_load_dwordx4 v9, s[8:11], s88 offen offset:1024 lds
buffer_load_dwordx4 v10, s[8:11], s88 offen offset:2048 lds
s_add_u32 s88, s88, 110592
s_cmp_eq_u32 s88, s87
s_cselect_b32 s88, s89, s88
s_cmp_ge_u32 s65, 35
s_cbranch_scc0 slow_195
bk_194:
s_mov_b32 m0, 77056
s_nop 0
buffer_load_dwordx4 v8, s[8:11], s88 offen offset:0 lds
buffer_load_dwordx4 v9, s[8:11], s88 offen offset:1024 lds
buffer_load_dwordx4 v10, s[8:11], s88 offen offset:2048 lds
s_add_u32 s88, s88, 110592
s_cmp_ge_u32 s65, 36
s_cbranch_scc0 slow_197
bk_196:
s_mov_b32 m0, 89344
s_getreg_b32 s69, hwreg(HW_REG_IB_STS)
buffer_load_dwordx4 v8, s[8:11], s88 offen offset:0 lds
s_and_b32 s70, s69, 15
buffer_load_dwordx4 v9, s[8:11], s88 offen offset:1024 lds
s_bfe_u32 s71, s69, 0x20016
buffer_load_dwordx4 v10, s[8:11], s88 offen offset:2048 lds
s_add_u32 s88, s88, 110592
s_cmp_eq_u32 s88, s87
s_cselect_b32 s88, s89, s88
s_lshl4_add_u32 s70, s71, s70
s_sub_u32 s70, 159, s70
v_mov_b32 v40, s70
ds_write_b32 v30, v40 offset:0
v_add_u32 v2, 0, v0
v_mul_u32_u24 v3, 6554, v2
v_lshrrev_b32 v3, 16, v3
v_mul_u32_u24 v4, 10, v3
v_sub_u32 v4, v2, v4
v_lshrrev_b32 v6, 2, v3
v_lshrrev_b32 v5, 3, v3
v_xor_b32 v6, v6, v5
v_and_b32 v6, 1, v6
v_mul_u32_u24 v6, 12, v6
v_xor_b32 v5, v3, v6
v_lshrrev_b32 v6, 3, v5
v_and_b32 v7, 7, v5
v_and_b32 v22, 3, v7
v_mul_u32_u24 v23, 3, v6
v_add_u32 v23, v23, v22
v_lshlrev_b32 v24, 1, v6
v_add_u32 v24, 12, v24
v_min_u32 v24, 17, v24
v_add_u32 v25, 12, v6
v_cmp_eq_u32 s[90:91], 3, v6
v_mov_b32 v26, 16
s_nop 0
v_cndmask_b32 v25, v25, v26, s[90:91]
v_cmp_lt_u32 s[90:91], 3, v7
s_nop 1
v_cndmask_b32 v24, v24, v25, s[90:91]
v_cmp_eq_u32 s[90:91], 3, v22
s_nop 1
v_cndmask_b32 v23, v23, v24, s[90:91]
v_lshrrev_b32 v24, 2, v7
v_mul_u32_u24 v24, 18, v24
v_add_u32 v23, v23, v24
v_mul_u32_u24 v23, 1152, v23
v_lshlrev_b32 v24, 4, v4
v_add_u32 v23, v23, v24
v_mov_b32 v26, 0x40000000
v_cmp_gt_u32 s[92:93], 9, v4
s_nop 1
v_cndmask_b32 v12, v26, v23, s[92:93]
v_and_b32 v27, 3, v7
v_lshlrev_b32 v23, 1, v27
v_add_u32 v23, 13, v23
v_lshrrev_b32 v25, 1, v27
v_mul_u32_u24 v25, 16, v25
v_add_u32 v23, v23, v25
v_lshrrev_b32 v25, 2, v7
v_lshl_add_u32 v25, v6, 1, v25
v_add_u32 v25, s99, v25
v_and_b32 v25, 15, v25
v_mul_u32_u24 v22, 36, v25
v_add_u32 v22, v23, v22
v_mul_u32_u24 v22, 1152, v22
v_add_u32 v22, v22, v24
v_cndmask_b32 v17, v26, v22, s[92:93]
v_xor_b32 v25, 8, v25
v_mul_u32_u24 v22, 36, v25
v_add_u32 v22, v23, v22
v_mul_u32_u24 v22, 1152, v22
v_add_u32 v22, v22, v24
v_cndmask_b32 v52, v26, v22, s[92:93]
v_add_u32 v2, 64, v0
v_mul_u32_u24 v3, 6554, v2
v_lshrrev_b32 v3, 16, v3
v_mul_u32_u24 v4, 10, v3
v_sub_u32 v4, v2, v4
v_lshrrev_b32 v6, 2, v3
v_lshrrev_b32 v5, 3, v3
v_xor_b32 v6, v6, v5
v_and_b32 v6, 1, v6
v_mul_u32_u24 v6, 12, v6
v_xor_b32 v5, v3, v6
v_lshrrev_b32 v6, 3, v5
v_and_b32 v7, 7, v5
v_and_b32 v22, 3, v7
v_mul_u32_u24 v23, 3, v6
s_getreg_b32 s69, hwreg(HW_REG_IB_STS)
s_and_b32 s70, s69, 15
s_bfe_u32 s71, s69, 0x20016
s_lshl4_add_u32 s70, s71, s70
s_sub_u32 s70, 162, s70
v_mov_b32 v40, s70
ds_write_b32 v30, v40 offset:0
v_add_u32 v23, v23, v22
v_lshlrev_b32 v24, 1, v6
v_add_u32 v24, 12, v24
v_min_u32 v24, 17, v24
v_add_u32 v25, 12, v6
v_cmp_eq_u32 s[90:91], 3, v6
v_mov_b32 v26, 16
s_nop 0
v_cndmask_b32 v25, v25, v26, s[90:91]
v_cmp_lt_u32 s[90:91], 3, v7
s_nop 1
v_cndmask_b32 v24, v24, v25, s[90:91]
v_cmp_eq_u32 s[90:91], 3, v22
s_nop 1
v_cndmask_b32 v23, v23, v24, s[90:91]
v_lshrrev_b32 v24, 2, v7
v_mul_u32_u24 v24, 18, v24
v_add_u32 v23, v23, v24
v_mul_u32_u24 v23, 1152, v23
v_lshlrev_b32 v24, 4, v4
v_add_u32 v23, v23, v24
v_mov_b32 v26, 0x40000000
v_cmp_gt_u32 s[92:93], 9, v4
s_nop 1
v_cndmask_b32 v13, v26, v23, s[92:93]
v_and_b32 v27, 3, v7
v_lshlrev_b32 v23, 1, v27
v_add_u32 v23, 13, v23
v_lshrrev_b32 v25, 1, v27
v_mul_u32_u24 v25, 16, v25
v_add_u32 v23, v23, v25
v_lshrrev_b32 v25, 2, v7
v_lshl_add_u32 v25, v6, 1, v25
v_add_u32 v25, s99, v25
v_and_b32 v25, 15, v25
v_mul_u32_u24 v22, 36, v25
v_add_u32 v22, v23, v22
v_mul_u32_u24 v22, 1152, v22
v_add_u32 v22, v22, v24
v_cndmask_b32 v18, v26, v22, s[92:93]
v_xor_b32 v25, 8, v25
v_mul_u32_u24 v22, 36, v25
v_add_u32 v22, v23, v22
v_mul_u32_u24 v22, 1152, v22
v_add_u32 v22, v22, v24
v_cndmask_b32 v53, v26, v22, s[92:93]
v_add_u32 v2, 128, v0
v_mul_u32_u24 v3, 6554, v2
v_lshrrev_b32 v3, 16, v3
v_mul_u32_u24 v4, 10, v3
v_sub_u32 v4, v2, v4
v_lshrrev_b32 v6, 2, v3
v_lshrrev_b32 v5, 3, v3
v_xor_b32 v6, v6, v5
v_and_b32 v6, 1, v6
v_mul_u32_u24 v6, 12, v6
v_xor_b32 v5, v3, v6
v_lshrrev_b32 v6, 3, v5
v_and_b32 v7, 7, v5
v_and_b32 v22, 3, v7
v_mul_u32_u24 v23, 3, v6
v_add_u32 v23, v23, v22
v_lshlrev_b32 v24, 1, v6
v_add_u32 v24, 12, v24
v_min_u32 v24, 17, v24
v_add_u32 v25, 12, v6
v_cmp_eq_u32 s[90:91], 3, v6
v_mov_b32 v26, 16
s_nop 0
v_cndmask_b32 v25, v25, v26, s[90:91]
v_cmp_lt_u32 s[90:91], 3, v7
s_nop 1
v_cndmask_b32 v24, v24, v25, s[90:91]
v_cmp_eq_u32 s[90:91], 3, v22
s_nop 1
v_cndmask_b32 v23, v23, v24, s[90:91]
v_lshrrev_b32 v24, 2, v7
v_mul_u32_u24 v24, 18, v24
v_add_u32 v23, v23, v24
s_getreg_b32 s69, hwreg(HW_REG_IB_STS)
s_and_b32 s70, s69, 15
s_bfe_u32 s71, s69, 0x20016
s_lshl4_add_u32 s70, s71, s70
s_sub_u32 s70, 162, s70
v_mov_b32 v40, s70
ds_write_b32 v30, v40 offset:0
v_mul_u32_u24 v23, 1152, v23
v_lshlrev_b32 v24, 4, v4
v_add_u32 v23, v23, v24
v_mov_b32 v26, 0x40000000
v_cmp_gt_u32 s[92:93], 9, v4
s_nop 1
v_cndmask_b32 v14, v26, v23, s[92:93]
v_and_b32 v27, 3, v7
v_lshlrev_b32 v23, 1, v27
v_add_u32 v23, 13, v23
v_lshrrev_b32 v25, 1, v27
v_mul_u32_u24 v25, 16, v25
v_add_u32 v23, v23, v25
v_lshrrev_b32 v25, 2, v7
v_lshl_add_u32 v25, v6, 1, v25
v_add_u32 v25, s99, v25
v_and_b32 v25, 15, v25
v_mul_u32_u24 v22, 36, v25
v_add_u32 v22, v23, v22
v_mul_u32_u24 v22, 1152, v22
v_add_u32 v22, v22, v24
v_cndmask_b32 v19, v26, v22, s[92:93]
v_xor_b32 v25, 8, v25
v_mul_u32_u24 v22, 36, v25
v_add_u32 v22, v23, v22
v_mul_u32_u24 v22, 1152, v22
v_add_u32 v22, v22, v24
v_cndmask_b32 v54, v26, v22, s[92:93]
v_add_u32 v2, 192, v0
v_mul_u32_u24 v3, 6554, v2
v_lshrrev_b32 v3, 16, v3
v_mul_u32_u24 v4, 10, v3
v_sub_u32 v4, v2, v4
v_lshrrev_b32 v6, 2, v3
v_lshrrev_b32 v5, 3, v3
v_xor_b32 v6, v6, v5
v_and_b32 v6, 1, v6
v_mul_u32_u24 v6, 12, v6
v_xor_b32 v5, v3, v6
v_lshrrev_b32 v6, 3, v5
v_and_b32 v7, 7, v5
v_and_b32 v22, 3, v7
v_mul_u32_u24 v23, 3, v6
v_add_u32 v23, v23, v22
v_lshlrev_b32 v24, 1, v6
v_add_u32 v24, 12, v24
v_min_u32 v24, 17, v24
v_add_u32 v25, 12, v6
v_cmp_eq_u32 s[90:91], 3, v6
v_mov_b32 v26, 16
s_nop 0
v_cndmask_b32 v25, v25, v26, s[90:91]
v_cmp_lt_u32 s[90:91], 3, v7
s_nop 1
v_cndmask_b32 v24, v24, v25, s[90:91]
v_cmp_eq_u32 s[90:91], 3, v22
s_nop 1
v_cndmask_b32 v23, v23, v24, s[90:91]
v_lshrrev_b32 v24, 2, v7
v_mul_u32_u24 v24, 18, v24
v_add_u32 v23, v23, v24
v_mul_u32_u24 v23, 1152, v23
v_lshlrev_b32 v24, 4, v4
v_add_u32 v23, v23, v24
v_mov_b32 v26, 0x40000000
v_cmp_gt_u32 s[92:93], 9, v4
s_nop 1
v_cndmask_b32 v15, v26, v23, s[92:93]
v_and_b32 v27, 3, v7
v_lshlrev_b32 v23, 1, v27
v_add_u32 v23, 13, v23
v_lshrrev_b32 v25, 1, v27
v_mul_u32_u24 v25, 16, v25
v_add_u32 v23, v23, v25
v_lshrrev_b32 v25, 2, v7
v_lshl_add_u32 v25, v6, 1, v25
v_add_u32 v25, s99, v25
s_getreg_b32 s69, hwreg(HW_REG_IB_STS)
s_and_b32 s70, s69, 15
s_bfe_u32 s71, s69, 0x20016
s_lshl4_add_u32 s70, s71, s70
s_sub_u32 s70, 162, s70
v_mov_b32 v40, s70
ds_write_b32 v30, v40 offset:0
v_and_b32 v25, 15, v25
v_mul_u32_u24 v22, 36, v25
v_add_u32 v22, v23, v22
v_mul_u32_u24 v22, 1152, v22
v_add_u32 v22, v22, v24
v_cndmask_b32 v20, v26, v22, s[92:93]
v_xor_b32 v25, 8, v25
v_mul_u32_u24 v22, 36, v25
v_add_u32 v22, v23, v22
v_mul_u32_u24 v22, 1152, v22
v_add_u32 v22, v22, v24
v_cndmask_b32 v55, v26, v22, s[92:93]
v_add_u32 v2, 256, v0
v_mul_u32_u24 v3, 6554, v2
v_lshrrev_b32 v3, 16, v3
v_mul_u32_u24 v4, 10, v3
v_sub_u32 v4, v2, v4
v_lshrrev_b32 v6, 2, v3
v_lshrrev_b32 v5, 3, v3
v_xor_b32 v6, v6, v5
v_and_b32 v6, 1, v6
v_mul_u32_u24 v6, 12, v6
v_xor_b32 v5, v3, v6
v_lshrrev_b32 v6, 3, v5
v_and_b32 v7, 7, v5
v_and_b32 v22, 3, v7
v_mul_u32_u24 v23, 3, v6
v_add_u32 v23, v23, v22
v_lshlrev_b32 v24, 1, v6
v_add_u32 v24, 12, v24
v_min_u32 v24, 17, v24
v_add_u32 v25, 12, v6
v_cmp_eq_u32 s[90:91], 3, v6
v_mov_b32 v26, 16
s_nop 0
v_cndmask_b32 v25, v25, v26, s[90:91]
v_cmp_lt_u32 s[90:91], 3, v7
s_nop 1
v_cndmask_b32 v24, v24, v25, s[90:91]
v_cmp_eq_u32 s[90:91], 3, v22
s_nop 1
v_cndmask_b32 v23, v23, v24, s[90:91]
v_lshrrev_b32 v24, 2, v7
v_mul_u32_u24 v24, 18, v24
v_add_u32 v23, v23, v24
v_mul_u32_u24 v23, 1152, v23
v_lshlrev_b32 v24, 4, v4
v_add_u32 v23, v23, v24
v_mov_b32 v26, 0x40000000
v_cmp_gt_u32 s[92:93], 9, v4
s_nop 1
v_cndmask_b32 v16, v26, v23, s[92:93]
v_and_b32 v27, 3, v7
v_lshlrev_b32 v23, 1, v27
v_add_u32 v23, 13, v23
v_lshrrev_b32 v25, 1, v27
v_mul_u32_u24 v25, 16, v25
v_add_u32 v23, v23, v25
v_lshrrev_b32 v25, 2, v7
v_lshl_add_u32 v25, v6, 1, v25
v_add_u32 v25, s99, v25
v_and_b32 v25, 15, v25
v_mul_u32_u24 v22, 36, v25
v_add_u32 v22, v23, v22
v_mul_u32_u24 v22, 1152, v22
v_add_u32 v22, v22, v24
v_cndmask_b32 v21, v26, v22, s[92:93]
v_xor_b32 v25, 8, v25
v_mul_u32_u24 v22, 36, v25
v_add_u32 v22, v23, v22
v_mul_u32_u24 v22, 1152, v22
v_add_u32 v22, v22, v24
v_cndmask_b32 v56, v26, v22, s[92:93]
s_getreg_b32 s69, hwreg(HW_REG_IB_STS)
s_and_b32 s70, s69, 15
s_bfe_u32 s71, s69, 0x20016
s_lshl4_add_u32 s70, s71, s70
s_sub_u32 s70, 162, s70
v_mov_b32 v40, s70
ds_write_b32 v30, v40 offset:0
s_cmp_ge_u32 s65, 37
s_cbranch_scc0 slow_199
bk_198:
s_add_u32 s68, s99, 9
s_and_b32 s68, s68, 15
s_mul_i32 s68, s68, 41472
s_add_u32 s68, s68, s81
s_waitcnt vmcnt(50)
s_mov_b32 m0, 46336
s_getreg_b32 s69, hwreg(HW_REG_IB_STS)
buffer_load_dwordx4 v12, s[24:27], s68 offen lds
s_mov_b32 m0, 47360
s_and_b32 s70, s69, 15
buffer_load_dwordx4 v13, s[24:27], s68 offen lds
s_mov_b32 m0, 48384
s_bfe_u32 s71, s69, 0x20016
buffer_load_dwordx4 v14, s[24:27], s68 offen lds
s_mov_b32 m0, 49408
s_nop 0
buffer_load_dwordx4 v15, s[24:27], s68 offen lds
s_mov_b32 m0, 50432
s_nop 0
buffer_load_dwordx4 v16, s[24:27], s68 offen lds
s_lshl4_add_u32 s70, s71, s70
s_sub_u32 s70, 162, s70
v_mov_b32 v40, s70
ds_write_b32 v30, v40 offset:0
s_add_u32 s68, s99, 11
s_and_b32 s68, s68, 15
s_mul_i32 s68, s68, 41472
s_add_u32 s68, s68, s81
s_waitcnt vmcnt(50)
s_mov_b32 m0, 56576
s_getreg_b32 s69, hwreg(HW_REG_IB_STS)
buffer_load_dwordx4 v12, s[24:27], s68 offen lds
s_mov_b32 m0, 57600
s_and_b32 s70, s69, 15
buffer_load_dwordx4 v13, s[24:27], s68 offen lds
s_mov_b32 m0, 58624
s_bfe_u32 s71, s69, 0x20016
buffer_load_dwordx4 v14, s[24:27], s68 offen lds
s_mov_b32 m0, 59648
s_nop 0
buffer_load_dwordx4 v15, s[24:27], s68 offen lds
s_mov_b32 m0, 60672
s_nop 0
buffer_load_dwordx4 v16, s[24:27], s68 offen lds
s_lshl4_add_u32 s70, s71, s70
s_sub_u32 s70, 167, s70
v_mov_b32 v40, s70
ds_write_b32 v30, v40 offset:0
s_add_u32 s68, s99, 14
s_and_b32 s68, s68, 15
s_mul_i32 s68, s68, 41472
s_add_u32 s68, s68, s81
s_waitcnt vmcnt(50)
s_mov_b32 m0, 71936
s_getreg_b32 s69, hwreg(HW_REG_IB_STS)
buffer_load_dwordx4 v12, s[24:27], s68 offen lds
s_mov_b32 m0, 72960
s_and_b32 s70, s69, 15
buffer_load_dwordx4 v13, s[24:27], s68 offen lds
s_mov_b32 m0, 73984
s_bfe_u32 s71, s69, 0x20016
buffer_load_dwordx4 v14, s[24:27], s68 offen lds
s_mov_b32 m0, 75008
s_nop 0
buffer_load_dwordx4 v15, s[24:27], s68 offen lds
s_mov_b32 m0, 76032
s_nop 0
buffer_load_dwordx4 v16, s[24:27], s68 offen lds
s_lshl4_add_u32 s70, s71, s70
s_sub_u32 s70, 172, s70
v_mov_b32 v40, s70
ds_write_b32 v30, v40 offset:0
s_mov_b32 s68, s81
s_waitcnt vmcnt(50)
s_mov_b32 m0, 82176
s_getreg_b32 s69, hwreg(HW_REG_IB_STS)
buffer_load_dwordx4 v17, s[24:27], s68 offen lds
s_mov_b32 m0, 83200
s_and_b32 s70, s69, 15
buffer_load_dwordx4 v18, s[24:27], s68 offen lds
s_mov_b32 m0, 84224
s_bfe_u32 s71, s69, 0x20016
buffer_load_dwordx4 v19, s[24:27], s68 offen lds
s_mov_b32 m0, 85248
s_nop 0
buffer_load_dwordx4 v20, s[24:27], s68 offen lds
s_mov_b32 m0, 86272
s_nop 0
buffer_load_dwordx4 v21, s[24:27], s68 offen lds
s_lshl4_add_u32 s70, s71, s70
s_sub_u32 s70, 177, s70
v_mov_b32 v40, s70
ds_write_b32 v30, v40 offset:0
s_cmp_ge_u32 s65, 55
s_cbranch_scc0 slow_201
bk_200:
s_add_u32 s68, s99, 0
s_and_b32 s68, s68, 15
s_mul_i32 s68, s68, 41472
s_add_u32 s68, s68, s81
s_waitcnt vmcnt(50)
s_mov_b32 m0, 256
s_getreg_b32 s69, hwreg(HW_REG_IB_STS)
buffer_load_dwordx4 v12, s[24:27], s68 offen lds
s_mov_b32 m0, 1280
s_and_b32 s70, s69, 15
buffer_load_dwordx4 v13, s[24:27], s68 offen lds
s_mov_b32 m0, 2304
s_bfe_u32 s71, s69, 0x20016
buffer_load_dwordx4 v14, s[24:27], s68 offen lds
s_mov_b32 m0, 3328
s_nop 0
buffer_load_dwordx4 v15, s[24:27], s68 offen lds
s_mov_b32 m0, 4352
s_nop 0
buffer_load_dwordx4 v16, s[24:27], s68 offen lds
s_lshl4_add_u32 s70, s71, s70
s_sub_u32 s70, 182, s70
v_mov_b32 v40, s70
ds_write_b32 v30, v40 offset:0
s_add_u32 s68, s99, 1
s_and_b32 s68, s68, 15
s_mul_i32 s68, s68, 41472
s_add_u32 s68, s68, s81
s_waitcnt vmcnt(50)
s_mov_b32 m0, 5376
s_getreg_b32 s69, hwreg(HW_REG_IB_STS)
buffer_load_dwordx4 v12, s[24:27], s68 offen lds
s_mov_b32 m0, 6400
s_and_b32 s70, s69, 15
buffer_load_dwordx4 v13, s[24:27], s68 offen lds
s_mov_b32 m0, 7424
s_bfe_u32 s71, s69, 0x20016
buffer_load_dwordx4 v14, s[24:27], s68 offen lds
s_mov_b32 m0, 8448
s_nop 0
buffer_load_dwordx4 v15, s[24:27], s68 offen lds
s_mov_b32 m0, 9472
s_nop 0
buffer_load_dwordx4 v16, s[24:27], s68 offen lds
s_lshl4_add_u32 s70, s71, s70
s_sub_u32 s70, 187, s70
v_mov_b32 v40, s70
ds_write_b32 v30, v40 offset:0
s_add_u32 s68, s99, 2
s_and_b32 s68, s68, 15
s_mul_i32 s68, s68, 41472
s_add_u32 s68, s68, s81
s_waitcnt vmcnt(50)
s_mov_b32 m0, 10496
s_getreg_b32 s69, hwreg(HW_REG_IB_STS)
buffer_load_dwordx4 v12, s[24:27], s68 offen lds
s_mov_b32 m0, 11520
s_and_b32 s70, s69, 15
buffer_load_dwordx4 v13, s[24:27], s68 offen lds
s_mov_b32 m0, 12544
s_bfe_u32 s71, s69, 0x20016
buffer_load_dwordx4 v14, s[24:27], s68 offen lds
s_mov_b32 m0, 13568
s_nop 0
buffer_load_dwordx4 v15, s[24:27], s68 offen lds
s_mov_b32 m0, 14592
s_nop 0
buffer_load_dwordx4 v16, s[24:27], s68 offen lds
s_lshl4_add_u32 s70, s71, s70
s_sub_u32 s70, 192, s70
v_mov_b32 v40, s70
ds_write_b32 v30, v40 offset:0
s_add_u32 s68, s99, 3
s_and_b32 s68, s68, 15
s_mul_i32 s68, s68, 41472
s_add_u32 s68, s68, s81
s_waitcnt vmcnt(50)
s_mov_b32 m0, 15616
s_getreg_b32 s69, hwreg(HW_REG_IB_STS)
buffer_load_dwordx4 v12, s[24:27], s68 offen lds
s_mov_b32 m0, 16640
s_and_b32 s70, s69, 15
buffer_load_dwordx4 v13, s[24:27], s68 offen lds
s_mov_b32 m0, 17664
s_bfe_u32 s71, s69, 0x20016
buffer_load_dwordx4 v14, s[24:27], s68 offen lds
s_mov_b32 m0, 18688
s_nop 0
buffer_load_dwordx4 v15, s[24:27], s68 offen lds
s_mov_b32 m0, 19712
s_nop 0
buffer_load_dwordx4 v16, s[24:27], s68 offen lds
s_lshl4_add_u32 s70, s71, s70
s_sub_u32 s70, 197, s70
v_mov_b32 v40, s70
ds_write_b32 v30, v40 offset:0
s_add_u32 s68, s99, 4
s_and_b32 s68, s68, 15
s_mul_i32 s68, s68, 41472
s_add_u32 s68, s68, s81
s_waitcnt vmcnt(50)
s_mov_b32 m0, 20736
s_getreg_b32 s69, hwreg(HW_REG_IB_STS)
buffer_load_dwordx4 v12, s[24:27], s68 offen lds
s_mov_b32 m0, 21760
s_and_b32 s70, s69, 15
buffer_load_dwordx4 v13, s[24:27], s68 offen lds
s_mov_b32 m0, 22784
s_bfe_u32 s71, s69, 0x20016
buffer_load_dwordx4 v14, s[24:27], s68 offen lds
s_mov_b32 m0, 23808
s_nop 0
buffer_load_dwordx4 v15, s[24:27], s68 offen lds
s_mov_b32 m0, 24832
s_nop 0
buffer_load_dwordx4 v16, s[24:27], s68 offen lds
s_lshl4_add_u32 s70, s71, s70
s_sub_u32 s70, 202, s70
v_mov_b32 v40, s70
ds_write_b32 v30, v40 offset:0
s_add_u32 s68, s99, 5
s_and_b32 s68, s68, 15
s_mul_i32 s68, s68, 41472
s_add_u32 s68, s68, s81
s_waitcnt vmcnt(50)
s_mov_b32 m0, 25856
s_getreg_b32 s69, hwreg(HW_REG_IB_STS)
buffer_load_dwordx4 v12, s[24:27], s68 offen lds
s_mov_b32 m0, 26880
s_and_b32 s70, s69, 15
buffer_load_dwordx4 v13, s[24:27], s68 offen lds
s_mov_b32 m0, 27904
s_bfe_u32 s71, s69, 0x20016
buffer_load_dwordx4 v14, s[24:27], s68 offen lds
s_mov_b32 m0, 28928
s_nop 0
buffer_load_dwordx4 v15, s[24:27], s68 offen lds
s_mov_b32 m0, 29952
s_nop 0
buffer_load_dwordx4 v16, s[24:27], s68 offen lds
s_lshl4_add_u32 s70, s71, s70
s_sub_u32 s70, 207, s70
v_mov_b32 v40, s70
ds_write_b32 v30, v40 offset:0
s_add_u32 s68, s99, 6
s_and_b32 s68, s68, 15
s_mul_i32 s68, s68, 41472
s_add_u32 s68, s68, s81
s_waitcnt vmcnt(50)
s_mov_b32 m0, 30976
s_getreg_b32 s69, hwreg(HW_REG_IB_STS)
buffer_load_dwordx4 v12, s[24:27], s68 offen lds
s_mov_b32 m0, 32000
s_and_b32 s70, s69, 15
buffer_load_dwordx4 v13, s[24:27], s68 offen lds
s_mov_b32 m0, 33024
s_bfe_u32 s71, s69, 0x20016
buffer_load_dwordx4 v14, s[24:27], s68 offen lds
s_mov_b32 m0, 34048
s_nop 0
buffer_load_dwordx4 v15, s[24:27], s68 offen lds
s_mov_b32 m0, 35072
s_nop 0
buffer_load_dwordx4 v16, s[24:27], s68 offen lds
s_lshl4_add_u32 s70, s71, s70
s_sub_u32 s70, 212, s70
v_mov_b32 v40, s70
ds_write_b32 v30, v40 offset:0
s_add_u32 s68, s99, 7
s_and_b32 s68, s68, 15
s_mul_i32 s68, s68, 41472
s_add_u32 s68, s68, s81
s_waitcnt vmcnt(50)
s_mov_b32 m0, 36096
s_getreg_b32 s69, hwreg(HW_REG_IB_STS)
buffer_load_dwordx4 v12, s[24:27], s68 offen lds
s_mov_b32 m0, 37120
s_and_b32 s70, s69, 15
buffer_load_dwordx4 v13, s[24:27], s68 offen lds
s_mov_b32 m0, 38144
s_bfe_u32 s71, s69, 0x20016
buffer_load_dwordx4 v14, s[24:27], s68 offen lds
s_mov_b32 m0, 39168
s_nop 0
buffer_load_dwordx4 v15, s[24:27], s68 offen lds
s_mov_b32 m0, 40192
s_nop 0
buffer_load_dwordx4 v16, s[24:27], s68 offen lds
s_lshl4_add_u32 s70, s71, s70
s_sub_u32 s70, 217, s70
v_mov_b32 v40, s70
ds_write_b32 v30, v40 offset:0
s_add_u32 s68, s99, 8
s_and_b32 s68, s68, 15
s_mul_i32 s68, s68, 41472
s_add_u32 s68, s68, s81
s_waitcnt vmcnt(50)
s_mov_b32 m0, 41216
s_getreg_b32 s69, hwreg(HW_REG_IB_STS)
buffer_load_dwordx4 v12, s[24:27], s68 offen lds
s_mov_b32 m0, 42240
s_and_b32 s70, s69, 15
buffer_load_dwordx4 v13, s[24:27], s68 offen lds
s_mov_b32 m0, 43264
s_bfe_u32 s71, s69, 0x20016
buffer_load_dwordx4 v14, s[24:27], s68 offen lds
s_mov_b32 m0, 44288
s_nop 0
buffer_load_dwordx4 v15, s[24:27], s68 offen lds
s_mov_b32 m0, 45312
s_nop 0
buffer_load_dwordx4 v16, s[24:27], s68 offen lds
s_lshl4_add_u32 s70, s71, s70
s_sub_u32 s70, 222, s70
v_mov_b32 v40, s70
ds_write_b32 v30, v40 offset:0
s_add_u32 s68, s99, 10
s_and_b32 s68, s68, 15
s_mul_i32 s68, s68, 41472
s_add_u32 s68, s68, s81
s_waitcnt vmcnt(50)
s_mov_b32 m0, 51456
s_getreg_b32 s69, hwreg(HW_REG_IB_STS)
buffer_load_dwordx4 v12, s[24:27], s68 offen lds
s_mov_b32 m0, 52480
s_and_b32 s70, s69, 15
buffer_load_dwordx4 v13, s[24:27], s68 offen lds
s_mov_b32 m0, 53504
s_bfe_u32 s71, s69, 0x20016
buffer_load_dwordx4 v14, s[24:27], s68 offen lds
s_mov_b32 m0, 54528
s_nop 0
buffer_load_dwordx4 v15, s[24:27], s68 offen lds
s_mov_b32 m0, 55552
s_nop 0
buffer_load_dwordx4 v16, s[24:27], s68 offen lds
s_lshl4_add_u32 s70, s71, s70
s_sub_u32 s70, 227, s70
v_mov_b32 v40, s70
ds_write_b32 v30, v40 offset:0
s_add_u32 s68, s99, 12
s_and_b32 s68, s68, 15
s_mul_i32 s68, s68, 41472
s_add_u32 s68, s68, s81
s_waitcnt vmcnt(50)
s_mov_b32 m0, 61696
s_getreg_b32 s69, hwreg(HW_REG_IB_STS)
buffer_load_dwordx4 v12, s[24:27], s68 offen lds
s_mov_b32 m0, 62720
s_and_b32 s70, s69, 15
buffer_load_dwordx4 v13, s[24:27], s68 offen lds
s_mov_b32 m0, 63744
s_bfe_u32 s71, s69, 0x20016
buffer_load_dwordx4 v14, s[24:27], s68 offen lds
s_mov_b32 m0, 64768
s_nop 0
buffer_load_dwordx4 v15, s[24:27], s68 offen lds
s_mov_b32 m0, 65792
s_nop 0
buffer_load_dwordx4 v16, s[24:27], s68 offen lds
s_lshl4_add_u32 s70, s71, s70
s_sub_u32 s70, 232, s70
v_mov_b32 v40, s70
ds_write_b32 v30, v40 offset:0
s_add_u32 s68, s99, 13
s_and_b32 s68, s68, 15
s_mul_i32 s68, s68, 41472
s_add_u32 s68, s68, s81
s_waitcnt vmcnt(50)
s_mov_b32 m0, 66816
s_getreg_b32 s69, hwreg(HW_REG_IB_STS)
buffer_load_dwordx4 v12, s[24:27], s68 offen lds
s_mov_b32 m0, 67840
s_and_b32 s70, s69, 15
buffer_load_dwordx4 v13, s[24:27], s68 offen lds
s_mov_b32 m0, 68864
s_bfe_u32 s71, s69, 0x20016
buffer_load_dwordx4 v14, s[24:27], s68 offen lds
s_mov_b32 m0, 69888
s_nop 0
buffer_load_dwordx4 v15, s[24:27], s68 offen lds
s_mov_b32 m0, 70912
s_nop 0
buffer_load_dwordx4 v16, s[24:27], s68 offen lds
s_lshl4_add_u32 s70, s71, s70
s_sub_u32 s70, 237, s70
v_mov_b32 v40, s70
ds_write_b32 v30, v40 offset:0
s_add_u32 s68, s99, 15
s_and_b32 s68, s68, 15
s_mul_i32 s68, s68, 41472
s_add_u32 s68, s68, s81
s_waitcnt vmcnt(50)
s_mov_b32 m0, 77056
s_getreg_b32 s69, hwreg(HW_REG_IB_STS)
buffer_load_dwordx4 v12, s[24:27], s68 offen lds
s_mov_b32 m0, 78080
s_and_b32 s70, s69, 15
buffer_load_dwordx4 v13, s[24:27], s68 offen lds
s_mov_b32 m0, 79104
s_bfe_u32 s71, s69, 0x20016
buffer_load_dwordx4 v14, s[24:27], s68 offen lds
s_mov_b32 m0, 80128
s_nop 0
buffer_load_dwordx4 v15, s[24:27], s68 offen lds
s_mov_b32 m0, 81152
s_nop 0
buffer_load_dwordx4 v16, s[24:27], s68 offen lds
s_lshl4_add_u32 s70, s71, s70
s_sub_u32 s70, 242, s70
v_mov_b32 v40, s70
ds_write_b32 v30, v40 offset:0
s_mov_b32 s68, s81
s_waitcnt vmcnt(50)
s_mov_b32 m0, 87296
s_getreg_b32 s69, hwreg(HW_REG_IB_STS)
buffer_load_dwordx4 v52, s[24:27], s68 offen lds
s_mov_b32 m0, 88320
s_and_b32 s70, s69, 15
buffer_load_dwordx4 v53, s[24:27], s68 offen lds
s_mov_b32 m0, 89344
s_bfe_u32 s71, s69, 0x20016
buffer_load_dwordx4 v54, s[24:27], s68 offen lds
s_mov_b32 m0, 90368
s_nop 0
buffer_load_dwordx4 v55, s[24:27], s68 offen lds
s_mov_b32 m0, 91392
s_nop 0
buffer_load_dwordx4 v56, s[24:27], s68 offen lds
s_lshl4_add_u32 s70, s71, s70
s_sub_u32 s70, 247, s70
v_mov_b32 v40, s70
ds_write_b32 v30, v40 offset:0
v_and_b32 v100, 15, v0
v_lshrrev_b32 v101, 4, v0
v_lshrrev_b32 v102, 1, v101
v_lshlrev_b32 v102, 4, v102
v_and_b32 v103, 1, v101
v_lshlrev_b32 v103, 2, v103
v_add_u32 v102, v102, v103
v_lshrrev_b32 v103, 2, v100
v_add_u32 v102, v102, v103
v_mul_u32_u24 v102, 160, v102
v_and_b32 v103, 3, v100
v_lshlrev_b32 v103, 3, v103
v_add_u32 v102, v102, v103
v_add_u32 v100, 256, v102
v_add_u32 v101, 46080, v100
v_lshlrev_b32 v102, 4, v0
v_add_u32 v102, 256, v102
v_add_u32 v103, 46080, v102
s_setprio 1
s_waitcnt vmcnt(55)
ds_read_b64_tr_b16 v[60:61], v101 offset:0
ds_read_b64_tr_b16 v[62:63], v101 offset:1280
ds_read_b64_tr_b16 v[64:65], v101 offset:32
ds_read_b64_tr_b16 v[66:67], v101 offset:1312
ds_read_b64_tr_b16 v[68:69], v101 offset:64
ds_read_b64_tr_b16 v[70:71], v101 offset:1344
ds_read_b64_tr_b16 v[72:73], v101 offset:96
ds_read_b64_tr_b16 v[74:75], v101 offset:1376
ds_read_b64_tr_b16 v[76:77], v101 offset:128
ds_read_b64_tr_b16 v[78:79], v101 offset:1408
s_waitcnt lgkmcnt(0)
s_waitcnt vmcnt(55)
ds_read_b64_tr_b16 v[80:81], v101 offset:10240
ds_read_b64_tr_b16 v[82:83], v101 offset:11520
ds_read_b64_tr_b16 v[84:85], v101 offset:10272
ds_read_b64_tr_b16 v[86:87], v101 offset:11552
ds_read_b64_tr_b16 v[88:89], v101 offset:10304
ds_read_b64_tr_b16 v[90:91], v101 offset:11584
ds_read_b64_tr_b16 v[92:93], v101 offset:10336
ds_read_b64_tr_b16 v[94:95], v101 offset:11616
ds_read_b64_tr_b16 v[96:97], v101 offset:10368
ds_read_b64_tr_b16 v[98:99], v101 offset:11648
s_waitcnt lgkmcnt(10)
ds_write_b128 v103, v[60:63] offset:0
ds_write_b128 v103, v[64:67] offset:1024
ds_write_b128 v103, v[68:71] offset:2048
ds_write_b128 v103, v[72:75] offset:3072
ds_write_b128 v103, v[76:79] offset:4096
s_waitcnt lgkmcnt(5)
s_waitcnt vmcnt(55)
ds_read_b64_tr_b16 v[60:61], v101 offset:25600
ds_read_b64_tr_b16 v[62:63], v101 offset:26880
ds_read_b64_tr_b16 v[64:65], v101 offset:25632
ds_read_b64_tr_b16 v[66:67], v101 offset:26912
ds_read_b64_tr_b16 v[68:69], v101 offset:25664
ds_read_b64_tr_b16 v[70:71], v101 offset:26944
ds_read_b64_tr_b16 v[72:73], v101 offset:25696
ds_read_b64_tr_b16 v[74:75], v101 offset:26976
ds_read_b64_tr_b16 v[76:77], v101 offset:25728
ds_read_b64_tr_b16 v[78:79], v101 offset:27008
s_waitcnt lgkmcnt(10)
ds_write_b128 v103, v[80:83] offset:10240
ds_write_b128 v103, v[84:87] offset:11264
ds_write_b128 v103, v[88:91] offset:12288
ds_write_b128 v103, v[92:95] offset:13312
ds_write_b128 v103, v[96:99] offset:14336
s_waitcnt lgkmcnt(5)
s_waitcnt vmcnt(55)
ds_read_b64_tr_b16 v[80:81], v101 offset:35840
ds_read_b64_tr_b16 v[82:83], v101 offset:37120
ds_read_b64_tr_b16 v[84:85], v101 offset:35872
ds_read_b64_tr_b16 v[86:87], v101 offset:37152
ds_read_b64_tr_b16 v[88:89], v101 offset:35904
ds_read_b64_tr_b16 v[90:91], v101 offset:37184
ds_read_b64_tr_b16 v[92:93], v101 offset:35936
ds_read_b64_tr_b16 v[94:95], v101 offset:37216
ds_read_b64_tr_b16 v[96:97], v101 offset:35968
ds_read_b64_tr_b16 v[98:99], v101 offset:37248
s_waitcnt lgkmcnt(10)
ds_write_b128 v103, v[60:63] offset:25600
ds_write_b128 v103, v[64:67] offset:26624
ds_write_b128 v103, v[68:71] offset:27648
ds_write_b128 v103, v[72:75] offset:28672
ds_write_b128 v103, v[76:79] offset:29696
s_waitcnt lgkmcnt(5)
s_waitcnt vmcnt(55)
ds_read_b64_tr_b16 v[60:61], v100 offset:0
ds_read_b64_tr_b16 v[62:63], v100 offset:1280
ds_read_b64_tr_b16 v[64:65], v100 offset:32
ds_read_b64_tr_b16 v[66:67], v100 offset:1312
ds_read_b64_tr_b16 v[68:69], v100 offset:64
ds_read_b64_tr_b16 v[70:71], v100 offset:1344
ds_read_b64_tr_b16 v[72:73], v100 offset:96
ds_read_b64_tr_b16 v[74:75], v100 offset:1376
ds_read_b64_tr_b16 v[76:77], v100 offset:128
ds_read_b64_tr_b16 v[78:79], v100 offset:1408
s_waitcnt lgkmcnt(10)
ds_write_b128 v103, v[80:83] offset:35840
ds_write_b128 v103, v[84:87] offset:36864
ds_write_b128 v103, v[88:91] offset:37888
ds_write_b128 v103, v[92:95] offset:38912
ds_write_b128 v103, v[96:99] offset:39936
s_waitcnt lgkmcnt(5)
s_waitcnt vmcnt(55)
ds_read_b64_tr_b16 v[80:81], v100 offset:5120
ds_read_b64_tr_b16 v[82:83], v100 offset:6400
ds_read_b64_tr_b16 v[84:85], v100 offset:5152
ds_read_b64_tr_b16 v[86:87], v100 offset:6432
ds_read_b64_tr_b16 v[88:89], v100 offset:5184
ds_read_b64_tr_b16 v[90:91], v100 offset:6464
ds_read_b64_tr_b16 v[92:93], v100 offset:5216
ds_read_b64_tr_b16 v[94:95], v100 offset:6496
ds_read_b64_tr_b16 v[96:97], v100 offset:5248
ds_read_b64_tr_b16 v[98:99], v100 offset:6528
s_waitcnt lgkmcnt(10)
ds_write_b128 v102, v[60:63] offset:0
ds_write_b128 v102, v[64:67] offset:1024
ds_write_b128 v102, v[68:71] offset:2048
ds_write_b128 v102, v[72:75] offset:3072
ds_write_b128 v102, v[76:79] offset:4096
s_waitcnt lgkmcnt(5)
s_waitcnt vmcnt(55)
ds_read_b64_tr_b16 v[60:61], v100 offset:10240
ds_read_b64_tr_b16 v[62:63], v100 offset:11520
ds_read_b64_tr_b16 v[64:65], v100 offset:10272
ds_read_b64_tr_b16 v[66:67], v100 offset:11552
ds_read_b64_tr_b16 v[68:69], v100 offset:10304
ds_read_b64_tr_b16 v[70:71], v100 offset:11584
ds_read_b64_tr_b16 v[72:73], v100 offset:10336
ds_read_b64_tr_b16 v[74:75], v100 offset:11616
ds_read_b64_tr_b16 v[76:77], v100 offset:10368
ds_read_b64_tr_b16 v[78:79], v100 offset:11648
s_waitcnt lgkmcnt(10)
ds_write_b128 v102, v[80:83] offset:5120
ds_write_b128 v102, v[84:87] offset:6144
ds_write_b128 v102, v[88:91] offset:7168
ds_write_b128 v102, v[92:95] offset:8192
ds_write_b128 v102, v[96:99] offset:9216
s_waitcnt lgkmcnt(5)
s_waitcnt vmcnt(50)
ds_read_b64_tr_b16 v[80:81], v100 offset:15360
ds_read_b64_tr_b16 v[82:83], v100 offset:16640
ds_read_b64_tr_b16 v[84:85], v100 offset:15392
ds_read_b64_tr_b16 v[86:87], v100 offset:16672
ds_read_b64_tr_b16 v[88:89], v100 offset:15424
ds_read_b64_tr_b16 v[90:91], v100 offset:16704
ds_read_b64_tr_b16 v[92:93], v100 offset:15456
ds_read_b64_tr_b16 v[94:95], v100 offset:16736
ds_read_b64_tr_b16 v[96:97], v100 offset:15488
ds_read_b64_tr_b16 v[98:99], v100 offset:16768
s_waitcnt lgkmcnt(10)
ds_write_b128 v102, v[60:63] offset:10240
ds_write_b128 v102, v[64:67] offset:11264
ds_write_b128 v102, v[68:71] offset:12288
ds_write_b128 v102, v[72:75] offset:13312
ds_write_b128 v102, v[76:79] offset:14336
s_waitcnt lgkmcnt(5)
s_waitcnt vmcnt(45)
ds_read_b64_tr_b16 v[60:61], v100 offset:20480
ds_read_b64_tr_b16 v[62:63], v100 offset:21760
ds_read_b64_tr_b16 v[64:65], v100 offset:20512
ds_read_b64_tr_b16 v[66:67], v100 offset:21792
ds_read_b64_tr_b16 v[68:69], v100 offset:20544
ds_read_b64_tr_b16 v[70:71], v100 offset:21824
ds_read_b64_tr_b16 v[72:73], v100 offset:20576
ds_read_b64_tr_b16 v[74:75], v100 offset:21856
ds_read_b64_tr_b16 v[76:77], v100 offset:20608
ds_read_b64_tr_b16 v[78:79], v100 offset:21888
s_waitcnt lgkmcnt(10)
ds_write_b128 v102, v[80:83] offset:15360
ds_write_b128 v102, v[84:87] offset:16384
ds_write_b128 v102, v[88:91] offset:17408
ds_write_b128 v102, v[92:95] offset:18432
ds_write_b128 v102, v[96:99] offset:19456
s_waitcnt lgkmcnt(5)
s_waitcnt vmcnt(40)
ds_read_b64_tr_b16 v[80:81], v100 offset:25600
ds_read_b64_tr_b16 v[82:83], v100 offset:26880
ds_read_b64_tr_b16 v[84:85], v100 offset:25632
ds_read_b64_tr_b16 v[86:87], v100 offset:26912
ds_read_b64_tr_b16 v[88:89], v100 offset:25664
ds_read_b64_tr_b16 v[90:91], v100 offset:26944
ds_read_b64_tr_b16 v[92:93], v100 offset:25696
ds_read_b64_tr_b16 v[94:95], v100 offset:26976
ds_read_b64_tr_b16 v[96:97], v100 offset:25728
ds_read_b64_tr_b16 v[98:99], v100 offset:27008
s_waitcnt lgkmcnt(10)
ds_write_b128 v102, v[60:63] offset:20480
ds_write_b128 v102, v[64:67] offset:21504
ds_write_b128 v102, v[68:71] offset:22528
ds_write_b128 v102, v[72:75] offset:23552
ds_write_b128 v102, v[76:79] offset:24576
s_waitcnt lgkmcnt(5)
s_waitcnt vmcnt(35)
ds_read_b64_tr_b16 v[60:61], v100 offset:30720
ds_read_b64_tr_b16 v[62:63], v100 offset:32000
ds_read_b64_tr_b16 v[64:65], v100 offset:30752
ds_read_b64_tr_b16 v[66:67], v100 offset:32032
ds_read_b64_tr_b16 v[68:69], v100 offset:30784
ds_read_b64_tr_b16 v[70:71], v100 offset:32064
ds_read_b64_tr_b16 v[72:73], v100 offset:30816
ds_read_b64_tr_b16 v[74:75], v100 offset:32096
ds_read_b64_tr_b16 v[76:77], v100 offset:30848
ds_read_b64_tr_b16 v[78:79], v100 offset:32128
s_waitcnt lgkmcnt(10)
ds_write_b128 v102, v[80:83] offset:25600
ds_write_b128 v102, v[84:87] offset:26624
ds_write_b128 v102, v[88:91] offset:27648
ds_write_b128 v102, v[92:95] offset:28672
ds_write_b128 v102, v[96:99] offset:29696
s_waitcnt lgkmcnt(5)
s_waitcnt vmcnt(30)
ds_read_b64_tr_b16 v[80:81], v100 offset:35840
ds_read_b64_tr_b16 v[82:83], v100 offset:37120
ds_read_b64_tr_b16 v[84:85], v100 offset:35872
ds_read_b64_tr_b16 v[86:87], v100 offset:37152
ds_read_b64_tr_b16 v[88:89], v100 offset:35904
ds_read_b64_tr_b16 v[90:91], v100 offset:37184
ds_read_b64_tr_b16 v[92:93], v100 offset:35936
ds_read_b64_tr_b16 v[94:95], v100 offset:37216
ds_read_b64_tr_b16 v[96:97], v100 offset:35968
ds_read_b64_tr_b16 v[98:99], v100 offset:37248
s_waitcnt lgkmcnt(10)
ds_write_b128 v102, v[60:63] offset:30720
ds_write_b128 v102, v[64:67] offset:31744
ds_write_b128 v102, v[68:71] offset:32768
ds_write_b128 v102, v[72:75] offset:33792
ds_write_b128 v102, v[76:79] offset:34816
s_waitcnt lgkmcnt(5)
s_waitcnt vmcnt(25)
ds_read_b64_tr_b16 v[60:61], v100 offset:40960
ds_read_b64_tr_b16 v[62:63], v100 offset:42240
ds_read_b64_tr_b16 v[64:65], v100 offset:40992
ds_read_b64_tr_b16 v[66:67], v100 offset:42272
ds_read_b64_tr_b16 v[68:69], v100 offset:41024
ds_read_b64_tr_b16 v[70:71], v100 offset:42304
ds_read_b64_tr_b16 v[72:73], v100 offset:41056
ds_read_b64_tr_b16 v[74:75], v100 offset:42336
ds_read_b64_tr_b16 v[76:77], v100 offset:41088
ds_read_b64_tr_b16 v[78:79], v100 offset:42368
s_waitcnt lgkmcnt(10)
ds_write_b128 v102, v[80:83] offset:35840
ds_write_b128 v102, v[84:87] offset:36864
ds_write_b128 v102, v[88:91] offset:37888
ds_write_b128 v102, v[92:95] offset:38912
ds_write_b128 v102, v[96:99] offset:39936
s_waitcnt lgkmcnt(5)
s_waitcnt vmcnt(20)
ds_read_b64_tr_b16 v[80:81], v101 offset:5120
ds_read_b64_tr_b16 v[82:83], v101 offset:6400
ds_read_b64_tr_b16 v[84:85], v101 offset:5152
ds_read_b64_tr_b16 v[86:87], v101 offset:6432
ds_read_b64_tr_b16 v[88:89], v101 offset:5184
ds_read_b64_tr_b16 v[90:91], v101 offset:6464
ds_read_b64_tr_b16 v[92:93], v101 offset:5216
ds_read_b64_tr_b16 v[94:95], v101 offset:6496
ds_read_b64_tr_b16 v[96:97], v101 offset:5248
ds_read_b64_tr_b16 v[98:99], v101 offset:6528
s_waitcnt lgkmcnt(10)
ds_write_b128 v102, v[60:63] offset:40960
ds_write_b128 v102, v[64:67] offset:41984
ds_write_b128 v102, v[68:71] offset:43008
ds_write_b128 v102, v[72:75] offset:44032
ds_write_b128 v102, v[76:79] offset:45056
s_waitcnt lgkmcnt(5)
s_waitcnt vmcnt(15)
ds_read_b64_tr_b16 v[60:61], v101 offset:15360
ds_read_b64_tr_b16 v[62:63], v101 offset:16640
ds_read_b64_tr_b16 v[64:65], v101 offset:15392
ds_read_b64_tr_b16 v[66:67], v101 offset:16672
ds_read_b64_tr_b16 v[68:69], v101 offset:15424
ds_read_b64_tr_b16 v[70:71], v101 offset:16704
ds_read_b64_tr_b16 v[72:73], v101 offset:15456
ds_read_b64_tr_b16 v[74:75], v101 offset:16736
ds_read_b64_tr_b16 v[76:77], v101 offset:15488
ds_read_b64_tr_b16 v[78:79], v101 offset:16768
s_waitcnt lgkmcnt(10)
ds_write_b128 v103, v[80:83] offset:5120
ds_write_b128 v103, v[84:87] offset:6144
ds_write_b128 v103, v[88:91] offset:7168
ds_write_b128 v103, v[92:95] offset:8192
ds_write_b128 v103, v[96:99] offset:9216
s_waitcnt lgkmcnt(5)
s_waitcnt vmcnt(10)
ds_read_b64_tr_b16 v[80:81], v101 offset:20480
ds_read_b64_tr_b16 v[82:83], v101 offset:21760
ds_read_b64_tr_b16 v[84:85], v101 offset:20512
ds_read_b64_tr_b16 v[86:87], v101 offset:21792
ds_read_b64_tr_b16 v[88:89], v101 offset:20544
ds_read_b64_tr_b16 v[90:91], v101 offset:21824
ds_read_b64_tr_b16 v[92:93], v101 offset:20576
ds_read_b64_tr_b16 v[94:95], v101 offset:21856
ds_read_b64_tr_b16 v[96:97], v101 offset:20608
ds_read_b64_tr_b16 v[98:99], v101 offset:21888
s_waitcnt lgkmcnt(10)
ds_write_b128 v103, v[60:63] offset:15360
ds_write_b128 v103, v[64:67] offset:16384
ds_write_b128 v103, v[68:71] offset:17408
ds_write_b128 v103, v[72:75] offset:18432
ds_write_b128 v103, v[76:79] offset:19456
s_waitcnt lgkmcnt(5)
s_waitcnt vmcnt(5)
ds_read_b64_tr_b16 v[60:61], v101 offset:30720
ds_read_b64_tr_b16 v[62:63], v101 offset:32000
ds_read_b64_tr_b16 v[64:65], v101 offset:30752
ds_read_b64_tr_b16 v[66:67], v101 offset:32032
ds_read_b64_tr_b16 v[68:69], v101 offset:30784
ds_read_b64_tr_b16 v[70:71], v101 offset:32064
ds_read_b64_tr_b16 v[72:73], v101 offset:30816
ds_read_b64_tr_b16 v[74:75], v101 offset:32096
ds_read_b64_tr_b16 v[76:77], v101 offset:30848
ds_read_b64_tr_b16 v[78:79], v101 offset:32128
s_waitcnt lgkmcnt(10)
ds_write_b128 v103, v[80:83] offset:20480
ds_write_b128 v103, v[84:87] offset:21504
ds_write_b128 v103, v[88:91] offset:22528
ds_write_b128 v103, v[92:95] offset:23552
ds_write_b128 v103, v[96:99] offset:24576
s_waitcnt lgkmcnt(5)
s_waitcnt vmcnt(0)
ds_read_b64_tr_b16 v[80:81], v101 offset:40960
ds_read_b64_tr_b16 v[82:83], v101 offset:42240
ds_read_b64_tr_b16 v[84:85], v101 offset:40992
ds_read_b64_tr_b16 v[86:87], v101 offset:42272
ds_read_b64_tr_b16 v[88:89], v101 offset:41024
ds_read_b64_tr_b16 v[90:91], v101 offset:42304
ds_read_b64_tr_b16 v[92:93], v101 offset:41056
ds_read_b64_tr_b16 v[94:95], v101 offset:42336
ds_read_b64_tr_b16 v[96:97], v101 offset:41088
ds_read_b64_tr_b16 v[98:99], v101 offset:42368
s_waitcnt lgkmcnt(10)
ds_write_b128 v103, v[60:63] offset:30720
ds_write_b128 v103, v[64:67] offset:31744
ds_write_b128 v103, v[68:71] offset:32768
ds_write_b128 v103, v[72:75] offset:33792
ds_write_b128 v103, v[76:79] offset:34816
s_waitcnt lgkmcnt(5)
ds_write_b128 v103, v[80:83] offset:40960
ds_write_b128 v103, v[84:87] offset:41984
ds_write_b128 v103, v[88:91] offset:43008
ds_write_b128 v103, v[92:95] offset:44032
ds_write_b128 v103, v[96:99] offset:45056
s_waitcnt lgkmcnt(0)
v_mov_b32 v40, 300
ds_write_b32 v30, v40 offset:0
s_waitcnt lgkmcnt(0)
s_mov_b32 s81, 150784
s_mov_b32 s84, 1
s_cmp_lt_u32 s2, 144
s_cbranch_scc1 L_yhalf
s_endpgm
slow_105:
ds_read_b128 v[44:47], v30 offset:16
s_getreg_b32 s69, hwreg(HW_REG_IB_STS)
s_and_b32 s70, s69, 15
s_bfe_u32 s71, s69, 0x20016
s_lshl4_add_u32 s70, s71, s70
s_sub_u32 s70, 21, s70
v_mov_b32 v40, s70
ds_write_b32 v30, v40 offset:0
s_waitcnt lgkmcnt(1)
v_min_u32 v44, v44, v45
v_min3_u32 v44, v44, v46, v47
s_nop 0
v_readfirstlane_b32 s65, v44
s_cmp_ge_u32 s65, 1
s_cbranch_scc1 bk_104
s_sub_u32 s64, s64, 1
s_cbranch_scc0 slow_105
s_mov_b32 s64, 0
s_branch bk_104
slow_107:
ds_read_b128 v[44:47], v30 offset:16
s_getreg_b32 s69, hwreg(HW_REG_IB_STS)
s_and_b32 s70, s69, 15
s_bfe_u32 s71, s69, 0x20016
s_lshl4_add_u32 s70, s71, s70
s_sub_u32 s70, 24, s70
v_mov_b32 v40, s70
ds_write_b32 v30, v40 offset:0
s_waitcnt lgkmcnt(1)
v_min_u32 v44, v44, v45
v_min3_u32 v44, v44, v46, v47
s_nop 0
v_readfirstlane_b32 s65, v44
s_cmp_ge_u32 s65, 2
s_cbranch_scc1 bk_106
s_sub_u32 s64, s64, 1
s_cbranch_scc0 slow_107
s_mov_b32 s64, 0
s_branch bk_106
slow_109:
ds_read_b128 v[44:47], v30 offset:16
s_getreg_b32 s69, hwreg(HW_REG_IB_STS)
s_and_b32 s70, s69, 15
s_bfe_u32 s71, s69, 0x20016
s_lshl4_add_u32 s70, s71, s70
s_sub_u32 s70, 27, s70
v_mov_b32 v40, s70
ds_write_b32 v30, v40 offset:0
s_waitcnt lgkmcnt(1)
v_min_u32 v44, v44, v45
v_min3_u32 v44, v44, v46, v47
s_nop 0
v_readfirstlane_b32 s65, v44
s_cmp_ge_u32 s65, 3
s_cbranch_scc1 bk_108
s_sub_u32 s64, s64, 1
s_cbranch_scc0 slow_109
s_mov_b32 s64, 0
s_branch bk_108
slow_111:
ds_read_b128 v[44:47], v30 offset:16
s_getreg_b32 s69, hwreg(HW_REG_IB_STS)
s_and_b32 s70, s69, 15
s_bfe_u32 s71, s69, 0x20016
s_lshl4_add_u32 s70, s71, s70
s_sub_u32 s70, 30, s70
v_mov_b32 v40, s70
ds_write_b32 v30, v40 offset:0
s_waitcnt lgkmcnt(1)
v_min_u32 v44, v44, v45
v_min3_u32 v44, v44, v46, v47
s_nop 0
v_readfirstlane_b32 s65, v44
s_cmp_ge_u32 s65, 4
s_cbranch_scc1 bk_110
s_sub_u32 s64, s64, 1
s_cbranch_scc0 slow_111
s_mov_b32 s64, 0
s_branch bk_110
slow_113:
ds_read_b128 v[44:47], v30 offset:16
s_getreg_b32 s69, hwreg(HW_REG_IB_STS)
s_and_b32 s70, s69, 15
s_bfe_u32 s71, s69, 0x20016
s_lshl4_add_u32 s70, s71, s70
s_sub_u32 s70, 33, s70
v_mov_b32 v40, s70
ds_write_b32 v30, v40 offset:0
s_waitcnt lgkmcnt(1)
v_min_u32 v44, v44, v45
v_min3_u32 v44, v44, v46, v47
s_nop 0
v_readfirstlane_b32 s65, v44
s_cmp_ge_u32 s65, 5
s_cbranch_scc1 bk_112
s_sub_u32 s64, s64, 1
s_cbranch_scc0 slow_113
s_mov_b32 s64, 0
s_branch bk_112
slow_115:
ds_read_b128 v[44:47], v30 offset:16
s_getreg_b32 s69, hwreg(HW_REG_IB_STS)
s_and_b32 s70, s69, 15
s_bfe_u32 s71, s69, 0x20016
s_lshl4_add_u32 s70, s71, s70
s_sub_u32 s70, 36, s70
v_mov_b32 v40, s70
ds_write_b32 v30, v40 offset:0
s_waitcnt lgkmcnt(1)
v_min_u32 v44, v44, v45
v_min3_u32 v44, v44, v46, v47
s_nop 0
v_readfirstlane_b32 s65, v44
s_cmp_ge_u32 s65, 6
s_cbranch_scc1 bk_114
s_sub_u32 s64, s64, 1
s_cbranch_scc0 slow_115
s_mov_b32 s64, 0
s_branch bk_114
slow_117:
ds_read_b128 v[44:47], v30 offset:16
s_getreg_b32 s69, hwreg(HW_REG_IB_STS)
s_and_b32 s70, s69, 15
s_bfe_u32 s71, s69, 0x20016
s_lshl4_add_u32 s70, s71, s70
s_sub_u32 s70, 39, s70
v_mov_b32 v40, s70
ds_write_b32 v30, v40 offset:0
s_waitcnt lgkmcnt(1)
v_min_u32 v44, v44, v45
v_min3_u32 v44, v44, v46, v47
s_nop 0
v_readfirstlane_b32 s65, v44
s_cmp_ge_u32 s65, 7
s_cbranch_scc1 bk_116
s_sub_u32 s64, s64, 1
s_cbranch_scc0 slow_117
s_mov_b32 s64, 0
s_branch bk_116
slow_119:
ds_read_b128 v[44:47], v30 offset:16
s_getreg_b32 s69, hwreg(HW_REG_IB_STS)
s_and_b32 s70, s69, 15
s_bfe_u32 s71, s69, 0x20016
s_lshl4_add_u32 s70, s71, s70
s_sub_u32 s70, 42, s70
v_mov_b32 v40, s70
ds_write_b32 v30, v40 offset:0
s_waitcnt lgkmcnt(1)
v_min_u32 v44, v44, v45
v_min3_u32 v44, v44, v46, v47
s_nop 0
v_readfirstlane_b32 s65, v44
s_cmp_ge_u32 s65, 8
s_cbranch_scc1 bk_118
s_sub_u32 s64, s64, 1
s_cbranch_scc0 slow_119
s_mov_b32 s64, 0
s_branch bk_118
slow_121:
ds_read_b128 v[44:47], v30 offset:16
s_getreg_b32 s69, hwreg(HW_REG_IB_STS)
s_and_b32 s70, s69, 15
s_bfe_u32 s71, s69, 0x20016
s_lshl4_add_u32 s70, s71, s70
s_sub_u32 s70, 45, s70
v_mov_b32 v40, s70
ds_write_b32 v30, v40 offset:0
s_waitcnt lgkmcnt(1)
v_min_u32 v44, v44, v45
v_min3_u32 v44, v44, v46, v47
s_nop 0
v_readfirstlane_b32 s65, v44
s_cmp_ge_u32 s65, 9
s_cbranch_scc1 bk_120
s_sub_u32 s64, s64, 1
s_cbranch_scc0 slow_121
s_mov_b32 s64, 0
s_branch bk_120
slow_123:
ds_read_b128 v[44:47], v30 offset:16
s_getreg_b32 s69, hwreg(HW_REG_IB_STS)
s_and_b32 s70, s69, 15
s_bfe_u32 s71, s69, 0x20016
s_lshl4_add_u32 s70, s71, s70
s_sub_u32 s70, 48, s70
v_mov_b32 v40, s70
ds_write_b32 v30, v40 offset:0
s_waitcnt lgkmcnt(1)
v_min_u32 v44, v44, v45
v_min3_u32 v44, v44, v46, v47
s_nop 0
v_readfirstlane_b32 s65, v44
s_cmp_ge_u32 s65, 10
s_cbranch_scc1 bk_122
s_sub_u32 s64, s64, 1
s_cbranch_scc0 slow_123
s_mov_b32 s64, 0
s_branch bk_122
slow_125:
ds_read_b128 v[44:47], v30 offset:16
s_getreg_b32 s69, hwreg(HW_REG_IB_STS)
s_and_b32 s70, s69, 15
s_bfe_u32 s71, s69, 0x20016
s_lshl4_add_u32 s70, s71, s70
s_sub_u32 s70, 51, s70
v_mov_b32 v40, s70
ds_write_b32 v30, v40 offset:0
s_waitcnt lgkmcnt(1)
v_min_u32 v44, v44, v45
v_min3_u32 v44, v44, v46, v47
s_nop 0
v_readfirstlane_b32 s65, v44
s_cmp_ge_u32 s65, 11
s_cbranch_scc1 bk_124
s_sub_u32 s64, s64, 1
s_cbranch_scc0 slow_125
s_mov_b32 s64, 0
s_branch bk_124
slow_127:
ds_read_b128 v[44:47], v30 offset:16
s_getreg_b32 s69, hwreg(HW_REG_IB_STS)
s_and_b32 s70, s69, 15
s_bfe_u32 s71, s69, 0x20016
s_lshl4_add_u32 s70, s71, s70
s_sub_u32 s70, 54, s70
v_mov_b32 v40, s70
ds_write_b32 v30, v40 offset:0
s_waitcnt lgkmcnt(1)
v_min_u32 v44, v44, v45
v_min3_u32 v44, v44, v46, v47
s_nop 0
v_readfirstlane_b32 s65, v44
s_cmp_ge_u32 s65, 5
s_cbranch_scc1 bk_126
s_sub_u32 s64, s64, 1
s_cbranch_scc0 slow_127
s_mov_b32 s64, 0
s_branch bk_126
slow_129:
ds_read_b128 v[44:47], v30 offset:16
s_getreg_b32 s69, hwreg(HW_REG_IB_STS)
s_and_b32 s70, s69, 15
s_bfe_u32 s71, s69, 0x20016
s_lshl4_add_u32 s70, s71, s70
s_sub_u32 s70, 57, s70
v_mov_b32 v40, s70
ds_write_b32 v30, v40 offset:0
s_waitcnt lgkmcnt(1)
v_min_u32 v44, v44, v45
v_min3_u32 v44, v44, v46, v47
s_nop 0
v_readfirstlane_b32 s65, v44
s_cmp_ge_u32 s65, 6
s_cbranch_scc1 bk_128
s_sub_u32 s64, s64, 1
s_cbranch_scc0 slow_129
s_mov_b32 s64, 0
s_branch bk_128
slow_131:
ds_read_b128 v[44:47], v30 offset:16
s_getreg_b32 s69, hwreg(HW_REG_IB_STS)
s_and_b32 s70, s69, 15
s_bfe_u32 s71, s69, 0x20016
s_lshl4_add_u32 s70, s71, s70
s_sub_u32 s70, 60, s70
v_mov_b32 v40, s70
ds_write_b32 v30, v40 offset:0
s_waitcnt lgkmcnt(1)
v_min_u32 v44, v44, v45
v_min3_u32 v44, v44, v46, v47
s_nop 0
v_readfirstlane_b32 s65, v44
s_cmp_ge_u32 s65, 7
s_cbranch_scc1 bk_130
s_sub_u32 s64, s64, 1
s_cbranch_scc0 slow_131
s_mov_b32 s64, 0
s_branch bk_130
slow_133:
ds_read_b128 v[44:47], v30 offset:16
s_getreg_b32 s69, hwreg(HW_REG_IB_STS)
s_and_b32 s70, s69, 15
s_bfe_u32 s71, s69, 0x20016
s_lshl4_add_u32 s70, s71, s70
s_sub_u32 s70, 63, s70
v_mov_b32 v40, s70
ds_write_b32 v30, v40 offset:0
s_waitcnt lgkmcnt(1)
v_min_u32 v44, v44, v45
v_min3_u32 v44, v44, v46, v47
s_nop 0
v_readfirstlane_b32 s65, v44
s_cmp_ge_u32 s65, 8
s_cbranch_scc1 bk_132
s_sub_u32 s64, s64, 1
s_cbranch_scc0 slow_133
s_mov_b32 s64, 0
s_branch bk_132
slow_135:
ds_read_b128 v[44:47], v30 offset:16
s_getreg_b32 s69, hwreg(HW_REG_IB_STS)
s_and_b32 s70, s69, 15
s_bfe_u32 s71, s69, 0x20016
s_lshl4_add_u32 s70, s71, s70
s_sub_u32 s70, 66, s70
v_mov_b32 v40, s70
ds_write_b32 v30, v40 offset:0
s_waitcnt lgkmcnt(1)
v_min_u32 v44, v44, v45
v_min3_u32 v44, v44, v46, v47
s_nop 0
v_readfirstlane_b32 s65, v44
s_cmp_ge_u32 s65, 9
s_cbranch_scc1 bk_134
s_sub_u32 s64, s64, 1
s_cbranch_scc0 slow_135
s_mov_b32 s64, 0
s_branch bk_134
slow_137:
ds_read_b128 v[44:47], v30 offset:16
s_getreg_b32 s69, hwreg(HW_REG_IB_STS)
s_and_b32 s70, s69, 15
s_bfe_u32 s71, s69, 0x20016
s_lshl4_add_u32 s70, s71, s70
s_sub_u32 s70, 69, s70
v_mov_b32 v40, s70
ds_write_b32 v30, v40 offset:0
s_waitcnt lgkmcnt(1)
v_min_u32 v44, v44, v45
v_min3_u32 v44, v44, v46, v47
s_nop 0
v_readfirstlane_b32 s65, v44
s_cmp_ge_u32 s65, 10
s_cbranch_scc1 bk_136
s_sub_u32 s64, s64, 1
s_cbranch_scc0 slow_137
s_mov_b32 s64, 0
s_branch bk_136
slow_139:
ds_read_b128 v[44:47], v30 offset:16
s_getreg_b32 s69, hwreg(HW_REG_IB_STS)
s_and_b32 s70, s69, 15
s_bfe_u32 s71, s69, 0x20016
s_lshl4_add_u32 s70, s71, s70
s_sub_u32 s70, 72, s70
v_mov_b32 v40, s70
ds_write_b32 v30, v40 offset:0
s_waitcnt lgkmcnt(1)
v_min_u32 v44, v44, v45
v_min3_u32 v44, v44, v46, v47
s_nop 0
v_readfirstlane_b32 s65, v44
s_cmp_ge_u32 s65, 11
s_cbranch_scc1 bk_138
s_sub_u32 s64, s64, 1
s_cbranch_scc0 slow_139
s_mov_b32 s64, 0
s_branch bk_138
slow_141:
ds_read_b128 v[44:47], v30 offset:16
s_getreg_b32 s69, hwreg(HW_REG_IB_STS)
s_and_b32 s70, s69, 15
s_bfe_u32 s71, s69, 0x20016
s_lshl4_add_u32 s70, s71, s70
s_sub_u32 s70, 75, s70
v_mov_b32 v40, s70
ds_write_b32 v30, v40 offset:0
s_waitcnt lgkmcnt(1)
v_min_u32 v44, v44, v45
v_min3_u32 v44, v44, v46, v47
s_nop 0
v_readfirstlane_b32 s65, v44
s_cmp_ge_u32 s65, 12
s_cbranch_scc1 bk_140
s_sub_u32 s64, s64, 1
s_cbranch_scc0 slow_141
s_mov_b32 s64, 0
s_branch bk_140
slow_143:
ds_read_b128 v[44:47], v30 offset:16
s_getreg_b32 s69, hwreg(HW_REG_IB_STS)
s_and_b32 s70, s69, 15
s_bfe_u32 s71, s69, 0x20016
s_lshl4_add_u32 s70, s71, s70
s_sub_u32 s70, 78, s70
v_mov_b32 v40, s70
ds_write_b32 v30, v40 offset:0
s_waitcnt lgkmcnt(1)
v_min_u32 v44, v44, v45
v_min3_u32 v44, v44, v46, v47
s_nop 0
v_readfirstlane_b32 s65, v44
s_cmp_ge_u32 s65, 13
s_cbranch_scc1 bk_142
s_sub_u32 s64, s64, 1
s_cbranch_scc0 slow_143
s_mov_b32 s64, 0
s_branch bk_142
slow_145:
ds_read_b128 v[44:47], v30 offset:16
s_getreg_b32 s69, hwreg(HW_REG_IB_STS)
s_and_b32 s70, s69, 15
s_bfe_u32 s71, s69, 0x20016
s_lshl4_add_u32 s70, s71, s70
s_sub_u32 s70, 81, s70
v_mov_b32 v40, s70
ds_write_b32 v30, v40 offset:0
s_waitcnt lgkmcnt(1)
v_min_u32 v44, v44, v45
v_min3_u32 v44, v44, v46, v47
s_nop 0
v_readfirstlane_b32 s65, v44
s_cmp_ge_u32 s65, 14
s_cbranch_scc1 bk_144
s_sub_u32 s64, s64, 1
s_cbranch_scc0 slow_145
s_mov_b32 s64, 0
s_branch bk_144
slow_147:
ds_read_b128 v[44:47], v30 offset:16
s_getreg_b32 s69, hwreg(HW_REG_IB_STS)
s_and_b32 s70, s69, 15
s_bfe_u32 s71, s69, 0x20016
s_lshl4_add_u32 s70, s71, s70
s_sub_u32 s70, 84, s70
v_mov_b32 v40, s70
ds_write_b32 v30, v40 offset:0
s_waitcnt lgkmcnt(1)
v_min_u32 v44, v44, v45
v_min3_u32 v44, v44, v46, v47
s_nop 0
v_readfirstlane_b32 s65, v44
s_cmp_ge_u32 s65, 15
s_cbranch_scc1 bk_146
s_sub_u32 s64, s64, 1
s_cbranch_scc0 slow_147
s_mov_b32 s64, 0
s_branch bk_146
slow_149:
ds_read_b128 v[44:47], v30 offset:16
s_getreg_b32 s69, hwreg(HW_REG_IB_STS)
s_and_b32 s70, s69, 15
s_bfe_u32 s71, s69, 0x20016
s_lshl4_add_u32 s70, s71, s70
s_sub_u32 s70, 87, s70
v_mov_b32 v40, s70
ds_write_b32 v30, v40 offset:0
s_waitcnt lgkmcnt(1)
v_min_u32 v44, v44, v45
v_min3_u32 v44, v44, v46, v47
s_nop 0
v_readfirstlane_b32 s65, v44
s_cmp_ge_u32 s65, 16
s_cbranch_scc1 bk_148
s_sub_u32 s64, s64, 1
s_cbranch_scc0 slow_149
s_mov_b32 s64, 0
s_branch bk_148
slow_151:
ds_read_b128 v[44:47], v30 offset:16
s_getreg_b32 s69, hwreg(HW_REG_IB_STS)
s_and_b32 s70, s69, 15
s_bfe_u32 s71, s69, 0x20016
s_lshl4_add_u32 s70, s71, s70
s_sub_u32 s70, 90, s70
v_mov_b32 v40, s70
ds_write_b32 v30, v40 offset:0
s_waitcnt lgkmcnt(1)
v_min_u32 v44, v44, v45
v_min3_u32 v44, v44, v46, v47
s_nop 0
v_readfirstlane_b32 s65, v44
s_cmp_ge_u32 s65, 17
s_cbranch_scc1 bk_150
s_sub_u32 s64, s64, 1
s_cbranch_scc0 slow_151
s_mov_b32 s64, 0
s_branch bk_150
slow_153:
ds_read_b128 v[44:47], v30 offset:16
s_getreg_b32 s69, hwreg(HW_REG_IB_STS)
s_and_b32 s70, s69, 15
s_bfe_u32 s71, s69, 0x20016
s_lshl4_add_u32 s70, s71, s70
s_sub_u32 s70, 93, s70
v_mov_b32 v40, s70
ds_write_b32 v30, v40 offset:0
s_waitcnt lgkmcnt(1)
v_min_u32 v44, v44, v45
v_min3_u32 v44, v44, v46, v47
s_nop 0
v_readfirstlane_b32 s65, v44
s_cmp_ge_u32 s65, 18
s_cbranch_scc1 bk_152
s_sub_u32 s64, s64, 1
s_cbranch_scc0 slow_153
s_mov_b32 s64, 0
s_branch bk_152
slow_155:
ds_read_b128 v[44:47], v30 offset:16
s_getreg_b32 s69, hwreg(HW_REG_IB_STS)
s_and_b32 s70, s69, 15
s_bfe_u32 s71, s69, 0x20016
s_lshl4_add_u32 s70, s71, s70
s_sub_u32 s70, 96, s70
v_mov_b32 v40, s70
ds_write_b32 v30, v40 offset:0
s_waitcnt lgkmcnt(1)
v_min_u32 v44, v44, v45
v_min3_u32 v44, v44, v46, v47
s_nop 0
v_readfirstlane_b32 s65, v44
s_cmp_ge_u32 s65, 17
s_cbranch_scc1 bk_154
s_sub_u32 s64, s64, 1
s_cbranch_scc0 slow_155
s_mov_b32 s64, 0
s_branch bk_154
slow_157:
ds_read_b128 v[44:47], v30 offset:16
s_getreg_b32 s69, hwreg(HW_REG_IB_STS)
s_and_b32 s70, s69, 15
s_bfe_u32 s71, s69, 0x20016
s_lshl4_add_u32 s70, s71, s70
s_sub_u32 s70, 99, s70
v_mov_b32 v40, s70
ds_write_b32 v30, v40 offset:0
s_waitcnt lgkmcnt(1)
v_min_u32 v44, v44, v45
v_min3_u32 v44, v44, v46, v47
s_nop 0
v_readfirstlane_b32 s65, v44
s_cmp_ge_u32 s65, 17
s_cbranch_scc1 bk_156
s_sub_u32 s64, s64, 1
s_cbranch_scc0 slow_157
s_mov_b32 s64, 0
s_branch bk_156
slow_159:
ds_read_b128 v[44:47], v30 offset:16
s_getreg_b32 s69, hwreg(HW_REG_IB_STS)
s_and_b32 s70, s69, 15
s_bfe_u32 s71, s69, 0x20016
s_lshl4_add_u32 s70, s71, s70
s_sub_u32 s70, 102, s70
v_mov_b32 v40, s70
ds_write_b32 v30, v40 offset:0
s_waitcnt lgkmcnt(1)
v_min_u32 v44, v44, v45
v_min3_u32 v44, v44, v46, v47
s_nop 0
v_readfirstlane_b32 s65, v44
s_cmp_ge_u32 s65, 17
s_cbranch_scc1 bk_158
s_sub_u32 s64, s64, 1
s_cbranch_scc0 slow_159
s_mov_b32 s64, 0
s_branch bk_158
slow_161:
ds_read_b128 v[44:47], v30 offset:16
s_getreg_b32 s69, hwreg(HW_REG_IB_STS)
s_and_b32 s70, s69, 15
s_bfe_u32 s71, s69, 0x20016
s_lshl4_add_u32 s70, s71, s70
s_sub_u32 s70, 105, s70
v_mov_b32 v40, s70
ds_write_b32 v30, v40 offset:0
s_waitcnt lgkmcnt(1)
v_min_u32 v44, v44, v45
v_min3_u32 v44, v44, v46, v47
s_nop 0
v_readfirstlane_b32 s65, v44
s_cmp_ge_u32 s65, 17
s_cbranch_scc1 bk_160
s_sub_u32 s64, s64, 1
s_cbranch_scc0 slow_161
s_mov_b32 s64, 0
s_branch bk_160
slow_163:
ds_read_b128 v[44:47], v30 offset:16
s_getreg_b32 s69, hwreg(HW_REG_IB_STS)
s_and_b32 s70, s69, 15
s_bfe_u32 s71, s69, 0x20016
s_lshl4_add_u32 s70, s71, s70
s_sub_u32 s70, 108, s70
v_mov_b32 v40, s70
ds_write_b32 v30, v40 offset:0
s_waitcnt lgkmcnt(1)
v_min_u32 v44, v44, v45
v_min3_u32 v44, v44, v46, v47
s_nop 0
v_readfirstlane_b32 s65, v44
s_cmp_ge_u32 s65, 19
s_cbranch_scc1 bk_162
s_sub_u32 s64, s64, 1
s_cbranch_scc0 slow_163
s_mov_b32 s64, 0
s_branch bk_162
slow_165:
ds_read_b128 v[44:47], v30 offset:16
s_getreg_b32 s69, hwreg(HW_REG_IB_STS)
s_and_b32 s70, s69, 15
s_bfe_u32 s71, s69, 0x20016
s_lshl4_add_u32 s70, s71, s70
s_sub_u32 s70, 111, s70
v_mov_b32 v40, s70
ds_write_b32 v30, v40 offset:0
s_waitcnt lgkmcnt(1)
v_min_u32 v44, v44, v45
v_min3_u32 v44, v44, v46, v47
s_nop 0
v_readfirstlane_b32 s65, v44
s_cmp_ge_u32 s65, 20
s_cbranch_scc1 bk_164
s_sub_u32 s64, s64, 1
s_cbranch_scc0 slow_165
s_mov_b32 s64, 0
s_branch bk_164
slow_167:
ds_read_b128 v[44:47], v30 offset:16
s_getreg_b32 s69, hwreg(HW_REG_IB_STS)
s_and_b32 s70, s69, 15
s_bfe_u32 s71, s69, 0x20016
s_lshl4_add_u32 s70, s71, s70
s_sub_u32 s70, 114, s70
v_mov_b32 v40, s70
ds_write_b32 v30, v40 offset:0
s_waitcnt lgkmcnt(1)
v_min_u32 v44, v44, v45
v_min3_u32 v44, v44, v46, v47
s_nop 0
v_readfirstlane_b32 s65, v44
s_cmp_ge_u32 s65, 21
s_cbranch_scc1 bk_166
s_sub_u32 s64, s64, 1
s_cbranch_scc0 slow_167
s_mov_b32 s64, 0
s_branch bk_166
slow_169:
ds_read_b128 v[44:47], v30 offset:16
s_getreg_b32 s69, hwreg(HW_REG_IB_STS)
s_and_b32 s70, s69, 15
s_bfe_u32 s71, s69, 0x20016
s_lshl4_add_u32 s70, s71, s70
s_sub_u32 s70, 117, s70
v_mov_b32 v40, s70
ds_write_b32 v30, v40 offset:0
s_waitcnt lgkmcnt(1)
v_min_u32 v44, v44, v45
v_min3_u32 v44, v44, v46, v47
s_nop 0
v_readfirstlane_b32 s65, v44
s_cmp_ge_u32 s65, 22
s_cbranch_scc1 bk_168
s_sub_u32 s64, s64, 1
s_cbranch_scc0 slow_169
s_mov_b32 s64, 0
s_branch bk_168
slow_171:
ds_read_b128 v[44:47], v30 offset:16
s_getreg_b32 s69, hwreg(HW_REG_IB_STS)
s_and_b32 s70, s69, 15
s_bfe_u32 s71, s69, 0x20016
s_lshl4_add_u32 s70, s71, s70
s_sub_u32 s70, 120, s70
v_mov_b32 v40, s70
ds_write_b32 v30, v40 offset:0
s_waitcnt lgkmcnt(1)
v_min_u32 v44, v44, v45
v_min3_u32 v44, v44, v46, v47
s_nop 0
v_readfirstlane_b32 s65, v44
s_cmp_ge_u32 s65, 23
s_cbranch_scc1 bk_170
s_sub_u32 s64, s64, 1
s_cbranch_scc0 slow_171
s_mov_b32 s64, 0
s_branch bk_170
slow_173:
ds_read_b128 v[44:47], v30 offset:16
s_getreg_b32 s69, hwreg(HW_REG_IB_STS)
s_and_b32 s70, s69, 15
s_bfe_u32 s71, s69, 0x20016
s_lshl4_add_u32 s70, s71, s70
s_sub_u32 s70, 123, s70
v_mov_b32 v40, s70
ds_write_b32 v30, v40 offset:0
s_waitcnt lgkmcnt(1)
v_min_u32 v44, v44, v45
v_min3_u32 v44, v44, v46, v47
s_nop 0
v_readfirstlane_b32 s65, v44
s_cmp_ge_u32 s65, 24
s_cbranch_scc1 bk_172
s_sub_u32 s64, s64, 1
s_cbranch_scc0 slow_173
s_mov_b32 s64, 0
s_branch bk_172
slow_175:
ds_read_b128 v[44:47], v30 offset:16
s_getreg_b32 s69, hwreg(HW_REG_IB_STS)
s_and_b32 s70, s69, 15
s_bfe_u32 s71, s69, 0x20016
s_lshl4_add_u32 s70, s71, s70
s_sub_u32 s70, 126, s70
v_mov_b32 v40, s70
ds_write_b32 v30, v40 offset:0
s_waitcnt lgkmcnt(1)
v_min_u32 v44, v44, v45
v_min3_u32 v44, v44, v46, v47
s_nop 0
v_readfirstlane_b32 s65, v44
s_cmp_ge_u32 s65, 25
s_cbranch_scc1 bk_174
s_sub_u32 s64, s64, 1
s_cbranch_scc0 slow_175
s_mov_b32 s64, 0
s_branch bk_174
slow_177:
ds_read_b128 v[44:47], v30 offset:16
s_getreg_b32 s69, hwreg(HW_REG_IB_STS)
s_and_b32 s70, s69, 15
s_bfe_u32 s71, s69, 0x20016
s_lshl4_add_u32 s70, s71, s70
s_sub_u32 s70, 129, s70
v_mov_b32 v40, s70
ds_write_b32 v30, v40 offset:0
s_waitcnt lgkmcnt(1)
v_min_u32 v44, v44, v45
v_min3_u32 v44, v44, v46, v47
s_nop 0
v_readfirstlane_b32 s65, v44
s_cmp_ge_u32 s65, 26
s_cbranch_scc1 bk_176
s_sub_u32 s64, s64, 1
s_cbranch_scc0 slow_177
s_mov_b32 s64, 0
s_branch bk_176
slow_179:
ds_read_b128 v[44:47], v30 offset:16
s_getreg_b32 s69, hwreg(HW_REG_IB_STS)
s_and_b32 s70, s69, 15
s_bfe_u32 s71, s69, 0x20016
s_lshl4_add_u32 s70, s71, s70
s_sub_u32 s70, 132, s70
v_mov_b32 v40, s70
ds_write_b32 v30, v40 offset:0
s_waitcnt lgkmcnt(1)
v_min_u32 v44, v44, v45
v_min3_u32 v44, v44, v46, v47
s_nop 0
v_readfirstlane_b32 s65, v44
s_cmp_ge_u32 s65, 27
s_cbranch_scc1 bk_178
s_sub_u32 s64, s64, 1
s_cbranch_scc0 slow_179
s_mov_b32 s64, 0
s_branch bk_178
slow_181:
ds_read_b128 v[44:47], v30 offset:16
s_getreg_b32 s69, hwreg(HW_REG_IB_STS)
s_and_b32 s70, s69, 15
s_bfe_u32 s71, s69, 0x20016
s_lshl4_add_u32 s70, s71, s70
s_sub_u32 s70, 135, s70
v_mov_b32 v40, s70
ds_write_b32 v30, v40 offset:0
s_waitcnt lgkmcnt(1)
v_min_u32 v44, v44, v45
v_min3_u32 v44, v44, v46, v47
s_nop 0
v_readfirstlane_b32 s65, v44
s_cmp_ge_u32 s65, 28
s_cbranch_scc1 bk_180
s_sub_u32 s64, s64, 1
s_cbranch_scc0 slow_181
s_mov_b32 s64, 0
s_branch bk_180
slow_183:
ds_read_b128 v[44:47], v30 offset:16
s_getreg_b32 s69, hwreg(HW_REG_IB_STS)
s_and_b32 s70, s69, 15
s_bfe_u32 s71, s69, 0x20016
s_lshl4_add_u32 s70, s71, s70
s_sub_u32 s70, 138, s70
v_mov_b32 v40, s70
ds_write_b32 v30, v40 offset:0
s_waitcnt lgkmcnt(1)
v_min_u32 v44, v44, v45
v_min3_u32 v44, v44, v46, v47
s_nop 0
v_readfirstlane_b32 s65, v44
s_cmp_ge_u32 s65, 29
s_cbranch_scc1 bk_182
s_sub_u32 s64, s64, 1
s_cbranch_scc0 slow_183
s_mov_b32 s64, 0
s_branch bk_182
slow_185:
ds_read_b128 v[44:47], v30 offset:16
s_getreg_b32 s69, hwreg(HW_REG_IB_STS)
s_and_b32 s70, s69, 15
s_bfe_u32 s71, s69, 0x20016
s_lshl4_add_u32 s70, s71, s70
s_sub_u32 s70, 141, s70
v_mov_b32 v40, s70
ds_write_b32 v30, v40 offset:0
s_waitcnt lgkmcnt(1)
v_min_u32 v44, v44, v45
v_min3_u32 v44, v44, v46, v47
s_nop 0
v_readfirstlane_b32 s65, v44
s_cmp_ge_u32 s65, 30
s_cbranch_scc1 bk_184
s_sub_u32 s64, s64, 1
s_cbranch_scc0 slow_185
s_mov_b32 s64, 0
s_branch bk_184
slow_187:
ds_read_b128 v[44:47], v30 offset:16
s_getreg_b32 s69, hwreg(HW_REG_IB_STS)
s_and_b32 s70, s69, 15
s_bfe_u32 s71, s69, 0x20016
s_lshl4_add_u32 s70, s71, s70
s_sub_u32 s70, 144, s70
v_mov_b32 v40, s70
ds_write_b32 v30, v40 offset:0
s_waitcnt lgkmcnt(1)
v_min_u32 v44, v44, v45
v_min3_u32 v44, v44, v46, v47
s_nop 0
v_readfirstlane_b32 s65, v44
s_cmp_ge_u32 s65, 31
s_cbranch_scc1 bk_186
s_sub_u32 s64, s64, 1
s_cbranch_scc0 slow_187
s_mov_b32 s64, 0
s_branch bk_186
slow_189:
ds_read_b128 v[44:47], v30 offset:16
s_getreg_b32 s69, hwreg(HW_REG_IB_STS)
s_and_b32 s70, s69, 15
s_bfe_u32 s71, s69, 0x20016
s_lshl4_add_u32 s70, s71, s70
s_sub_u32 s70, 147, s70
v_mov_b32 v40, s70
ds_write_b32 v30, v40 offset:0
s_waitcnt lgkmcnt(1)
v_min_u32 v44, v44, v45
v_min3_u32 v44, v44, v46, v47
s_nop 0
v_readfirstlane_b32 s65, v44
s_cmp_ge_u32 s65, 32
s_cbranch_scc1 bk_188
s_sub_u32 s64, s64, 1
s_cbranch_scc0 slow_189
s_mov_b32 s64, 0
s_branch bk_188
slow_191:
ds_read_b128 v[44:47], v30 offset:16
s_getreg_b32 s69, hwreg(HW_REG_IB_STS)
s_and_b32 s70, s69, 15
s_bfe_u32 s71, s69, 0x20016
s_lshl4_add_u32 s70, s71, s70
s_sub_u32 s70, 150, s70
v_mov_b32 v40, s70
ds_write_b32 v30, v40 offset:0
s_waitcnt lgkmcnt(1)
v_min_u32 v44, v44, v45
v_min3_u32 v44, v44, v46, v47
s_nop 0
v_readfirstlane_b32 s65, v44
s_cmp_ge_u32 s65, 33
s_cbranch_scc1 bk_190
s_sub_u32 s64, s64, 1
s_cbranch_scc0 slow_191
s_mov_b32 s64, 0
s_branch bk_190
slow_193:
ds_read_b128 v[44:47], v30 offset:16
s_getreg_b32 s69, hwreg(HW_REG_IB_STS)
s_and_b32 s70, s69, 15
s_bfe_u32 s71, s69, 0x20016
s_lshl4_add_u32 s70, s71, s70
s_sub_u32 s70, 153, s70
v_mov_b32 v40, s70
ds_write_b32 v30, v40 offset:0
s_waitcnt lgkmcnt(1)
v_min_u32 v44, v44, v45
v_min3_u32 v44, v44, v46, v47
s_nop 0
v_readfirstlane_b32 s65, v44
s_cmp_ge_u32 s65, 34
s_cbranch_scc1 bk_192
s_sub_u32 s64, s64, 1
s_cbranch_scc0 slow_193
s_mov_b32 s64, 0
s_branch bk_192
slow_195:
ds_read_b128 v[44:47], v30 offset:16
s_getreg_b32 s69, hwreg(HW_REG_IB_STS)
s_and_b32 s70, s69, 15
s_bfe_u32 s71, s69, 0x20016
s_lshl4_add_u32 s70, s71, s70
s_sub_u32 s70, 156, s70
v_mov_b32 v40, s70
ds_write_b32 v30, v40 offset:0
s_waitcnt lgkmcnt(1)
v_min_u32 v44, v44, v45
v_min3_u32 v44, v44, v46, v47
s_nop 0
v_readfirstlane_b32 s65, v44
s_cmp_ge_u32 s65, 35
s_cbranch_scc1 bk_194
s_sub_u32 s64, s64, 1
s_cbranch_scc0 slow_195
s_mov_b32 s64, 0
s_branch bk_194
slow_197:
ds_read_b128 v[44:47], v30 offset:16
s_getreg_b32 s69, hwreg(HW_REG_IB_STS)
s_and_b32 s70, s69, 15
s_bfe_u32 s71, s69, 0x20016
s_lshl4_add_u32 s70, s71, s70
s_sub_u32 s70, 159, s70
v_mov_b32 v40, s70
ds_write_b32 v30, v40 offset:0
s_waitcnt lgkmcnt(1)
v_min_u32 v44, v44, v45
v_min3_u32 v44, v44, v46, v47
s_nop 0
v_readfirstlane_b32 s65, v44
s_cmp_ge_u32 s65, 36
s_cbranch_scc1 bk_196
s_sub_u32 s64, s64, 1
s_cbranch_scc0 slow_197
s_mov_b32 s64, 0
s_branch bk_196
slow_199:
ds_read_b128 v[44:47], v30 offset:16
s_getreg_b32 s69, hwreg(HW_REG_IB_STS)
s_and_b32 s70, s69, 15
s_bfe_u32 s71, s69, 0x20016
s_lshl4_add_u32 s70, s71, s70
s_sub_u32 s70, 162, s70
v_mov_b32 v40, s70
ds_write_b32 v30, v40 offset:0
s_waitcnt lgkmcnt(1)
v_min_u32 v44, v44, v45
v_min3_u32 v44, v44, v46, v47
s_nop 0
v_readfirstlane_b32 s65, v44
s_cmp_ge_u32 s65, 37
s_cbranch_scc1 bk_198
s_sub_u32 s64, s64, 1
s_cbranch_scc0 slow_199
s_mov_b32 s64, 0
s_branch bk_198
slow_201:
ds_read_b128 v[44:47], v30 offset:16
s_getreg_b32 s69, hwreg(HW_REG_IB_STS)
s_and_b32 s70, s69, 15
s_bfe_u32 s71, s69, 0x20016
s_lshl4_add_u32 s70, s71, s70
s_sub_u32 s70, 182, s70
v_mov_b32 v40, s70
ds_write_b32 v30, v40 offset:0
s_waitcnt lgkmcnt(1)
v_min_u32 v44, v44, v45
v_min3_u32 v44, v44, v46, v47
s_nop 0
v_readfirstlane_b32 s65, v44
s_cmp_ge_u32 s65, 55
s_cbranch_scc1 bk_200
s_sub_u32 s64, s64, 1
s_cbranch_scc0 slow_201
s_mov_b32 s64, 0
s_branch bk_200
L_bteam:
s_sub_u32 s68, s3, 4
s_mul_i32 s81, s68, 21248
s_add_u32 s81, s81, 100096
s_lshl_b32 s80, s2, 1
s_add_u32 s80, s80, s68
s_cmp_lt_u32 s3, 6
s_cbranch_scc1 L_channel
s_cmp_lt_u32 s2, 144
s_cbranch_scc1 L_mover
s_add_u32 s80, s2, 320
s_cmp_ge_u32 s2, 192
s_cbranch_scc1 L_channel
s_waitcnt lgkmcnt(0)
s_barrier
s_endpgm
L_channel:
v_lshlrev_b32 v3, 2, v0
v_mov_b32 v4, 0
s_lshl_b32 s82, s80, 8
s_lshl_b32 s83, s80, 1
s_waitcnt lgkmcnt(0)
s_mov_b32 s8, s46
s_mov_b32 s9, s47
s_mov_b32 s10, 0x24000
s_mov_b32 s11, 0x20000
buffer_load_dword v10, v3, s[8:11], s82 offen
s_mov_b32 s12, s48
s_mov_b32 s13, s49
s_mov_b32 s14, 0x24000
s_mov_b32 s15, 0x20000
buffer_load_dword v11, v3, s[12:15], s82 offen
s_mov_b32 s24, s50
s_mov_b32 s25, s51
s_mov_b32 s26, 0x24000
s_mov_b32 s27, 0x20000
buffer_load_dword v12, v3, s[24:27], s82 offen
s_mov_b32 s28, s52
s_mov_b32 s29, s53
s_mov_b32 s30, 0x24000
s_mov_b32 s31, 0x20000
buffer_load_dword v13, v3, s[28:31], s82 offen
s_mov_b32 s32, s54
s_mov_b32 s33, s55
s_mov_b32 s34, 0x480
s_mov_b32 s35, 0x20000
s_mov_b32 s8, s56
s_mov_b32 s9, s57
s_mov_b32 s10, 0x480
s_mov_b32 s11, 0x20000
buffer_load_ushort v14, v4, s[32:35], s83 offen
buffer_load_ushort v15, v4, s[8:11], s83 offen
v_and_b32 v1, 15, v0
v_lshrrev_b32 v2, 4, v0
v_lshlrev_b32 v5, 4, v0
v_add_u32 v5, s81, v5
v_and_b32 v7, 3, v0
v_lshlrev_b32 v6, 10, v7
v_and_b32 v8, 1, v7
v_lshlrev_b32 v8, 5, v8
v_lshrrev_b32 v7, 1, v7
v_lshlrev_b32 v7, 7, v7
v_add3_u32 v6, v6, v7, v8
v_lshrrev_b32 v7, 3, v1
v_lshl_add_u32 v7, v2, 2, v7
v_lshlrev_b32 v7, 4, v7
v_lshrrev_b32 v8, 2, v1
v_and_b32 v8, 1, v8
v_lshlrev_b32 v8, 3, v8
v_add3_u32 v6, v6, v7, v8
v_add_u32 v6, s81, v6
s_barrier
s_mov_b32 s16, s62
s_mov_b32 s17, s63
s_mov_b32 s18, 0x2000000
s_mov_b32 s19, 0x20000
s_mov_b32 s20, s58
s_mov_b32 s21, s59
s_mov_b32 s22, 0x480000
s_mov_b32 s23, 0x20000
s_mov_b32 s28, s60
s_mov_b32 s29, s61
s_mov_b32 s30, 0x100
s_mov_b32 s31, 0x20000
s_cmp_lg_u32 s3, 4
s_cbranch_scc1 notw4_202
s_cmp_lg_u32 s2, 0
s_cbranch_scc1 nn_203
s_or_b32 s96, s96, 1
v_mov_b32 v238, s96
v_mov_b32 v239, 0
s_mov_b64 exec, 1
buffer_store_dword v238, v239, s[28:31], 0 offen sc1
s_mov_b64 exec, -1
nn_203:
notw4_202:
s_waitcnt vmcnt(0)
buffer_load_dword v230, v4, s[28:31], 0 offen sc1
v_lshlrev_b32 v14, 16, v14
v_mul_f32 v24, 0x3fb8aa3b, v14
v_exp_f32 v24, v24
s_nop 0
v_cvt_pk_bf16_f32 v24, v24, v24
v_lshlrev_b32 v24, 16, v24
v_lshlrev_b32 v15, 16, v15
v_lshlrev_b32 v16, 16, v10
v_lshlrev_b32 v17, 16, v11
v_lshlrev_b32 v18, 16, v12
v_lshlrev_b32 v19, 16, v13
v_mul_f32 v26, 0x3fb8aa3b, v16
v_exp_f32 v26, v26
s_nop 0
v_cvt_pk_bf16_f32 v26, v26, v26
v_lshlrev_b32 v26, 16, v26
v_mul_f32 v16, v26, v24
v_mul_f32 v16, 0xbfb8aa3b, v16
v_mul_f32 v17, v17, v24
v_mul_f32 v17, 0x3e22f983, v17
v_mul_f32 v18, v18, v24
v_mul_f32 v19, v19, v24
v_add_f32 v18, v18, v18
v_add_f32 v19, v19, v19
v_and_b32 v20, 0xffff0000, v10
v_and_b32 v21, 0xffff0000, v11
v_and_b32 v22, 0xffff0000, v12
v_and_b32 v23, 0xffff0000, v13
v_mul_f32 v26, 0x3fb8aa3b, v20
v_exp_f32 v26, v26
s_nop 0
v_cvt_pk_bf16_f32 v26, v26, v26
v_lshlrev_b32 v26, 16, v26
v_mul_f32 v20, v26, v24
v_mul_f32 v20, 0xbfb8aa3b, v20
v_mul_f32 v21, v21, v24
v_mul_f32 v21, 0x3e22f983, v21
v_mul_f32 v22, v22, v24
v_mul_f32 v23, v23, v24
v_add_f32 v22, v22, v22
v_add_f32 v23, v23, v23
v_mov_b32 v28, 0
v_mov_b32 v29, 0
v_mov_b32 v30, 0
v_mov_b32 v31, 0
v_mov_b32 v32, 0
v_mov_b32 v33, 0
v_mov_b32 v34, 0
v_mov_b32 v35, 0
v_mov_b32 v36, 0
v_mov_b32 v37, 0
v_mov_b32 v38, 0
v_mov_b32 v39, 0
s_lshr_b32 s72, s80, 6
s_lshl_b32 s72, s72, 11
s_add_u32 s72, s72, 0xc80000
v_lshlrev_b32 v232, 7, v1
v_add_u32 v232, s72, v232
s_mov_b32 s70, 0
khalf_204:
v_mul_f32 v54, 0x3f800000, v16
v_mul_f32 v55, 0x3f800000, v17
v_exp_f32 v54, v54
v_fract_f32 v55, v55
v_cos_f32 v56, v55
v_sin_f32 v55, v55
v_mul_f32 v40, v54, v56
v_mul_f32 v41, v54, v55
v_mul_f32 v57, 0x41000000, v16
v_mul_f32 v58, 0x41000000, v17
v_exp_f32 v57, v57
v_fract_f32 v58, v58
v_cos_f32 v59, v58
v_sin_f32 v58, v58
v_mul_f32 v46, v57, v59
v_mul_f32 v47, v57, v58
v_mul_f32 v54, 0x43000000, v16
v_mul_f32 v55, 0x43000000, v17
v_exp_f32 v54, v54
v_fract_f32 v55, v55
v_cos_f32 v56, v55
v_sin_f32 v55, v55
v_mul_f32 v48, v54, v56
v_mul_f32 v49, v54, v55
v_mul_f32 v42, v40, v40
v_mul_f32 v43, v40, v41
v_fma_f32 v42, -v41, v41, v42
v_fma_f32 v43, v41, v40, v43
v_mul_f32 v50, v48, v48
v_mul_f32 v51, v48, v49
v_fma_f32 v50, -v49, v49, v50
v_fma_f32 v51, v49, v48, v51
v_mul_f32 v44, v42, v42
v_mul_f32 v45, v42, v43
v_fma_f32 v44, -v43, v43, v44
v_fma_f32 v45, v43, v42, v45
v_mul_f32 v52, v50, v50
v_mul_f32 v53, v50, v51
v_fma_f32 v52, -v51, v51, v52
v_fma_f32 v53, v51, v50, v53
v_mul_f32 v68, v46, v46
v_mul_f32 v69, v46, v47
v_fma_f32 v68, -v47, v47, v68
v_fma_f32 v69, v47, v46, v69
v_mul_f32 v70, v68, v46
v_mul_f32 v71, v68, v47
v_fma_f32 v70, -v69, v47, v70
v_fma_f32 v71, v69, v46, v71
v_cvt_pk_bf16_f32 v56, 1.0, v46
v_cvt_pk_bf16_f32 v57, v68, v70
v_cvt_pk_bf16_f32 v58, 0, -v47
v_cvt_pk_bf16_f32 v59, -v69, -v71
ds_write_b128 v5, v[56:59] offset:0
v_mul_f32 v64, v70, v46
v_mul_f32 v65, v70, v47
v_fma_f32 v64, -v71, v47, v64
v_fma_f32 v65, v71, v46, v65
v_mul_f32 v66, v64, v46
v_mul_f32 v67, v64, v47
v_fma_f32 v66, -v65, v47, v66
v_fma_f32 v67, v65, v46, v67
v_mul_f32 v68, v66, v46
v_mul_f32 v69, v66, v47
v_fma_f32 v68, -v67, v47, v68
v_fma_f32 v69, v67, v46, v69
v_mul_f32 v70, v68, v46
v_mul_f32 v71, v68, v47
v_fma_f32 v70, -v69, v47, v70
v_fma_f32 v71, v69, v46, v71
v_cvt_pk_bf16_f32 v60, v64, v66
v_cvt_pk_bf16_f32 v61, v68, v70
v_cvt_pk_bf16_f32 v62, -v65, -v67
v_cvt_pk_bf16_f32 v63, -v69, -v71
ds_write_b128 v5, v[60:63] offset:1056
v_mul_f32 v64, v70, v46
v_mul_f32 v65, v70, v47
v_fma_f32 v64, -v71, v47, v64
v_fma_f32 v65, v71, v46, v65
v_mul_f32 v66, v64, v46
v_mul_f32 v67, v64, v47
v_fma_f32 v66, -v65, v47, v66
v_fma_f32 v67, v65, v46, v67
v_mul_f32 v68, v66, v46
v_mul_f32 v69, v66, v47
v_fma_f32 v68, -v67, v47, v68
v_fma_f32 v69, v67, v46, v69
v_mul_f32 v70, v68, v46
v_mul_f32 v71, v68, v47
v_fma_f32 v70, -v69, v47, v70
v_fma_f32 v71, v69, v46, v71
v_cvt_pk_bf16_f32 v56, v64, v66
v_cvt_pk_bf16_f32 v57, v68, v70
v_cvt_pk_bf16_f32 v58, -v65, -v67
v_cvt_pk_bf16_f32 v59, -v69, -v71
ds_write_b128 v5, v[56:59] offset:2176
v_mul_f32 v64, v70, v46
v_mul_f32 v65, v70, v47
v_fma_f32 v64, -v71, v47, v64
v_fma_f32 v65, v71, v46, v65
v_mul_f32 v66, v64, v46
v_mul_f32 v67, v64, v47
v_fma_f32 v66, -v65, v47, v66
v_fma_f32 v67, v65, v46, v67
v_mul_f32 v68, v66, v46
v_mul_f32 v69, v66, v47
v_fma_f32 v68, -v67, v47, v68
v_fma_f32 v69, v67, v46, v69
v_mul_f32 v70, v68, v46
v_mul_f32 v71, v68, v47
v_fma_f32 v70, -v69, v47, v70
v_fma_f32 v71, v69, v46, v71
v_cvt_pk_bf16_f32 v60, v64, v66
v_cvt_pk_bf16_f32 v61, v68, v70
v_cvt_pk_bf16_f32 v62, -v65, -v67
v_cvt_pk_bf16_f32 v63, -v69, -v71
ds_write_b128 v5, v[60:63] offset:3232
v_mul_f32 v72, v18, v40
v_mul_f32 v73, v18, v41
v_fma_f32 v72, -v19, v41, v72
v_fma_f32 v73, v19, v40, v73
v_mul_f32 v74, v72, v40
v_mul_f32 v75, v72, v41
v_fma_f32 v74, -v73, v41, v74
v_fma_f32 v75, v73, v40, v75
v_mul_f32 v76, v74, v40
v_mul_f32 v77, v74, v41
v_fma_f32 v76, -v75, v41, v76
v_fma_f32 v77, v75, v40, v77
v_cvt_pk_bf16_f32 v56, v18, v72
v_cvt_pk_bf16_f32 v57, v74, v76
v_cvt_pk_bf16_f32 v58, v19, v73
v_cvt_pk_bf16_f32 v59, v75, v77
ds_write_b128 v5, v[56:59] offset:4352
v_mul_f32 v78, v76, v40
v_mul_f32 v79, v76, v41
v_fma_f32 v78, -v77, v41, v78
v_fma_f32 v79, v77, v40, v79
v_mul_f32 v80, v78, v40
v_mul_f32 v81, v78, v41
v_fma_f32 v80, -v79, v41, v80
v_fma_f32 v81, v79, v40, v81
v_mul_f32 v82, v80, v40
v_mul_f32 v83, v80, v41
v_fma_f32 v82, -v81, v41, v82
v_fma_f32 v83, v81, v40, v83
v_mul_f32 v84, v82, v40
v_mul_f32 v85, v82, v41
v_fma_f32 v84, -v83, v41, v84
v_fma_f32 v85, v83, v40, v85
v_cvt_pk_bf16_f32 v60, v78, v80
v_cvt_pk_bf16_f32 v61, v82, v84
v_cvt_pk_bf16_f32 v62, v79, v81
v_cvt_pk_bf16_f32 v63, v83, v85
ds_write_b128 v5, v[60:63] offset:5408
v_mul_f32 v64, v18, v48
v_mul_f32 v65, v18, v49
v_fma_f32 v64, -v19, v49, v64
v_fma_f32 v65, v19, v48, v65
v_mul_f32 v66, v72, v48
v_mul_f32 v67, v72, v49
v_fma_f32 v66, -v73, v49, v66
v_fma_f32 v67, v73, v48, v67
v_mul_f32 v68, v74, v48
v_mul_f32 v69, v74, v49
v_fma_f32 v68, -v75, v49, v68
v_fma_f32 v69, v75, v48, v69
v_mul_f32 v70, v76, v48
v_mul_f32 v71, v76, v49
v_fma_f32 v70, -v77, v49, v70
v_fma_f32 v71, v77, v48, v71
v_cvt_pk_bf16_f32 v56, v64, v66
v_cvt_pk_bf16_f32 v57, v68, v70
v_cvt_pk_bf16_f32 v58, v65, v67
v_cvt_pk_bf16_f32 v59, v69, v71
ds_write_b128 v5, v[56:59] offset:6528
v_mul_f32 v64, v78, v48
v_mul_f32 v65, v78, v49
v_fma_f32 v64, -v79, v49, v64
v_fma_f32 v65, v79, v48, v65
v_mul_f32 v66, v80, v48
v_mul_f32 v67, v80, v49
v_fma_f32 v66, -v81, v49, v66
v_fma_f32 v67, v81, v48, v67
v_mul_f32 v68, v82, v48
v_mul_f32 v69, v82, v49
v_fma_f32 v68, -v83, v49, v68
v_fma_f32 v69, v83, v48, v69
v_mul_f32 v70, v84, v48
v_mul_f32 v71, v84, v49
v_fma_f32 v70, -v85, v49, v70
v_fma_f32 v71, v85, v48, v71
v_cvt_pk_bf16_f32 v60, v64, v66
v_cvt_pk_bf16_f32 v61, v68, v70
v_cvt_pk_bf16_f32 v62, v65, v67
v_cvt_pk_bf16_f32 v63, v69, v71
ds_write_b128 v5, v[60:63] offset:7584
v_mul_f32 v72, v18, v50
v_mul_f32 v73, v18, v51
v_fma_f32 v72, -v19, v51, v72
v_fma_f32 v73, v19, v50, v73
v_mul_f32 v74, v72, v42
v_mul_f32 v75, v72, v43
v_fma_f32 v74, -v73, v43, v74
v_fma_f32 v75, v73, v42, v75
v_mul_f32 v76, v74, v42
v_mul_f32 v77, v74, v43
v_fma_f32 v76, -v75, v43, v76
v_fma_f32 v77, v75, v42, v77
v_mul_f32 v78, v76, v42
v_mul_f32 v79, v76, v43
v_fma_f32 v78, -v77, v43, v78
v_fma_f32 v79, v77, v42, v79
v_cvt_pk_bf16_f32 v56, v72, v74
v_cvt_pk_bf16_f32 v57, v76, v78
v_cvt_pk_bf16_f32 v58, v73, v75
v_cvt_pk_bf16_f32 v59, v77, v79
ds_write_b128 v5, v[56:59] offset:13056
v_mul_f32 v64, v72, v48
v_mul_f32 v65, v72, v49
v_fma_f32 v64, -v73, v49, v64
v_fma_f32 v65, v73, v48, v65
v_mul_f32 v66, v74, v48
v_mul_f32 v67, v74, v49
v_fma_f32 v66, -v75, v49, v66
v_fma_f32 v67, v75, v48, v67
v_mul_f32 v68, v76, v48
v_mul_f32 v69, v76, v49
v_fma_f32 v68, -v77, v49, v68
v_fma_f32 v69, v77, v48, v69
v_mul_f32 v70, v78, v48
v_mul_f32 v71, v78, v49
v_fma_f32 v70, -v79, v49, v70
v_fma_f32 v71, v79, v48, v71
v_cvt_pk_bf16_f32 v60, v64, v66
v_cvt_pk_bf16_f32 v61, v68, v70
v_cvt_pk_bf16_f32 v62, v65, v67
v_cvt_pk_bf16_f32 v63, v69, v71
ds_write_b128 v5, v[60:63] offset:14112
v_mul_f32 v80, v72, v50
v_mul_f32 v81, v72, v51
v_fma_f32 v80, -v73, v51, v80
v_fma_f32 v81, v73, v50, v81
v_mul_f32 v82, v80, v52
v_mul_f32 v83, v80, v53
v_fma_f32 v82, -v81, v53, v82
v_fma_f32 v83, v81, v52, v83
v_mul_f32 v88, v80, v44
v_mul_f32 v89, v80, v45
v_fma_f32 v88, -v81, v45, v88
v_fma_f32 v89, v81, v44, v89
v_mul_f32 v84, v82, v52
v_mul_f32 v85, v82, v53
v_fma_f32 v84, -v83, v53, v84
v_fma_f32 v85, v83, v52, v85
v_cvt_pk_bf16_f32 v56, v82, v84
v_cvt_pk_bf16_f32 v57, v80, v88
v_cvt_pk_bf16_f32 v58, v83, v85
v_cvt_pk_bf16_f32 v59, v81, v89
ds_write_b128 v5, v[56:59] offset:8704
v_mul_f32 v55, v82, v49
v_mul_f32 v82, v82, v48
v_fma_f32 v82, -v83, v49, v82
v_fma_f32 v83, v83, v48, v55
v_mul_f32 v55, v84, v49
v_mul_f32 v84, v84, v48
v_fma_f32 v84, -v85, v49, v84
v_fma_f32 v85, v85, v48, v55
v_mul_f32 v86, v80, v48
v_mul_f32 v87, v80, v49
v_fma_f32 v86, -v81, v49, v86
v_fma_f32 v87, v81, v48, v87
v_mul_f32 v55, v88, v49
v_mul_f32 v88, v88, v48
v_fma_f32 v88, -v89, v49, v88
v_fma_f32 v89, v89, v48, v55
v_cvt_pk_bf16_f32 v60, v82, v84
v_cvt_pk_bf16_f32 v61, v86, v88
v_cvt_pk_bf16_f32 v62, v83, v85
v_cvt_pk_bf16_f32 v63, v87, v89
ds_write_b128 v5, v[60:63] offset:9760
v_mul_f32 v55, v82, v49
v_mul_f32 v82, v82, v48
v_fma_f32 v82, -v83, v49, v82
v_fma_f32 v83, v83, v48, v55
v_mul_f32 v55, v84, v49
v_mul_f32 v84, v84, v48
v_fma_f32 v84, -v85, v49, v84
v_fma_f32 v85, v85, v48, v55
v_mul_f32 v55, v86, v49
v_mul_f32 v86, v86, v48
v_fma_f32 v86, -v87, v49, v86
v_fma_f32 v87, v87, v48, v55
v_mul_f32 v55, v88, v49
v_mul_f32 v88, v88, v48
v_fma_f32 v88, -v89, v49, v88
v_fma_f32 v89, v89, v48, v55
v_cvt_pk_bf16_f32 v56, v82, v84
v_cvt_pk_bf16_f32 v57, v86, v88
v_cvt_pk_bf16_f32 v58, v83, v85
v_cvt_pk_bf16_f32 v59, v87, v89
ds_write_b128 v5, v[56:59] offset:10880
v_mul_f32 v55, v82, v49
v_mul_f32 v82, v82, v48
v_fma_f32 v82, -v83, v49, v82
v_fma_f32 v83, v83, v48, v55
v_mul_f32 v55, v84, v49
v_mul_f32 v84, v84, v48
v_fma_f32 v84, -v85, v49, v84
v_fma_f32 v85, v85, v48, v55
v_mul_f32 v55, v86, v49
v_mul_f32 v86, v86, v48
v_fma_f32 v86, -v87, v49, v86
v_fma_f32 v87, v87, v48, v55
v_mul_f32 v55, v88, v49
v_mul_f32 v88, v88, v48
v_fma_f32 v88, -v89, v49, v88
v_fma_f32 v89, v89, v48, v55
v_cvt_pk_bf16_f32 v60, v82, v84
v_cvt_pk_bf16_f32 v61, v86, v88
v_cvt_pk_bf16_f32 v62, v83, v85
v_cvt_pk_bf16_f32 v63, v87, v89
ds_write_b128 v5, v[60:63] offset:11936
v_mul_f32 v64, v84, v48
v_mul_f32 v65, v84, v49
v_fma_f32 v64, -v85, v49, v64
v_fma_f32 v65, v85, v48, v65
v_cvt_pk_bf16_f32 v56, v80, v64
v_cvt_pk_bf16_f32 v58, v81, v65
ds_write_b128 v5, v[56:59] offset:15232
ds_read_b64_tr_b16 v[96:97], v6 offset:0
ds_read_b64_tr_b16 v[98:99], v6 offset:32
ds_read_b64_tr_b16 v[100:101], v6 offset:4352
ds_read_b64_tr_b16 v[102:103], v6 offset:4384
ds_read_b64_tr_b16 v[104:105], v6 offset:8704
ds_read_b64_tr_b16 v[106:107], v6 offset:8736
ds_read_b64_tr_b16 v[108:109], v6 offset:13056
ds_read_b64_tr_b16 v[110:111], v6 offset:13088
ds_read_b64_tr_b16 v[112:113], v6 offset:256
ds_read_b64_tr_b16 v[114:115], v6 offset:288
ds_read_b64_tr_b16 v[116:117], v6 offset:4608
ds_read_b64_tr_b16 v[118:119], v6 offset:4640
ds_read_b64_tr_b16 v[120:121], v6 offset:8960
ds_read_b64_tr_b16 v[122:123], v6 offset:8992
ds_read_b64_tr_b16 v[124:125], v6 offset:13312
ds_read_b64_tr_b16 v[126:127], v6 offset:13344
s_waitcnt lgkmcnt(8)
v_mfma_f32_16x16x32_bf16 v[28:31], v[100:103], v[96:99], v[28:31]
v_mfma_f32_16x16x32_bf16 v[32:35], v[104:107], v[96:99], v[32:35]
v_mfma_f32_16x16x32_bf16 v[36:39], v[108:111], v[96:99], v[36:39]
ds_read_b64_tr_b16 v[128:129], v6 offset:512
ds_read_b64_tr_b16 v[130:131], v6 offset:544
ds_read_b64_tr_b16 v[132:133], v6 offset:4864
ds_read_b64_tr_b16 v[134:135], v6 offset:4896
ds_read_b64_tr_b16 v[136:137], v6 offset:9216
ds_read_b64_tr_b16 v[138:139], v6 offset:9248
ds_read_b64_tr_b16 v[140:141], v6 offset:13568
ds_read_b64_tr_b16 v[142:143], v6 offset:13600
s_waitcnt lgkmcnt(8)
v_mfma_f32_16x16x32_bf16 v[28:31], v[116:119], v[112:115], v[28:31]
v_mfma_f32_16x16x32_bf16 v[32:35], v[120:123], v[112:115], v[32:35]
v_mfma_f32_16x16x32_bf16 v[36:39], v[124:127], v[112:115], v[36:39]
ds_read_b64_tr_b16 v[144:145], v6 offset:768
ds_read_b64_tr_b16 v[146:147], v6 offset:800
ds_read_b64_tr_b16 v[148:149], v6 offset:5120
ds_read_b64_tr_b16 v[150:151], v6 offset:5152
ds_read_b64_tr_b16 v[152:153], v6 offset:9472
ds_read_b64_tr_b16 v[154:155], v6 offset:9504
ds_read_b64_tr_b16 v[156:157], v6 offset:13824
ds_read_b64_tr_b16 v[158:159], v6 offset:13856
s_waitcnt lgkmcnt(8)
v_mfma_f32_16x16x32_bf16 v[28:31], v[132:135], v[128:131], v[28:31]
v_mfma_f32_16x16x32_bf16 v[32:35], v[136:139], v[128:131], v[32:35]
v_mfma_f32_16x16x32_bf16 v[36:39], v[140:143], v[128:131], v[36:39]
s_waitcnt lgkmcnt(0)
v_mfma_f32_16x16x32_bf16 v[28:31], v[148:151], v[144:147], v[28:31]
v_mfma_f32_16x16x32_bf16 v[32:35], v[152:155], v[144:147], v[32:35]
v_mfma_f32_16x16x32_bf16 v[36:39], v[156:159], v[144:147], v[36:39]
v_mov_b32 v16, v20
v_mov_b32 v17, v21
v_mov_b32 v18, v22
v_mov_b32 v19, v23
s_add_u32 s70, s70, 1
s_cmp_lt_u32 s70, 2
s_cbranch_scc0 kdone_205
s_waitcnt vmcnt(0)
v_readfirstlane_b32 s66, v230
s_cmp_lg_u32 s66, 0
s_cbranch_scc1 nok_206
poll_208:
buffer_load_dword v230, v4, s[28:31], 0 offen sc1
s_waitcnt vmcnt(0)
v_readfirstlane_b32 s66, v230
s_cmp_lg_u32 s66, 0
s_cbranch_scc1 ok_207
s_sleep 1
s_sub_u32 s64, s64, 64
s_cbranch_scc0 poll_208
s_mov_b32 s64, 0
ok_207:
nok_206:
s_branch khalf_204
kdone_205:
s_mov_b32 s84, 0
s_mov_b64 exec, 0xffff
buffer_load_dword v233, v232, s[16:19], 0 offen sc1
s_mov_b64 exec, -1
s_nop 7
v_lshlrev_b32 v11, 4, v0
v_sub_u32 v7, s81, v11
v_add_u32 v7, 13488, v7
v_readlane_b32 s73, v33, 0
v_mov_b32_dpp v40, v32 wave_shl:1 row_mask:0xf bank_mask:0xf
s_nop 0
v_writelane_b32 v40, s73, 63
v_readlane_b32 s73, v37, 32
v_mov_b32_dpp v41, v33 wave_shl:1 row_mask:0xf bank_mask:0xf
s_nop 0
v_writelane_b32 v41, s73, 63
v_readlane_b32 s73, v32, 0
v_mov_b32_dpp v42, v34 wave_shl:1 row_mask:0xf bank_mask:0xf
s_nop 0
v_writelane_b32 v42, s73, 63
v_mov_b32_dpp v43, v36 wave_shl:1 row_mask:0xf bank_mask:0xf
v_and_b32 v11, 1, v0
v_cmp_eq_u32 vcc, 1, v11
s_nop 1
v_cndmask_b32 v12, v32, v40, vcc
v_cvt_pk_bf16_f32 v44, v40, v40
v_cvt_pk_bf16_f32 v45, v40, v12
v_cvt_pk_bf16_f32 v46, v32, v32
v_cvt_pk_bf16_f32 v47, v32, v32
ds_write_b128 v7, v[44:47] offset:1024
v_cndmask_b32 v12, v33, v41, vcc
v_cvt_pk_bf16_f32 v48, v41, v41
v_cvt_pk_bf16_f32 v49, v41, v12
v_cvt_pk_bf16_f32 v50, v33, v33
v_cvt_pk_bf16_f32 v51, v33, v33
ds_write_b128 v7, v[48:51] offset:0
v_cvt_pk_bf16_f32 v52, v42, v42
v_cvt_pk_bf16_f32 v53, v35, v35
v_cvt_pk_bf16_f32 v54, v35, v34
v_cvt_pk_bf16_f32 v55, v34, v34
ds_write_b128 v7, v[52:55] offset:2048
v_cvt_pk_bf16_f32 v56, v43, v39
v_cvt_pk_bf16_f32 v57, v38, v38
v_cvt_pk_bf16_f32 v58, v38, v37
v_cvt_pk_bf16_f32 v59, v36, v36
s_mov_b32 exec_hi, 0
ds_write_b128 v7, v[56:59] offset:2560
s_mov_b32 exec_hi, -1
v_lshrrev_b32 v11, 1, v2
v_lshlrev_b32 v11, 7, v11
v_lshlrev_b32 v12, 3, v1
v_add_u32 v11, v11, v12
v_and_b32 v12, 1, v2
v_lshlrev_b32 v12, 2, v12
v_add_u32 v11, v11, v12
v_lshlrev_b32 v11, 1, v11
v_sub_u32 v11, s81, v11
v_add_u32 v11, 16568, v11
v_cvt_pk_bf16_f32 v12, v31, v30
v_cvt_pk_bf16_f32 v13, v29, v28
ds_write_b64 v11, v[12:13]
v_mov_b32 v60, 0
v_mov_b32 v61, 0
v_mov_b32 v62, 0
v_mov_b32 v63, 0
v_lshrrev_b32 v11, 1, v0
v_mul_u32_u24 v11, 4160, v11
v_and_b32 v16, 1, v0
v_lshlrev_b32 v16, 4, v16
v_add_u32 v11, v11, v16
v_add_u32 v11, s81, v11
s_mov_b64 exec, 0xff
ds_write_b128 v11, v[60:63] offset:4096
s_mov_b64 exec, -1
v_lshlrev_b32 v11, 4, v0
v_add_u32 v11, s81, v11
s_mov_b64 exec, 0x3fffffff
ds_write_b128 v11, v[60:63] offset:16640
s_mov_b64 exec, -1
s_cmp_lg_u32 s84, 0
s_cbranch_scc1 usk_209
s_waitcnt vmcnt(0)
s_mov_b64 exec, 0xffff
v_cmp_ne_u32 vcc, s66, v233
s_mov_b64 exec, -1
s_cmp_eq_u64 vcc, 0
s_cbranch_scc0 uno_210
s_mul_i32 s72, s80, 4096
s_add_u32 s72, s72, 0x500000
v_lshlrev_b32 v232, 4, v0
s_add_u32 m0, s81, 17120
s_nop 0
buffer_load_dwordx4 v232, s[16:19], s72 offen sc1 lds
s_add_u32 s72, s72, 1024
s_add_u32 m0, s81, 18144
s_nop 0
buffer_load_dwordx4 v232, s[16:19], s72 offen sc1 lds
s_add_u32 s72, s72, 1024
s_add_u32 m0, s81, 19168
s_nop 0
buffer_load_dwordx4 v232, s[16:19], s72 offen sc1 lds
s_add_u32 s72, s72, 1024
s_add_u32 m0, s81, 20192
s_nop 0
buffer_load_dwordx4 v232, s[16:19], s72 offen sc1 lds
s_add_u32 s72, s72, 1024
s_mov_b32 s84, 1
s_branch usk_209
uno_210:
s_mov_b64 exec, 0xffff
buffer_load_dword v233, v232, s[16:19], 0 offen sc1
s_mov_b64 exec, -1
usk_209:
ds_read_b128 v[44:47], v11 offset:12480
ds_read_b64 v[48:49], v11 offset:12496
s_waitcnt lgkmcnt(0)
v_alignbit_b32 v50, v45, v44, 16
v_alignbit_b32 v51, v46, v45, 16
v_alignbit_b32 v52, v47, v46, 16
v_alignbit_b32 v53, v48, v47, 16
v_alignbit_b32 v54, v46, v45, 16
v_alignbit_b32 v55, v47, v46, 16
v_alignbit_b32 v56, v48, v47, 16
v_alignbit_b32 v57, v49, v48, 16
v_mov_b32 v58, v45
v_mov_b32 v59, v46
v_mov_b32 v60, v47
v_mov_b32 v61, v48
ds_write_b128 v11, v[50:53] offset:8320
ds_write_b128 v11, v[54:57] offset:0
ds_write_b128 v11, v[58:61] offset:4160
ds_read_b128 v[64:67], v11 offset:13504
ds_read_b64 v[68:69], v11 offset:13520
s_waitcnt lgkmcnt(0)
v_alignbit_b32 v70, v65, v64, 16
v_alignbit_b32 v71, v66, v65, 16
v_alignbit_b32 v72, v67, v66, 16
v_alignbit_b32 v73, v68, v67, 16
v_alignbit_b32 v74, v66, v65, 16
v_alignbit_b32 v75, v67, v66, 16
v_alignbit_b32 v76, v68, v67, 16
v_alignbit_b32 v77, v69, v68, 16
v_mov_b32 v78, v65
v_mov_b32 v79, v66
v_mov_b32 v80, v67
v_mov_b32 v81, v68
ds_write_b128 v11, v[70:73] offset:9344
ds_write_b128 v11, v[74:77] offset:1024
ds_write_b128 v11, v[78:81] offset:5184
ds_read_b128 v[44:47], v11 offset:14528
ds_read_b64 v[48:49], v11 offset:14544
s_waitcnt lgkmcnt(0)
v_alignbit_b32 v50, v45, v44, 16
v_alignbit_b32 v51, v46, v45, 16
v_alignbit_b32 v52, v47, v46, 16
v_alignbit_b32 v53, v48, v47, 16
v_alignbit_b32 v54, v46, v45, 16
v_alignbit_b32 v55, v47, v46, 16
v_alignbit_b32 v56, v48, v47, 16
v_alignbit_b32 v57, v49, v48, 16
v_mov_b32 v58, v45
v_mov_b32 v59, v46
v_mov_b32 v60, v47
v_mov_b32 v61, v48
ds_write_b128 v11, v[50:53] offset:10368
ds_write_b128 v11, v[54:57] offset:2048
ds_write_b128 v11, v[58:61] offset:6208
ds_read_b128 v[64:67], v11 offset:15552
ds_read_b64 v[68:69], v11 offset:15568
s_waitcnt lgkmcnt(0)
v_alignbit_b32 v70, v65, v64, 16
v_alignbit_b32 v71, v66, v65, 16
v_alignbit_b32 v72, v67, v66, 16
v_alignbit_b32 v73, v68, v67, 16
v_alignbit_b32 v74, v66, v65, 16
v_alignbit_b32 v75, v67, v66, 16
v_alignbit_b32 v76, v68, v67, 16
v_alignbit_b32 v77, v69, v68, 16
v_mov_b32 v78, v65
v_mov_b32 v79, v66
v_mov_b32 v80, v67
v_mov_b32 v81, v68
ds_write_b128 v11, v[70:73] offset:11392
ds_write_b128 v11, v[74:77] offset:3072
ds_write_b128 v11, v[78:81] offset:7232
s_cmp_lg_u32 s84, 0
s_cbranch_scc1 usk_211
s_waitcnt vmcnt(0)
s_mov_b64 exec, 0xffff
v_cmp_ne_u32 vcc, s66, v233
s_mov_b64 exec, -1
s_cmp_eq_u64 vcc, 0
s_cbranch_scc1 uno_212
s_mov_b64 s[70:71], exec
s_mov_b64 exec, 0xffff
poll_214:
buffer_load_dword v233, v232, s[16:19], 0 offen sc1
s_waitcnt vmcnt(0)
v_cmp_ne_u32 vcc, s66, v233
s_cmp_eq_u64 vcc, 0
s_cbranch_scc1 ok_213
s_sleep 1
s_sub_u32 s64, s64, 64
s_cbranch_scc0 poll_214
s_mov_b32 s64, 0
ok_213:
s_mov_b64 exec, s[70:71]
uno_212:
s_mul_i32 s72, s80, 4096
s_add_u32 s72, s72, 0x500000
v_lshlrev_b32 v232, 4, v0
s_add_u32 m0, s81, 17120
s_nop 0
buffer_load_dwordx4 v232, s[16:19], s72 offen sc1 lds
s_add_u32 s72, s72, 1024
s_add_u32 m0, s81, 18144
s_nop 0
buffer_load_dwordx4 v232, s[16:19], s72 offen sc1 lds
s_add_u32 s72, s72, 1024
s_add_u32 m0, s81, 19168
s_nop 0
buffer_load_dwordx4 v232, s[16:19], s72 offen sc1 lds
s_add_u32 s72, s72, 1024
s_add_u32 m0, s81, 20192
s_nop 0
buffer_load_dwordx4 v232, s[16:19], s72 offen sc1 lds
s_add_u32 s72, s72, 1024
s_mov_b32 s84, 1
usk_211:
v_and_b32 v13, 3, v1
v_mul_u32_u24 v13, 4160, v13
v_lshrrev_b32 v14, 2, v1
v_lshlrev_b32 v14, 3, v14
v_sub_u32 v13, v13, v14
v_lshlrev_b32 v14, 4, v2
v_add_u32 v13, v13, v14
v_add_u32 v13, 24, v13
v_add_u32 v8, s81, v13
v_add_u32 v9, 2048, v8
v_lshlrev_b32 v13, 5, v1
v_add_u32 v13, v13, v14
v_add_u32 v13, s81, v13
v_add_u32 v10, 16640, v13
v_lshlrev_b32 v13, 5, v1
v_lshlrev_b32 v14, 3, v2
v_add_u32 v13, v13, v14
v_add_u32 v13, s81, v13
v_add_u32 v11, 17120, v13
v_mov_b32 v16, 0
v_mov_b32 v17, 0
v_mov_b32 v18, 0
v_mov_b32 v19, 0
v_mov_b32 v20, 0
v_mov_b32 v21, 0
v_mov_b32 v22, 0
v_mov_b32 v23, 0
v_mov_b32 v24, 0
v_mov_b32 v25, 0
v_mov_b32 v26, 0
v_mov_b32 v27, 0
v_mov_b32 v28, 0
v_mov_b32 v29, 0
v_mov_b32 v30, 0
v_mov_b32 v31, 0
v_mov_b32 v32, 0
v_mov_b32 v33, 0
v_mov_b32 v34, 0
v_mov_b32 v35, 0
v_mov_b32 v36, 0
v_mov_b32 v37, 0
v_mov_b32 v38, 0
v_mov_b32 v39, 0
v_mov_b32 v40, 0
v_mov_b32 v41, 0
v_mov_b32 v42, 0
v_mov_b32 v43, 0
v_mov_b32 v44, 0
v_mov_b32 v45, 0
v_mov_b32 v46, 0
v_mov_b32 v47, 0
ds_read_b64 v[48:49], v9 offset:1984
ds_read_b64 v[50:51], v9 offset:1992
ds_read_b64 v[52:53], v9 offset:1472
ds_read_b64 v[54:55], v9 offset:1480
ds_read_b64 v[56:57], v9 offset:960
ds_read_b64 v[58:59], v9 offset:968
ds_read_b64 v[60:61], v9 offset:448
ds_read_b64 v[62:63], v9 offset:456
ds_read_b64 v[64:65], v8 offset:1984
ds_read_b64 v[66:67], v8 offset:1992
ds_read_b64 v[68:69], v8 offset:1472
ds_read_b64 v[70:71], v8 offset:1480
ds_read_b64 v[72:73], v8 offset:960
ds_read_b64 v[74:75], v8 offset:968
ds_read_b64 v[76:77], v8 offset:448
ds_read_b64 v[78:79], v8 offset:456
s_waitcnt vmcnt(0)
ds_read_b128 v[80:83], v10 offset:448
ds_read_b128 v[84:87], v10 offset:960
ds_read_b128 v[88:91], v10 offset:1472
ds_read_b128 v[92:95], v10 offset:1984
ds_read_b128 v[96:99], v10 offset:2496
ds_read_b128 v[100:103], v10 offset:3008
ds_read_b128 v[104:107], v10 offset:3520
ds_read_b128 v[108:111], v10 offset:4032
ds_read_b64 v[208:209], v11 offset:0
ds_read_b64 v[210:211], v11 offset:512
ds_read_b64 v[212:213], v11 offset:1024
ds_read_b64 v[214:215], v11 offset:1536
ds_read_b64 v[216:217], v11 offset:2048
ds_read_b64 v[218:219], v11 offset:2560
ds_read_b64 v[220:221], v11 offset:3072
ds_read_b64 v[222:223], v11 offset:3584
s_lshl_b32 s72, s80, 7
s_add_u32 s72, s72, 0xca0000
v_mov_b32 v228, s72
v_mov_b32 v229, s66
v_mov_b32 v230, 0
v_mov_b32 v231, 1
s_waitcnt lgkmcnt(0)
v_mfma_f32_16x16x32_bf16 v[16:19], v[48:51], v[80:83], v[16:19]
v_mfma_f32_16x16x32_bf16 v[20:23], v[48:51], v[84:87], v[20:23]
ds_read_b64 v[112:113], v9 offset:1920
v_mfma_f32_16x16x32_bf16 v[24:27], v[48:51], v[88:91], v[24:27]
ds_read_b64 v[114:115], v9 offset:1928
v_mfma_f32_16x16x32_bf16 v[28:31], v[48:51], v[92:95], v[28:31]
v_mfma_f32_16x16x32_bf16 v[32:35], v[48:51], v[96:99], v[32:35]
ds_read_b128 v[144:147], v10 offset:384
v_mfma_f32_16x16x32_bf16 v[36:39], v[48:51], v[100:103], v[36:39]
ds_read_b64 v[116:117], v9 offset:1408
v_mfma_f32_16x16x32_bf16 v[40:43], v[48:51], v[104:107], v[40:43]
v_mfma_f32_16x16x32_bf16 v[44:47], v[48:51], v[108:111], v[44:47]
ds_read_b64 v[118:119], v9 offset:1416
v_mfma_f32_16x16x32_bf16 v[20:23], v[52:55], v[80:83], v[20:23]
ds_read_b128 v[148:151], v10 offset:896
v_mfma_f32_16x16x32_bf16 v[24:27], v[52:55], v[84:87], v[24:27]
v_mfma_f32_16x16x32_bf16 v[28:31], v[52:55], v[88:91], v[28:31]
ds_read_b64 v[120:121], v9 offset:896
v_mfma_f32_16x16x32_bf16 v[32:35], v[52:55], v[92:95], v[32:35]
ds_read_b64 v[122:123], v9 offset:904
v_mfma_f32_16x16x32_bf16 v[36:39], v[52:55], v[96:99], v[36:39]
v_mfma_f32_16x16x32_bf16 v[40:43], v[52:55], v[100:103], v[40:43]
ds_read_b128 v[152:155], v10 offset:1408
v_mfma_f32_16x16x32_bf16 v[44:47], v[52:55], v[104:107], v[44:47]
ds_read_b64 v[124:125], v9 offset:384
v_mfma_f32_16x16x32_bf16 v[24:27], v[56:59], v[80:83], v[24:27]
v_mfma_f32_16x16x32_bf16 v[28:31], v[56:59], v[84:87], v[28:31]
ds_read_b64 v[126:127], v9 offset:392
v_mfma_f32_16x16x32_bf16 v[32:35], v[56:59], v[88:91], v[32:35]
ds_read_b128 v[156:159], v10 offset:1920
v_mfma_f32_16x16x32_bf16 v[36:39], v[56:59], v[92:95], v[36:39]
v_mfma_f32_16x16x32_bf16 v[40:43], v[56:59], v[96:99], v[40:43]
ds_read_b64 v[128:129], v8 offset:1920
v_mfma_f32_16x16x32_bf16 v[44:47], v[56:59], v[100:103], v[44:47]
ds_read_b64 v[130:131], v8 offset:1928
v_mfma_f32_16x16x32_bf16 v[28:31], v[60:63], v[80:83], v[28:31]
v_mfma_f32_16x16x32_bf16 v[32:35], v[60:63], v[84:87], v[32:35]
ds_read_b128 v[160:163], v10 offset:2432
v_mfma_f32_16x16x32_bf16 v[36:39], v[60:63], v[88:91], v[36:39]
ds_read_b64 v[132:133], v8 offset:1408
v_mfma_f32_16x16x32_bf16 v[40:43], v[60:63], v[92:95], v[40:43]
v_mfma_f32_16x16x32_bf16 v[44:47], v[60:63], v[96:99], v[44:47]
ds_read_b64 v[134:135], v8 offset:1416
v_mfma_f32_16x16x32_bf16 v[32:35], v[64:67], v[80:83], v[32:35]
ds_read_b128 v[164:167], v10 offset:2944
v_mfma_f32_16x16x32_bf16 v[36:39], v[64:67], v[84:87], v[36:39]
v_mfma_f32_16x16x32_bf16 v[40:43], v[64:67], v[88:91], v[40:43]
ds_read_b64 v[136:137], v8 offset:896
v_mfma_f32_16x16x32_bf16 v[44:47], v[64:67], v[92:95], v[44:47]
ds_read_b64 v[138:139], v8 offset:904
v_mfma_f32_16x16x32_bf16 v[36:39], v[68:71], v[80:83], v[36:39]
v_mfma_f32_16x16x32_bf16 v[40:43], v[68:71], v[84:87], v[40:43]
ds_read_b128 v[168:171], v10 offset:3456
v_mfma_f32_16x16x32_bf16 v[44:47], v[68:71], v[88:91], v[44:47]
ds_read_b64 v[140:141], v8 offset:384
v_mfma_f32_16x16x32_bf16 v[40:43], v[72:75], v[80:83], v[40:43]
v_mfma_f32_16x16x32_bf16 v[44:47], v[72:75], v[84:87], v[44:47]
ds_read_b64 v[142:143], v8 offset:392
v_mfma_f32_16x16x32_bf16 v[44:47], v[76:79], v[80:83], v[44:47]
ds_read_b128 v[172:175], v10 offset:3968
s_waitcnt lgkmcnt(0)
v_mfma_f32_16x16x32_bf16 v[16:19], v[112:115], v[144:147], v[16:19]
ds_read_b64 v[48:49], v9 offset:1856
v_mfma_f32_16x16x32_bf16 v[20:23], v[112:115], v[148:151], v[20:23]
ds_read_b64 v[50:51], v9 offset:1864
v_mfma_f32_16x16x32_bf16 v[24:27], v[112:115], v[152:155], v[24:27]
ds_read_b128 v[80:83], v10 offset:320
ds_read_b64 v[52:53], v9 offset:1344
v_mfma_f32_16x16x32_bf16 v[28:31], v[112:115], v[156:159], v[28:31]
ds_read_b64 v[54:55], v9 offset:1352
v_mfma_f32_16x16x32_bf16 v[32:35], v[112:115], v[160:163], v[32:35]
ds_read_b128 v[84:87], v10 offset:832
ds_read_b64 v[56:57], v9 offset:832
v_mfma_f32_16x16x32_bf16 v[36:39], v[112:115], v[164:167], v[36:39]
ds_read_b64 v[58:59], v9 offset:840
v_mfma_f32_16x16x32_bf16 v[40:43], v[112:115], v[168:171], v[40:43]
ds_read_b128 v[88:91], v10 offset:1344
ds_read_b64 v[60:61], v9 offset:320
v_mfma_f32_16x16x32_bf16 v[44:47], v[112:115], v[172:175], v[44:47]
ds_read_b64 v[62:63], v9 offset:328
v_mfma_f32_16x16x32_bf16 v[20:23], v[116:119], v[144:147], v[20:23]
ds_read_b128 v[92:95], v10 offset:1856
ds_read_b64 v[64:65], v8 offset:1856
v_mfma_f32_16x16x32_bf16 v[24:27], v[116:119], v[148:151], v[24:27]
ds_read_b64 v[66:67], v8 offset:1864
v_mfma_f32_16x16x32_bf16 v[28:31], v[116:119], v[152:155], v[28:31]
ds_read_b128 v[96:99], v10 offset:2368
v_mfma_f32_16x16x32_bf16 v[32:35], v[116:119], v[156:159], v[32:35]
ds_read_b64 v[68:69], v8 offset:1344
ds_read_b64 v[70:71], v8 offset:1352
v_mfma_f32_16x16x32_bf16 v[36:39], v[116:119], v[160:163], v[36:39]
ds_read_b128 v[100:103], v10 offset:2880
v_mfma_f32_16x16x32_bf16 v[40:43], v[116:119], v[164:167], v[40:43]
ds_read_b64 v[72:73], v8 offset:832
ds_read_b64 v[74:75], v8 offset:840
v_mfma_f32_16x16x32_bf16 v[44:47], v[116:119], v[168:171], v[44:47]
ds_read_b128 v[104:107], v10 offset:3392
v_mfma_f32_16x16x32_bf16 v[24:27], v[120:123], v[144:147], v[24:27]
ds_read_b64 v[76:77], v8 offset:320
ds_read_b64 v[78:79], v8 offset:328
v_mfma_f32_16x16x32_bf16 v[28:31], v[120:123], v[148:151], v[28:31]
ds_read_b128 v[108:111], v10 offset:3904
v_mfma_f32_16x16x32_bf16 v[32:35], v[120:123], v[152:155], v[32:35]
v_lshlrev_b32 v176, 16, v208
v_and_b32 v177, 0xffff0000, v208
v_mfma_f32_16x16x32_bf16 v[36:39], v[120:123], v[156:159], v[36:39]
v_mul_f32 v176, v176, v15
v_mfma_f32_16x16x32_bf16 v[40:43], v[120:123], v[160:163], v[40:43]
v_mul_f32 v177, v177, v15
v_mfma_f32_16x16x32_bf16 v[44:47], v[120:123], v[164:167], v[44:47]
v_cvt_pk_bf16_f32 v208, v176, v177
v_lshlrev_b32 v176, 16, v208
v_mfma_f32_16x16x32_bf16 v[28:31], v[124:127], v[144:147], v[28:31]
v_and_b32 v177, 0xffff0000, v208
v_mfma_f32_16x16x32_bf16 v[32:35], v[124:127], v[148:151], v[32:35]
v_lshlrev_b32 v178, 16, v209
v_and_b32 v179, 0xffff0000, v209
v_mfma_f32_16x16x32_bf16 v[36:39], v[124:127], v[152:155], v[36:39]
v_mul_f32 v178, v178, v15
v_mfma_f32_16x16x32_bf16 v[40:43], v[124:127], v[156:159], v[40:43]
v_mul_f32 v179, v179, v15
v_cvt_pk_bf16_f32 v209, v178, v179
v_mfma_f32_16x16x32_bf16 v[44:47], v[124:127], v[160:163], v[44:47]
v_lshlrev_b32 v178, 16, v209
v_mfma_f32_16x16x32_bf16 v[32:35], v[128:131], v[144:147], v[32:35]
v_and_b32 v179, 0xffff0000, v209
v_lshlrev_b32 v180, 16, v210
v_mfma_f32_16x16x32_bf16 v[36:39], v[128:131], v[148:151], v[36:39]
v_and_b32 v181, 0xffff0000, v210
v_mfma_f32_16x16x32_bf16 v[40:43], v[128:131], v[152:155], v[40:43]
v_mul_f32 v180, v180, v15
v_mfma_f32_16x16x32_bf16 v[44:47], v[128:131], v[156:159], v[44:47]
v_mul_f32 v181, v181, v15
v_cvt_pk_bf16_f32 v210, v180, v181
v_mfma_f32_16x16x32_bf16 v[36:39], v[132:135], v[144:147], v[36:39]
v_lshlrev_b32 v180, 16, v210
v_mfma_f32_16x16x32_bf16 v[40:43], v[132:135], v[148:151], v[40:43]
v_and_b32 v181, 0xffff0000, v210
v_lshlrev_b32 v182, 16, v211
v_mfma_f32_16x16x32_bf16 v[44:47], v[132:135], v[152:155], v[44:47]
v_and_b32 v183, 0xffff0000, v211
v_mfma_f32_16x16x32_bf16 v[40:43], v[136:139], v[144:147], v[40:43]
v_mul_f32 v182, v182, v15
v_mul_f32 v183, v183, v15
v_mfma_f32_16x16x32_bf16 v[44:47], v[136:139], v[148:151], v[44:47]
v_cvt_pk_bf16_f32 v211, v182, v183
v_mfma_f32_16x16x32_bf16 v[44:47], v[140:143], v[144:147], v[44:47]
v_lshlrev_b32 v182, 16, v211
v_and_b32 v183, 0xffff0000, v211
s_waitcnt lgkmcnt(0)
v_mfma_f32_16x16x32_bf16 v[16:19], v[48:51], v[80:83], v[16:19]
ds_read_b64 v[112:113], v9 offset:1792
v_mfma_f32_16x16x32_bf16 v[20:23], v[48:51], v[84:87], v[20:23]
ds_read_b64 v[114:115], v9 offset:1800
v_mfma_f32_16x16x32_bf16 v[24:27], v[48:51], v[88:91], v[24:27]
ds_read_b128 v[144:147], v10 offset:256
ds_read_b64 v[116:117], v9 offset:1280
v_mfma_f32_16x16x32_bf16 v[28:31], v[48:51], v[92:95], v[28:31]
ds_read_b64 v[118:119], v9 offset:1288
v_mfma_f32_16x16x32_bf16 v[32:35], v[48:51], v[96:99], v[32:35]
ds_read_b128 v[148:151], v10 offset:768
ds_read_b64 v[120:121], v9 offset:768
v_mfma_f32_16x16x32_bf16 v[36:39], v[48:51], v[100:103], v[36:39]
ds_read_b64 v[122:123], v9 offset:776
v_mfma_f32_16x16x32_bf16 v[40:43], v[48:51], v[104:107], v[40:43]
ds_read_b128 v[152:155], v10 offset:1280
ds_read_b64 v[124:125], v9 offset:256
v_mfma_f32_16x16x32_bf16 v[44:47], v[48:51], v[108:111], v[44:47]
ds_read_b64 v[126:127], v9 offset:264
v_mfma_f32_16x16x32_bf16 v[20:23], v[52:55], v[80:83], v[20:23]
ds_read_b128 v[156:159], v10 offset:1792
ds_read_b64 v[128:129], v8 offset:1792
v_mfma_f32_16x16x32_bf16 v[24:27], v[52:55], v[84:87], v[24:27]
ds_read_b64 v[130:131], v8 offset:1800
v_mfma_f32_16x16x32_bf16 v[28:31], v[52:55], v[88:91], v[28:31]
ds_read_b128 v[160:163], v10 offset:2304
v_mfma_f32_16x16x32_bf16 v[32:35], v[52:55], v[92:95], v[32:35]
ds_read_b64 v[132:133], v8 offset:1280
ds_read_b64 v[134:135], v8 offset:1288
v_mfma_f32_16x16x32_bf16 v[36:39], v[52:55], v[96:99], v[36:39]
ds_read_b128 v[164:167], v10 offset:2816
v_mfma_f32_16x16x32_bf16 v[40:43], v[52:55], v[100:103], v[40:43]
ds_read_b64 v[136:137], v8 offset:768
ds_read_b64 v[138:139], v8 offset:776
v_mfma_f32_16x16x32_bf16 v[44:47], v[52:55], v[104:107], v[44:47]
ds_read_b128 v[168:171], v10 offset:3328
v_mfma_f32_16x16x32_bf16 v[24:27], v[56:59], v[80:83], v[24:27]
ds_read_b64 v[140:141], v8 offset:256
ds_read_b64 v[142:143], v8 offset:264
v_mfma_f32_16x16x32_bf16 v[28:31], v[56:59], v[84:87], v[28:31]
ds_read_b128 v[172:175], v10 offset:3840
v_mfma_f32_16x16x32_bf16 v[32:35], v[56:59], v[88:91], v[32:35]
v_lshlrev_b32 v184, 16, v212
v_and_b32 v185, 0xffff0000, v212
v_mfma_f32_16x16x32_bf16 v[36:39], v[56:59], v[92:95], v[36:39]
v_mul_f32 v184, v184, v15
v_mfma_f32_16x16x32_bf16 v[40:43], v[56:59], v[96:99], v[40:43]
v_mul_f32 v185, v185, v15
v_mfma_f32_16x16x32_bf16 v[44:47], v[56:59], v[100:103], v[44:47]
v_cvt_pk_bf16_f32 v212, v184, v185
v_lshlrev_b32 v184, 16, v212
v_mfma_f32_16x16x32_bf16 v[28:31], v[60:63], v[80:83], v[28:31]
v_and_b32 v185, 0xffff0000, v212
v_mfma_f32_16x16x32_bf16 v[32:35], v[60:63], v[84:87], v[32:35]
v_lshlrev_b32 v186, 16, v213
v_and_b32 v187, 0xffff0000, v213
v_mfma_f32_16x16x32_bf16 v[36:39], v[60:63], v[88:91], v[36:39]
v_mul_f32 v186, v186, v15
v_mfma_f32_16x16x32_bf16 v[40:43], v[60:63], v[92:95], v[40:43]
v_mul_f32 v187, v187, v15
v_cvt_pk_bf16_f32 v213, v186, v187
v_mfma_f32_16x16x32_bf16 v[44:47], v[60:63], v[96:99], v[44:47]
v_lshlrev_b32 v186, 16, v213
v_mfma_f32_16x16x32_bf16 v[32:35], v[64:67], v[80:83], v[32:35]
v_and_b32 v187, 0xffff0000, v213
v_lshlrev_b32 v188, 16, v214
v_mfma_f32_16x16x32_bf16 v[36:39], v[64:67], v[84:87], v[36:39]
v_and_b32 v189, 0xffff0000, v214
v_mfma_f32_16x16x32_bf16 v[40:43], v[64:67], v[88:91], v[40:43]
v_mul_f32 v188, v188, v15
v_mfma_f32_16x16x32_bf16 v[44:47], v[64:67], v[92:95], v[44:47]
v_mul_f32 v189, v189, v15
v_cvt_pk_bf16_f32 v214, v188, v189
v_mfma_f32_16x16x32_bf16 v[36:39], v[68:71], v[80:83], v[36:39]
v_lshlrev_b32 v188, 16, v214
v_mfma_f32_16x16x32_bf16 v[40:43], v[68:71], v[84:87], v[40:43]
v_and_b32 v189, 0xffff0000, v214
v_lshlrev_b32 v190, 16, v215
v_mfma_f32_16x16x32_bf16 v[44:47], v[68:71], v[88:91], v[44:47]
v_and_b32 v191, 0xffff0000, v215
v_mfma_f32_16x16x32_bf16 v[40:43], v[72:75], v[80:83], v[40:43]
v_mul_f32 v190, v190, v15
v_mul_f32 v191, v191, v15
v_mfma_f32_16x16x32_bf16 v[44:47], v[72:75], v[84:87], v[44:47]
v_cvt_pk_bf16_f32 v215, v190, v191
v_mfma_f32_16x16x32_bf16 v[44:47], v[76:79], v[80:83], v[44:47]
v_lshlrev_b32 v190, 16, v215
v_and_b32 v191, 0xffff0000, v215
s_waitcnt lgkmcnt(0)
v_mfma_f32_16x16x32_bf16 v[16:19], v[112:115], v[144:147], v[16:19]
ds_read_b64 v[48:49], v9 offset:1728
v_mfma_f32_16x16x32_bf16 v[20:23], v[112:115], v[148:151], v[20:23]
ds_read_b64 v[50:51], v9 offset:1736
v_mfma_f32_16x16x32_bf16 v[24:27], v[112:115], v[152:155], v[24:27]
ds_read_b128 v[80:83], v10 offset:192
ds_read_b64 v[52:53], v9 offset:1216
v_mfma_f32_16x16x32_bf16 v[28:31], v[112:115], v[156:159], v[28:31]
ds_read_b64 v[54:55], v9 offset:1224
v_mfma_f32_16x16x32_bf16 v[32:35], v[112:115], v[160:163], v[32:35]
ds_read_b128 v[84:87], v10 offset:704
ds_read_b64 v[56:57], v9 offset:704
v_mfma_f32_16x16x32_bf16 v[36:39], v[112:115], v[164:167], v[36:39]
ds_read_b64 v[58:59], v9 offset:712
v_mfma_f32_16x16x32_bf16 v[40:43], v[112:115], v[168:171], v[40:43]
ds_read_b128 v[88:91], v10 offset:1216
ds_read_b64 v[60:61], v9 offset:192
v_mfma_f32_16x16x32_bf16 v[44:47], v[112:115], v[172:175], v[44:47]
ds_read_b64 v[62:63], v9 offset:200
v_mfma_f32_16x16x32_bf16 v[20:23], v[116:119], v[144:147], v[20:23]
ds_read_b128 v[92:95], v10 offset:1728
ds_read_b64 v[64:65], v8 offset:1728
v_mfma_f32_16x16x32_bf16 v[24:27], v[116:119], v[148:151], v[24:27]
ds_read_b64 v[66:67], v8 offset:1736
v_mfma_f32_16x16x32_bf16 v[28:31], v[116:119], v[152:155], v[28:31]
ds_read_b128 v[96:99], v10 offset:2240
v_mfma_f32_16x16x32_bf16 v[32:35], v[116:119], v[156:159], v[32:35]
ds_read_b64 v[68:69], v8 offset:1216
ds_read_b64 v[70:71], v8 offset:1224
v_mfma_f32_16x16x32_bf16 v[36:39], v[116:119], v[160:163], v[36:39]
ds_read_b128 v[100:103], v10 offset:2752
v_mfma_f32_16x16x32_bf16 v[40:43], v[116:119], v[164:167], v[40:43]
ds_read_b64 v[72:73], v8 offset:704
ds_read_b64 v[74:75], v8 offset:712
v_mfma_f32_16x16x32_bf16 v[44:47], v[116:119], v[168:171], v[44:47]
ds_read_b128 v[104:107], v10 offset:3264
v_mfma_f32_16x16x32_bf16 v[24:27], v[120:123], v[144:147], v[24:27]
ds_read_b64 v[76:77], v8 offset:192
ds_read_b64 v[78:79], v8 offset:200
v_mfma_f32_16x16x32_bf16 v[28:31], v[120:123], v[148:151], v[28:31]
ds_read_b128 v[108:111], v10 offset:3776
v_mfma_f32_16x16x32_bf16 v[32:35], v[120:123], v[152:155], v[32:35]
v_lshlrev_b32 v192, 16, v216
v_and_b32 v193, 0xffff0000, v216
v_mfma_f32_16x16x32_bf16 v[36:39], v[120:123], v[156:159], v[36:39]
v_mul_f32 v192, v192, v15
v_mfma_f32_16x16x32_bf16 v[40:43], v[120:123], v[160:163], v[40:43]
v_mul_f32 v193, v193, v15
v_mfma_f32_16x16x32_bf16 v[44:47], v[120:123], v[164:167], v[44:47]
v_cvt_pk_bf16_f32 v216, v192, v193
v_lshlrev_b32 v192, 16, v216
v_mfma_f32_16x16x32_bf16 v[28:31], v[124:127], v[144:147], v[28:31]
v_and_b32 v193, 0xffff0000, v216
v_mfma_f32_16x16x32_bf16 v[32:35], v[124:127], v[148:151], v[32:35]
v_lshlrev_b32 v194, 16, v217
v_and_b32 v195, 0xffff0000, v217
v_mfma_f32_16x16x32_bf16 v[36:39], v[124:127], v[152:155], v[36:39]
v_mul_f32 v194, v194, v15
v_mfma_f32_16x16x32_bf16 v[40:43], v[124:127], v[156:159], v[40:43]
v_mul_f32 v195, v195, v15
v_cvt_pk_bf16_f32 v217, v194, v195
v_mfma_f32_16x16x32_bf16 v[44:47], v[124:127], v[160:163], v[44:47]
v_lshlrev_b32 v194, 16, v217
v_mfma_f32_16x16x32_bf16 v[32:35], v[128:131], v[144:147], v[32:35]
v_and_b32 v195, 0xffff0000, v217
v_lshlrev_b32 v196, 16, v218
v_mfma_f32_16x16x32_bf16 v[36:39], v[128:131], v[148:151], v[36:39]
v_and_b32 v197, 0xffff0000, v218
v_mfma_f32_16x16x32_bf16 v[40:43], v[128:131], v[152:155], v[40:43]
v_mul_f32 v196, v196, v15
v_mfma_f32_16x16x32_bf16 v[44:47], v[128:131], v[156:159], v[44:47]
v_mul_f32 v197, v197, v15
v_cvt_pk_bf16_f32 v218, v196, v197
v_mfma_f32_16x16x32_bf16 v[36:39], v[132:135], v[144:147], v[36:39]
v_lshlrev_b32 v196, 16, v218
v_mfma_f32_16x16x32_bf16 v[40:43], v[132:135], v[148:151], v[40:43]
v_and_b32 v197, 0xffff0000, v218
v_lshlrev_b32 v198, 16, v219
v_mfma_f32_16x16x32_bf16 v[44:47], v[132:135], v[152:155], v[44:47]
v_and_b32 v199, 0xffff0000, v219
v_mfma_f32_16x16x32_bf16 v[40:43], v[136:139], v[144:147], v[40:43]
v_mul_f32 v198, v198, v15
v_mul_f32 v199, v199, v15
v_mfma_f32_16x16x32_bf16 v[44:47], v[136:139], v[148:151], v[44:47]
v_cvt_pk_bf16_f32 v219, v198, v199
v_mfma_f32_16x16x32_bf16 v[44:47], v[140:143], v[144:147], v[44:47]
v_lshlrev_b32 v198, 16, v219
v_and_b32 v199, 0xffff0000, v219
s_waitcnt lgkmcnt(0)
v_mfma_f32_16x16x32_bf16 v[16:19], v[48:51], v[80:83], v[16:19]
ds_read_b64 v[112:113], v9 offset:1664
v_mfma_f32_16x16x32_bf16 v[20:23], v[48:51], v[84:87], v[20:23]
ds_read_b64 v[114:115], v9 offset:1672
v_mfma_f32_16x16x32_bf16 v[24:27], v[48:51], v[88:91], v[24:27]
ds_read_b128 v[144:147], v10 offset:128
ds_read_b64 v[116:117], v9 offset:1152
v_mfma_f32_16x16x32_bf16 v[28:31], v[48:51], v[92:95], v[28:31]
ds_read_b64 v[118:119], v9 offset:1160
v_mfma_f32_16x16x32_bf16 v[32:35], v[48:51], v[96:99], v[32:35]
ds_read_b128 v[148:151], v10 offset:640
ds_read_b64 v[120:121], v9 offset:640
v_mfma_f32_16x16x32_bf16 v[36:39], v[48:51], v[100:103], v[36:39]
ds_read_b64 v[122:123], v9 offset:648
v_mfma_f32_16x16x32_bf16 v[40:43], v[48:51], v[104:107], v[40:43]
ds_read_b128 v[152:155], v10 offset:1152
ds_read_b64 v[124:125], v9 offset:128
v_mfma_f32_16x16x32_bf16 v[44:47], v[48:51], v[108:111], v[44:47]
ds_read_b64 v[126:127], v9 offset:136
v_mfma_f32_16x16x32_bf16 v[20:23], v[52:55], v[80:83], v[20:23]
ds_read_b128 v[156:159], v10 offset:1664
ds_read_b64 v[128:129], v8 offset:1664
v_mfma_f32_16x16x32_bf16 v[24:27], v[52:55], v[84:87], v[24:27]
ds_read_b64 v[130:131], v8 offset:1672
v_mfma_f32_16x16x32_bf16 v[28:31], v[52:55], v[88:91], v[28:31]
ds_read_b128 v[160:163], v10 offset:2176
v_mfma_f32_16x16x32_bf16 v[32:35], v[52:55], v[92:95], v[32:35]
ds_read_b64 v[132:133], v8 offset:1152
ds_read_b64 v[134:135], v8 offset:1160
v_mfma_f32_16x16x32_bf16 v[36:39], v[52:55], v[96:99], v[36:39]
ds_read_b128 v[164:167], v10 offset:2688
v_mfma_f32_16x16x32_bf16 v[40:43], v[52:55], v[100:103], v[40:43]
ds_read_b64 v[136:137], v8 offset:640
ds_read_b64 v[138:139], v8 offset:648
v_mfma_f32_16x16x32_bf16 v[44:47], v[52:55], v[104:107], v[44:47]
ds_read_b128 v[168:171], v10 offset:3200
v_mfma_f32_16x16x32_bf16 v[24:27], v[56:59], v[80:83], v[24:27]
ds_read_b64 v[140:141], v8 offset:128
ds_read_b64 v[142:143], v8 offset:136
v_mfma_f32_16x16x32_bf16 v[28:31], v[56:59], v[84:87], v[28:31]
ds_read_b128 v[172:175], v10 offset:3712
v_mfma_f32_16x16x32_bf16 v[32:35], v[56:59], v[88:91], v[32:35]
v_lshlrev_b32 v200, 16, v220
v_and_b32 v201, 0xffff0000, v220
v_mfma_f32_16x16x32_bf16 v[36:39], v[56:59], v[92:95], v[36:39]
v_mul_f32 v200, v200, v15
v_mfma_f32_16x16x32_bf16 v[40:43], v[56:59], v[96:99], v[40:43]
v_mul_f32 v201, v201, v15
v_mfma_f32_16x16x32_bf16 v[44:47], v[56:59], v[100:103], v[44:47]
v_cvt_pk_bf16_f32 v220, v200, v201
v_lshlrev_b32 v200, 16, v220
v_mfma_f32_16x16x32_bf16 v[28:31], v[60:63], v[80:83], v[28:31]
v_and_b32 v201, 0xffff0000, v220
v_mfma_f32_16x16x32_bf16 v[32:35], v[60:63], v[84:87], v[32:35]
v_lshlrev_b32 v202, 16, v221
v_and_b32 v203, 0xffff0000, v221
v_mfma_f32_16x16x32_bf16 v[36:39], v[60:63], v[88:91], v[36:39]
v_mul_f32 v202, v202, v15
v_mfma_f32_16x16x32_bf16 v[40:43], v[60:63], v[92:95], v[40:43]
v_mul_f32 v203, v203, v15
v_cvt_pk_bf16_f32 v221, v202, v203
v_mfma_f32_16x16x32_bf16 v[44:47], v[60:63], v[96:99], v[44:47]
v_lshlrev_b32 v202, 16, v221
v_mfma_f32_16x16x32_bf16 v[32:35], v[64:67], v[80:83], v[32:35]
v_and_b32 v203, 0xffff0000, v221
v_lshlrev_b32 v204, 16, v222
v_mfma_f32_16x16x32_bf16 v[36:39], v[64:67], v[84:87], v[36:39]
v_and_b32 v205, 0xffff0000, v222
v_mfma_f32_16x16x32_bf16 v[40:43], v[64:67], v[88:91], v[40:43]
v_mul_f32 v204, v204, v15
v_mfma_f32_16x16x32_bf16 v[44:47], v[64:67], v[92:95], v[44:47]
v_mul_f32 v205, v205, v15
v_cvt_pk_bf16_f32 v222, v204, v205
v_mfma_f32_16x16x32_bf16 v[36:39], v[68:71], v[80:83], v[36:39]
v_lshlrev_b32 v204, 16, v222
v_mfma_f32_16x16x32_bf16 v[40:43], v[68:71], v[84:87], v[40:43]
v_and_b32 v205, 0xffff0000, v222
v_lshlrev_b32 v206, 16, v223
v_mfma_f32_16x16x32_bf16 v[44:47], v[68:71], v[88:91], v[44:47]
v_and_b32 v207, 0xffff0000, v223
v_mfma_f32_16x16x32_bf16 v[40:43], v[72:75], v[80:83], v[40:43]
v_mul_f32 v206, v206, v15
v_mul_f32 v207, v207, v15
v_mfma_f32_16x16x32_bf16 v[44:47], v[72:75], v[84:87], v[44:47]
v_cvt_pk_bf16_f32 v223, v206, v207
v_mfma_f32_16x16x32_bf16 v[44:47], v[76:79], v[80:83], v[44:47]
v_lshlrev_b32 v206, 16, v223
v_and_b32 v207, 0xffff0000, v223
s_mul_i32 s72, s80, 4096
s_add_u32 s72, s72, 0x780000
v_lshlrev_b32 v12, 4, v0
v_mov_b32 v224, -1
v_mov_b32 v225, -1
v_mov_b32 v226, -1
v_mov_b32 v227, -1
buffer_store_dwordx4 v[224:227], v12, s[16:19], s72 offen offset:0 sc1
buffer_store_dwordx4 v[224:227], v12, s[16:19], s72 offen offset:1024 sc1
buffer_store_dwordx4 v[224:227], v12, s[16:19], s72 offen offset:2048 sc1
buffer_store_dwordx4 v[224:227], v12, s[16:19], s72 offen offset:3072 sc1
s_waitcnt lgkmcnt(0)
v_mfma_f32_16x16x32_bf16 v[16:19], v[112:115], v[144:147], v[16:19]
v_mfma_f32_16x16x32_bf16 v[20:23], v[112:115], v[148:151], v[20:23]
ds_read_b64 v[48:49], v9 offset:1600
v_mfma_f32_16x16x32_bf16 v[24:27], v[112:115], v[152:155], v[24:27]
ds_read_b64 v[50:51], v9 offset:1608
v_mfma_f32_16x16x32_bf16 v[28:31], v[112:115], v[156:159], v[28:31]
v_mfma_f32_16x16x32_bf16 v[32:35], v[112:115], v[160:163], v[32:35]
ds_read_b128 v[80:83], v10 offset:64
v_mfma_f32_16x16x32_bf16 v[36:39], v[112:115], v[164:167], v[36:39]
ds_read_b64 v[52:53], v9 offset:1088
v_mfma_f32_16x16x32_bf16 v[40:43], v[112:115], v[168:171], v[40:43]
v_mfma_f32_16x16x32_bf16 v[44:47], v[112:115], v[172:175], v[44:47]
ds_read_b64 v[54:55], v9 offset:1096
v_mfma_f32_16x16x32_bf16 v[20:23], v[116:119], v[144:147], v[20:23]
ds_read_b128 v[84:87], v10 offset:576
v_mfma_f32_16x16x32_bf16 v[24:27], v[116:119], v[148:151], v[24:27]
v_mfma_f32_16x16x32_bf16 v[28:31], v[116:119], v[152:155], v[28:31]
ds_read_b64 v[56:57], v9 offset:576
v_mfma_f32_16x16x32_bf16 v[32:35], v[116:119], v[156:159], v[32:35]
ds_read_b64 v[58:59], v9 offset:584
v_mfma_f32_16x16x32_bf16 v[36:39], v[116:119], v[160:163], v[36:39]
v_mfma_f32_16x16x32_bf16 v[40:43], v[116:119], v[164:167], v[40:43]
ds_read_b128 v[88:91], v10 offset:1088
v_mfma_f32_16x16x32_bf16 v[44:47], v[116:119], v[168:171], v[44:47]
ds_read_b64 v[60:61], v9 offset:64
v_mfma_f32_16x16x32_bf16 v[24:27], v[120:123], v[144:147], v[24:27]
v_mfma_f32_16x16x32_bf16 v[28:31], v[120:123], v[148:151], v[28:31]
ds_read_b64 v[62:63], v9 offset:72
v_mfma_f32_16x16x32_bf16 v[32:35], v[120:123], v[152:155], v[32:35]
ds_read_b128 v[92:95], v10 offset:1600
v_mfma_f32_16x16x32_bf16 v[36:39], v[120:123], v[156:159], v[36:39]
v_mfma_f32_16x16x32_bf16 v[40:43], v[120:123], v[160:163], v[40:43]
ds_read_b64 v[64:65], v8 offset:1600
v_mfma_f32_16x16x32_bf16 v[44:47], v[120:123], v[164:167], v[44:47]
ds_read_b64 v[66:67], v8 offset:1608
v_mfma_f32_16x16x32_bf16 v[28:31], v[124:127], v[144:147], v[28:31]
v_mfma_f32_16x16x32_bf16 v[32:35], v[124:127], v[148:151], v[32:35]
ds_read_b128 v[96:99], v10 offset:2112
v_mfma_f32_16x16x32_bf16 v[36:39], v[124:127], v[152:155], v[36:39]
ds_read_b64 v[68:69], v8 offset:1088
v_mfma_f32_16x16x32_bf16 v[40:43], v[124:127], v[156:159], v[40:43]
v_mfma_f32_16x16x32_bf16 v[44:47], v[124:127], v[160:163], v[44:47]
ds_read_b64 v[70:71], v8 offset:1096
v_mfma_f32_16x16x32_bf16 v[32:35], v[128:131], v[144:147], v[32:35]
ds_read_b128 v[100:103], v10 offset:2624
v_mfma_f32_16x16x32_bf16 v[36:39], v[128:131], v[148:151], v[36:39]
v_mfma_f32_16x16x32_bf16 v[40:43], v[128:131], v[152:155], v[40:43]
ds_read_b64 v[72:73], v8 offset:576
v_mfma_f32_16x16x32_bf16 v[44:47], v[128:131], v[156:159], v[44:47]
ds_read_b64 v[74:75], v8 offset:584
v_mfma_f32_16x16x32_bf16 v[36:39], v[132:135], v[144:147], v[36:39]
v_mfma_f32_16x16x32_bf16 v[40:43], v[132:135], v[148:151], v[40:43]
ds_read_b128 v[104:107], v10 offset:3136
v_mfma_f32_16x16x32_bf16 v[44:47], v[132:135], v[152:155], v[44:47]
ds_read_b64 v[76:77], v8 offset:64
v_mfma_f32_16x16x32_bf16 v[40:43], v[136:139], v[144:147], v[40:43]
v_mfma_f32_16x16x32_bf16 v[44:47], v[136:139], v[148:151], v[44:47]
ds_read_b64 v[78:79], v8 offset:72
v_mfma_f32_16x16x32_bf16 v[44:47], v[140:143], v[144:147], v[44:47]
ds_read_b128 v[108:111], v10 offset:3648
s_waitcnt lgkmcnt(0)
v_mfma_f32_16x16x32_bf16 v[16:19], v[48:51], v[80:83], v[16:19]
v_mfma_f32_16x16x32_bf16 v[20:23], v[48:51], v[84:87], v[20:23]
ds_read_b64 v[112:113], v9 offset:1536
v_mfma_f32_16x16x32_bf16 v[24:27], v[48:51], v[88:91], v[24:27]
ds_read_b64 v[114:115], v9 offset:1544
v_mfma_f32_16x16x32_bf16 v[28:31], v[48:51], v[92:95], v[28:31]
v_mfma_f32_16x16x32_bf16 v[32:35], v[48:51], v[96:99], v[32:35]
ds_read_b128 v[144:147], v10 offset:0
v_mfma_f32_16x16x32_bf16 v[36:39], v[48:51], v[100:103], v[36:39]
ds_read_b64 v[116:117], v9 offset:1024
v_mfma_f32_16x16x32_bf16 v[40:43], v[48:51], v[104:107], v[40:43]
v_mfma_f32_16x16x32_bf16 v[44:47], v[48:51], v[108:111], v[44:47]
ds_read_b64 v[118:119], v9 offset:1032
v_mfma_f32_16x16x32_bf16 v[20:23], v[52:55], v[80:83], v[20:23]
ds_read_b128 v[148:151], v10 offset:512
v_mfma_f32_16x16x32_bf16 v[24:27], v[52:55], v[84:87], v[24:27]
v_mfma_f32_16x16x32_bf16 v[28:31], v[52:55], v[88:91], v[28:31]
ds_read_b64 v[120:121], v9 offset:512
v_mfma_f32_16x16x32_bf16 v[32:35], v[52:55], v[92:95], v[32:35]
ds_read_b64 v[122:123], v9 offset:520
v_mfma_f32_16x16x32_bf16 v[36:39], v[52:55], v[96:99], v[36:39]
v_mfma_f32_16x16x32_bf16 v[40:43], v[52:55], v[100:103], v[40:43]
ds_read_b128 v[152:155], v10 offset:1024
v_mfma_f32_16x16x32_bf16 v[44:47], v[52:55], v[104:107], v[44:47]
ds_read_b64 v[124:125], v9 offset:0
v_mfma_f32_16x16x32_bf16 v[24:27], v[56:59], v[80:83], v[24:27]
v_mfma_f32_16x16x32_bf16 v[28:31], v[56:59], v[84:87], v[28:31]
ds_read_b64 v[126:127], v9 offset:8
v_mfma_f32_16x16x32_bf16 v[32:35], v[56:59], v[88:91], v[32:35]
ds_read_b128 v[156:159], v10 offset:1536
v_mfma_f32_16x16x32_bf16 v[36:39], v[56:59], v[92:95], v[36:39]
v_mfma_f32_16x16x32_bf16 v[40:43], v[56:59], v[96:99], v[40:43]
ds_read_b64 v[128:129], v8 offset:1536
v_mfma_f32_16x16x32_bf16 v[44:47], v[56:59], v[100:103], v[44:47]
ds_read_b64 v[130:131], v8 offset:1544
v_mfma_f32_16x16x32_bf16 v[28:31], v[60:63], v[80:83], v[28:31]
v_mfma_f32_16x16x32_bf16 v[32:35], v[60:63], v[84:87], v[32:35]
ds_read_b128 v[160:163], v10 offset:2048
v_mfma_f32_16x16x32_bf16 v[36:39], v[60:63], v[88:91], v[36:39]
ds_read_b64 v[132:133], v8 offset:1024
v_mfma_f32_16x16x32_bf16 v[40:43], v[60:63], v[92:95], v[40:43]
v_mfma_f32_16x16x32_bf16 v[44:47], v[60:63], v[96:99], v[44:47]
ds_read_b64 v[134:135], v8 offset:1032
v_mfma_f32_16x16x32_bf16 v[32:35], v[64:67], v[80:83], v[32:35]
ds_read_b128 v[164:167], v10 offset:2560
v_mfma_f32_16x16x32_bf16 v[36:39], v[64:67], v[84:87], v[36:39]
v_mfma_f32_16x16x32_bf16 v[40:43], v[64:67], v[88:91], v[40:43]
ds_read_b64 v[136:137], v8 offset:512
v_mfma_f32_16x16x32_bf16 v[44:47], v[64:67], v[92:95], v[44:47]
ds_read_b64 v[138:139], v8 offset:520
v_mfma_f32_16x16x32_bf16 v[36:39], v[68:71], v[80:83], v[36:39]
v_mfma_f32_16x16x32_bf16 v[40:43], v[68:71], v[84:87], v[40:43]
ds_read_b128 v[168:171], v10 offset:3072
v_mfma_f32_16x16x32_bf16 v[44:47], v[68:71], v[88:91], v[44:47]
ds_read_b64 v[140:141], v8 offset:0
v_mfma_f32_16x16x32_bf16 v[40:43], v[72:75], v[80:83], v[40:43]
v_mfma_f32_16x16x32_bf16 v[44:47], v[72:75], v[84:87], v[44:47]
ds_read_b64 v[142:143], v8 offset:8
v_mfma_f32_16x16x32_bf16 v[44:47], v[76:79], v[80:83], v[44:47]
ds_read_b128 v[172:175], v10 offset:3584
s_waitcnt lgkmcnt(0)
s_waitcnt vmcnt(0)
s_mov_b64 exec, 1
buffer_store_dword v229, v228, s[16:19], 0 offen sc1
ds_add_u32 v230, v231 offset:96
s_mov_b64 exec, -1
v_mfma_f32_16x16x32_bf16 v[16:19], v[112:115], v[144:147], v[16:19]
v_mfma_f32_16x16x32_bf16 v[20:23], v[112:115], v[148:151], v[20:23]
v_mfma_f32_16x16x32_bf16 v[24:27], v[112:115], v[152:155], v[24:27]
v_mfma_f32_16x16x32_bf16 v[28:31], v[112:115], v[156:159], v[28:31]
v_mfma_f32_16x16x32_bf16 v[32:35], v[112:115], v[160:163], v[32:35]
v_mfma_f32_16x16x32_bf16 v[36:39], v[112:115], v[164:167], v[36:39]
v_mfma_f32_16x16x32_bf16 v[40:43], v[112:115], v[168:171], v[40:43]
v_mfma_f32_16x16x32_bf16 v[44:47], v[112:115], v[172:175], v[44:47]
v_mfma_f32_16x16x32_bf16 v[20:23], v[116:119], v[144:147], v[20:23]
v_mfma_f32_16x16x32_bf16 v[24:27], v[116:119], v[148:151], v[24:27]
v_mfma_f32_16x16x32_bf16 v[28:31], v[116:119], v[152:155], v[28:31]
v_mfma_f32_16x16x32_bf16 v[32:35], v[116:119], v[156:159], v[32:35]
v_mfma_f32_16x16x32_bf16 v[36:39], v[116:119], v[160:163], v[36:39]
v_mfma_f32_16x16x32_bf16 v[40:43], v[116:119], v[164:167], v[40:43]
v_mfma_f32_16x16x32_bf16 v[44:47], v[116:119], v[168:171], v[44:47]
v_mfma_f32_16x16x32_bf16 v[24:27], v[120:123], v[144:147], v[24:27]
v_mfma_f32_16x16x32_bf16 v[28:31], v[120:123], v[148:151], v[28:31]
v_mfma_f32_16x16x32_bf16 v[32:35], v[120:123], v[152:155], v[32:35]
v_mfma_f32_16x16x32_bf16 v[36:39], v[120:123], v[156:159], v[36:39]
v_mfma_f32_16x16x32_bf16 v[40:43], v[120:123], v[160:163], v[40:43]
v_mfma_f32_16x16x32_bf16 v[44:47], v[120:123], v[164:167], v[44:47]
v_mfma_f32_16x16x32_bf16 v[28:31], v[124:127], v[144:147], v[28:31]
v_mfma_f32_16x16x32_bf16 v[32:35], v[124:127], v[148:151], v[32:35]
v_mfma_f32_16x16x32_bf16 v[36:39], v[124:127], v[152:155], v[36:39]
v_mfma_f32_16x16x32_bf16 v[40:43], v[124:127], v[156:159], v[40:43]
v_mfma_f32_16x16x32_bf16 v[44:47], v[124:127], v[160:163], v[44:47]
v_mfma_f32_16x16x32_bf16 v[32:35], v[128:131], v[144:147], v[32:35]
v_mfma_f32_16x16x32_bf16 v[36:39], v[128:131], v[148:151], v[36:39]
v_mfma_f32_16x16x32_bf16 v[40:43], v[128:131], v[152:155], v[40:43]
v_mfma_f32_16x16x32_bf16 v[44:47], v[128:131], v[156:159], v[44:47]
v_mfma_f32_16x16x32_bf16 v[36:39], v[132:135], v[144:147], v[36:39]
v_mfma_f32_16x16x32_bf16 v[40:43], v[132:135], v[148:151], v[40:43]
v_mfma_f32_16x16x32_bf16 v[44:47], v[132:135], v[152:155], v[44:47]
v_mfma_f32_16x16x32_bf16 v[40:43], v[136:139], v[144:147], v[40:43]
v_mfma_f32_16x16x32_bf16 v[44:47], v[136:139], v[148:151], v[44:47]
v_mfma_f32_16x16x32_bf16 v[44:47], v[140:143], v[144:147], v[44:47]
s_setprio 1
s_mov_b32 s76, 0x00003f80
s_mov_b32 s77, 0x3f800000
v_cvt_pk_bf16_f32 v8, v16, v17
v_cvt_pk_bf16_f32 v9, v18, v19
v_cvt_pk_bf16_f32 v10, v20, v21
v_cvt_pk_bf16_f32 v11, v22, v23
v_dot2_f32_bf16 v16, v8, s76, v176
v_dot2_f32_bf16 v17, v8, s77, v177
v_dot2_f32_bf16 v18, v9, s76, v178
v_dot2_f32_bf16 v19, v9, s77, v179
v_dot2_f32_bf16 v20, v10, s76, v180
v_dot2_f32_bf16 v21, v10, s77, v181
v_dot2_f32_bf16 v22, v11, s76, v182
v_dot2_f32_bf16 v23, v11, s77, v183
v_cvt_pk_bf16_f32 v48, v16, v17
v_cvt_pk_bf16_f32 v49, v18, v19
v_cvt_pk_bf16_f32 v50, v20, v21
v_cvt_pk_bf16_f32 v51, v22, v23
s_nop 0
v_permlane16_swap_b32 v48, v50
v_permlane16_swap_b32 v49, v51
v_cvt_pk_bf16_f32 v8, v24, v25
v_cvt_pk_bf16_f32 v9, v26, v27
v_cvt_pk_bf16_f32 v10, v28, v29
v_cvt_pk_bf16_f32 v11, v30, v31
v_dot2_f32_bf16 v24, v8, s76, v184
v_dot2_f32_bf16 v25, v8, s77, v185
v_dot2_f32_bf16 v26, v9, s76, v186
v_dot2_f32_bf16 v27, v9, s77, v187
v_dot2_f32_bf16 v28, v10, s76, v188
v_dot2_f32_bf16 v29, v10, s77, v189
v_dot2_f32_bf16 v30, v11, s76, v190
v_dot2_f32_bf16 v31, v11, s77, v191
v_cvt_pk_bf16_f32 v56, v24, v25
v_cvt_pk_bf16_f32 v57, v26, v27
v_cvt_pk_bf16_f32 v58, v28, v29
v_cvt_pk_bf16_f32 v59, v30, v31
s_nop 0
v_permlane16_swap_b32 v56, v58
v_permlane16_swap_b32 v57, v59
v_cvt_pk_bf16_f32 v8, v32, v33
v_cvt_pk_bf16_f32 v9, v34, v35
v_cvt_pk_bf16_f32 v10, v36, v37
v_cvt_pk_bf16_f32 v11, v38, v39
v_dot2_f32_bf16 v32, v8, s76, v192
v_dot2_f32_bf16 v33, v8, s77, v193
v_dot2_f32_bf16 v34, v9, s76, v194
v_dot2_f32_bf16 v35, v9, s77, v195
v_dot2_f32_bf16 v36, v10, s76, v196
v_dot2_f32_bf16 v37, v10, s77, v197
v_dot2_f32_bf16 v38, v11, s76, v198
v_dot2_f32_bf16 v39, v11, s77, v199
v_cvt_pk_bf16_f32 v64, v32, v33
v_cvt_pk_bf16_f32 v65, v34, v35
v_cvt_pk_bf16_f32 v66, v36, v37
v_cvt_pk_bf16_f32 v67, v38, v39
s_nop 0
v_permlane16_swap_b32 v64, v66
v_permlane16_swap_b32 v65, v67
v_cvt_pk_bf16_f32 v8, v40, v41
v_cvt_pk_bf16_f32 v9, v42, v43
v_cvt_pk_bf16_f32 v10, v44, v45
v_cvt_pk_bf16_f32 v11, v46, v47
v_dot2_f32_bf16 v40, v8, s76, v200
v_dot2_f32_bf16 v41, v8, s77, v201
v_dot2_f32_bf16 v42, v9, s76, v202
v_dot2_f32_bf16 v43, v9, s77, v203
v_dot2_f32_bf16 v44, v10, s76, v204
v_dot2_f32_bf16 v45, v10, s77, v205
v_dot2_f32_bf16 v46, v11, s76, v206
v_dot2_f32_bf16 v47, v11, s77, v207
v_cvt_pk_bf16_f32 v72, v40, v41
v_cvt_pk_bf16_f32 v73, v42, v43
v_cvt_pk_bf16_f32 v74, v44, v45
v_cvt_pk_bf16_f32 v75, v46, v47
s_nop 0
v_permlane16_swap_b32 v72, v74
v_permlane16_swap_b32 v73, v75
s_mul_i32 s72, s80, 4096
s_add_u32 s72, s72, 0x780000
v_lshlrev_b32 v12, 4, v0
buffer_store_dwordx4 v[48:51], v12, s[16:19], s72 offen offset:0 sc1
buffer_store_dwordx4 v[56:59], v12, s[16:19], s72 offen offset:1024 sc1
buffer_store_dwordx4 v[64:67], v12, s[16:19], s72 offen offset:2048 sc1
buffer_store_dwordx4 v[72:75], v12, s[16:19], s72 offen offset:3072 sc1
s_endpgm
L_mover:
s_lshr_b32 s82, s2, 4
s_and_b32 s83, s2, 15
v_lshrrev_b32 v3, 3, v0
v_mul_u32_u24 v3, 1152, v3
v_lshrrev_b32 v4, 4, v0
v_and_b32 v4, 1, v4
v_lshlrev_b32 v4, 1, v4
v_and_b32 v5, 7, v0
v_xor_b32 v4, v4, v5
v_lshlrev_b32 v4, 4, v4
v_add_u32 v6, v3, v4
v_xor_b32 v7, 64, v6
s_mul_i32 s68, s83, 147456
s_lshl_b32 s69, s82, 7
s_add_u32 s68, s68, s69
s_setprio 1
v_mov_b32 v101, 0
s_waitcnt lgkmcnt(0)
s_barrier
s_mov_b32 s16, s62
s_mov_b32 s17, s63
s_mov_b32 s18, 0x2000000
s_mov_b32 s19, 0x20000
s_mov_b32 s20, s58
s_mov_b32 s21, s59
s_mov_b32 s22, 0x480000
s_mov_b32 s23, 0x20000
s_mov_b32 s8, s44
s_mov_b32 s9, s45
s_mov_b32 s10, 0x240000
s_mov_b32 s11, 0x20000
s_mov_b32 s65, 0
s_cmp_ge_u32 s65, 8
s_cbranch_scc1 ok_215
poll_216:
ds_read_b128 v[102:105], v101 offset:16
s_waitcnt lgkmcnt(0)
v_min_u32 v102, v102, v103
v_min3_u32 v102, v102, v104, v105
s_nop 0
v_readfirstlane_b32 s65, v102
s_cmp_ge_u32 s65, 8
s_cbranch_scc1 ok_215
s_sub_u32 s64, s64, 1
s_cbranch_scc0 poll_216
s_mov_b32 s64, 0
ok_215:
s_add_u32 m0, s81, 0
s_nop 0
buffer_load_dwordx4 v6, s[8:11], s68 offen lds
s_add_u32 s68, s68, 9216
s_add_u32 m0, s81, 1024
s_nop 0
buffer_load_dwordx4 v7, s[8:11], s68 offen lds
s_add_u32 s68, s68, 9216
s_add_u32 m0, s81, 2048
s_nop 0
buffer_load_dwordx4 v6, s[8:11], s68 offen lds
s_add_u32 s68, s68, 9216
s_add_u32 m0, s81, 3072
s_nop 0
buffer_load_dwordx4 v7, s[8:11], s68 offen lds
s_add_u32 s68, s68, 9216
s_add_u32 m0, s81, 4096
s_nop 0
buffer_load_dwordx4 v6, s[8:11], s68 offen lds
s_add_u32 s68, s68, 9216
s_add_u32 m0, s81, 5120
s_nop 0
buffer_load_dwordx4 v7, s[8:11], s68 offen lds
s_add_u32 s68, s68, 9216
s_add_u32 m0, s81, 6144
s_nop 0
buffer_load_dwordx4 v6, s[8:11], s68 offen lds
s_add_u32 s68, s68, 9216
s_add_u32 m0, s81, 7168
s_nop 0
buffer_load_dwordx4 v7, s[8:11], s68 offen lds
s_add_u32 s68, s68, 9216
s_add_u32 m0, s81, 8192
s_nop 0
buffer_load_dwordx4 v6, s[8:11], s68 offen lds
s_add_u32 s68, s68, 9216
s_add_u32 m0, s81, 9216
s_nop 0
buffer_load_dwordx4 v7, s[8:11], s68 offen lds
s_add_u32 s68, s68, 9216
s_add_u32 m0, s81, 10240
s_nop 0
buffer_load_dwordx4 v6, s[8:11], s68 offen lds
s_add_u32 s68, s68, 9216
s_add_u32 m0, s81, 11264
s_nop 0
buffer_load_dwordx4 v7, s[8:11], s68 offen lds
s_add_u32 s68, s68, 9216
s_add_u32 m0, s81, 12288
s_nop 0
buffer_load_dwordx4 v6, s[8:11], s68 offen lds
s_add_u32 s68, s68, 9216
s_add_u32 m0, s81, 13312
s_nop 0
buffer_load_dwordx4 v7, s[8:11], s68 offen lds
s_add_u32 s68, s68, 9216
s_add_u32 m0, s81, 14336
s_nop 0
buffer_load_dwordx4 v6, s[8:11], s68 offen lds
s_add_u32 s68, s68, 9216
s_add_u32 m0, s81, 15360
s_nop 0
buffer_load_dwordx4 v7, s[8:11], s68 offen lds
s_add_u32 s68, s68, 9216
s_mov_b32 s28, s60
s_mov_b32 s29, s61
s_mov_b32 s30, 0x100
s_mov_b32 s31, 0x20000
v_and_b32 v1, 15, v0
v_lshrrev_b32 v2, 4, v0
v_lshrrev_b32 v8, 2, v1
v_and_b32 v9, 3, v1
v_lshlrev_b32 v10, 3, v2
v_add_u32 v10, v10, v8
v_lshlrev_b32 v10, 7, v10
v_lshrrev_b32 v11, 1, v8
v_and_b32 v12, 1, v2
v_lshlrev_b32 v12, 1, v12
v_or_b32 v11, v11, v12
v_lshlrev_b32 v11, 5, v11
v_add_u32 v10, v10, v11
v_lshlrev_b32 v11, 3, v9
v_add_u32 v10, v10, v11
v_add_u32 v10, s81, v10
v_xor_b32 v11, v2, v1
v_lshlrev_b32 v11, 4, v11
v_lshlrev_b32 v12, 8, v1
v_add_u32 v11, v11, v12
v_add_u32 v11, s81, v11
v_add_u32 v11, 16384, v11
v_xor_b32 v12, v2, v1
v_lshlrev_b32 v12, 4, v12
v_lshlrev_b32 v13, 8, v2
v_add_u32 v12, v12, v13
v_add_u32 v12, s81, v12
v_add_u32 v12, 16384, v12
v_mul_u32_u24 v13, 4096, v2
v_lshlrev_b32 v14, 4, v1
v_add_u32 v13, v13, v14
s_mul_i32 s68, s82, 262144
s_lshl_b32 s69, s83, 8
s_add_u32 s68, s68, s69
s_add_u32 s68, s68, 0x500000
v_mov_b32 v101, 0
s_waitcnt vmcnt(0)
buffer_load_dword v100, v101, s[28:31], 0 offen sc1
v_subrev_u32 v11, 16384, v11
v_subrev_u32 v12, 16384, v12
v_xor_b32 v14, 0, v10
ds_read_b64_tr_b16 v[32:33], v14 offset:0
ds_read_b64_tr_b16 v[34:35], v14 offset:512
ds_read_b64_tr_b16 v[36:37], v14 offset:4096
ds_read_b64_tr_b16 v[38:39], v14 offset:4608
ds_read_b64_tr_b16 v[40:41], v14 offset:8192
ds_read_b64_tr_b16 v[42:43], v14 offset:8704
ds_read_b64_tr_b16 v[44:45], v14 offset:12288
ds_read_b64_tr_b16 v[46:47], v14 offset:12800
v_xor_b32 v14, 32, v10
ds_read_b64_tr_b16 v[48:49], v14 offset:0
ds_read_b64_tr_b16 v[50:51], v14 offset:512
ds_read_b64_tr_b16 v[52:53], v14 offset:4096
ds_read_b64_tr_b16 v[54:55], v14 offset:4608
ds_read_b64_tr_b16 v[56:57], v14 offset:8192
ds_read_b64_tr_b16 v[58:59], v14 offset:8704
ds_read_b64_tr_b16 v[60:61], v14 offset:12288
ds_read_b64_tr_b16 v[62:63], v14 offset:12800
v_xor_b32 v14, 64, v10
ds_read_b64_tr_b16 v[64:65], v14 offset:0
ds_read_b64_tr_b16 v[66:67], v14 offset:512
ds_read_b64_tr_b16 v[68:69], v14 offset:4096
ds_read_b64_tr_b16 v[70:71], v14 offset:4608
ds_read_b64_tr_b16 v[72:73], v14 offset:8192
ds_read_b64_tr_b16 v[74:75], v14 offset:8704
ds_read_b64_tr_b16 v[76:77], v14 offset:12288
ds_read_b64_tr_b16 v[78:79], v14 offset:12800
v_xor_b32 v14, 96, v10
ds_read_b64_tr_b16 v[80:81], v14 offset:0
ds_read_b64_tr_b16 v[82:83], v14 offset:512
ds_read_b64_tr_b16 v[84:85], v14 offset:4096
ds_read_b64_tr_b16 v[86:87], v14 offset:4608
ds_read_b64_tr_b16 v[88:89], v14 offset:8192
ds_read_b64_tr_b16 v[90:91], v14 offset:8704
ds_read_b64_tr_b16 v[92:93], v14 offset:12288
ds_read_b64_tr_b16 v[94:95], v14 offset:12800
v_xor_b32 v168, 0, v11
v_xor_b32 v169, 64, v11
v_xor_b32 v170, 128, v11
v_xor_b32 v171, 192, v11
s_waitcnt lgkmcnt(0)
ds_write_b128 v168, v[32:35] offset:0
ds_write_b128 v169, v[36:39] offset:0
ds_write_b128 v170, v[40:43] offset:0
ds_write_b128 v171, v[44:47] offset:0
ds_write_b128 v168, v[48:51] offset:4096
ds_write_b128 v169, v[52:55] offset:4096
ds_write_b128 v170, v[56:59] offset:4096
ds_write_b128 v171, v[60:63] offset:4096
ds_write_b128 v168, v[64:67] offset:8192
ds_write_b128 v169, v[68:71] offset:8192
ds_write_b128 v170, v[72:75] offset:8192
ds_write_b128 v171, v[76:79] offset:8192
ds_write_b128 v168, v[80:83] offset:12288
ds_write_b128 v169, v[84:87] offset:12288
ds_write_b128 v170, v[88:91] offset:12288
ds_write_b128 v171, v[92:95] offset:12288
v_xor_b32 v168, 0, v12
v_xor_b32 v169, 64, v12
v_xor_b32 v170, 128, v12
v_xor_b32 v171, 192, v12
s_waitcnt lgkmcnt(0)
ds_read_b128 v[104:107], v168 offset:0
ds_read_b128 v[108:111], v169 offset:1024
ds_read_b128 v[112:115], v170 offset:2048
ds_read_b128 v[116:119], v171 offset:3072
ds_read_b128 v[120:123], v168 offset:4096
ds_read_b128 v[124:127], v169 offset:5120
ds_read_b128 v[128:131], v170 offset:6144
ds_read_b128 v[132:135], v171 offset:7168
ds_read_b128 v[136:139], v168 offset:8192
ds_read_b128 v[140:143], v169 offset:9216
ds_read_b128 v[144:147], v170 offset:10240
ds_read_b128 v[148:151], v171 offset:11264
ds_read_b128 v[152:155], v168 offset:12288
ds_read_b128 v[156:159], v169 offset:13312
ds_read_b128 v[160:163], v170 offset:14336
ds_read_b128 v[164:167], v171 offset:15360
s_waitcnt lgkmcnt(15)
buffer_store_dwordx4 v[104:107], v13, s[16:19], s68 offen sc1
s_add_u32 s68, s68, 16384
s_waitcnt lgkmcnt(14)
buffer_store_dwordx4 v[108:111], v13, s[16:19], s68 offen sc1
s_add_u32 s68, s68, 16384
s_waitcnt lgkmcnt(13)
buffer_store_dwordx4 v[112:115], v13, s[16:19], s68 offen sc1
s_add_u32 s68, s68, 16384
s_waitcnt lgkmcnt(12)
buffer_store_dwordx4 v[116:119], v13, s[16:19], s68 offen sc1
s_add_u32 s68, s68, 16384
s_waitcnt lgkmcnt(11)
buffer_store_dwordx4 v[120:123], v13, s[16:19], s68 offen sc1
s_add_u32 s68, s68, 16384
s_waitcnt lgkmcnt(10)
buffer_store_dwordx4 v[124:127], v13, s[16:19], s68 offen sc1
s_add_u32 s68, s68, 16384
s_waitcnt lgkmcnt(9)
buffer_store_dwordx4 v[128:131], v13, s[16:19], s68 offen sc1
s_add_u32 s68, s68, 16384
s_waitcnt lgkmcnt(8)
buffer_store_dwordx4 v[132:135], v13, s[16:19], s68 offen sc1
s_add_u32 s68, s68, 16384
s_waitcnt lgkmcnt(7)
buffer_store_dwordx4 v[136:139], v13, s[16:19], s68 offen sc1
s_add_u32 s68, s68, 16384
s_waitcnt lgkmcnt(6)
buffer_store_dwordx4 v[140:143], v13, s[16:19], s68 offen sc1
s_add_u32 s68, s68, 16384
s_waitcnt lgkmcnt(5)
buffer_store_dwordx4 v[144:147], v13, s[16:19], s68 offen sc1
s_add_u32 s68, s68, 16384
s_waitcnt lgkmcnt(4)
buffer_store_dwordx4 v[148:151], v13, s[16:19], s68 offen sc1
s_add_u32 s68, s68, 16384
s_waitcnt lgkmcnt(3)
buffer_store_dwordx4 v[152:155], v13, s[16:19], s68 offen sc1
s_add_u32 s68, s68, 16384
s_waitcnt lgkmcnt(2)
buffer_store_dwordx4 v[156:159], v13, s[16:19], s68 offen sc1
s_add_u32 s68, s68, 16384
s_waitcnt lgkmcnt(1)
buffer_store_dwordx4 v[160:163], v13, s[16:19], s68 offen sc1
s_add_u32 s68, s68, 16384
s_waitcnt lgkmcnt(0)
buffer_store_dwordx4 v[164:167], v13, s[16:19], s68 offen sc1
s_add_u32 s68, s68, 16384
s_waitcnt vmcnt(0)
v_readfirstlane_b32 s66, v100
s_cmp_lg_u32 s66, 0
s_cbranch_scc1 nok_217
poll_219:
buffer_load_dword v100, v101, s[28:31], 0 offen sc1
s_waitcnt vmcnt(0)
v_readfirstlane_b32 s66, v100
s_cmp_lg_u32 s66, 0
s_cbranch_scc1 ok_218
s_sleep 1
s_sub_u32 s64, s64, 64
s_cbranch_scc0 poll_219
s_mov_b32 s64, 0
ok_218:
nok_217:
s_lshl_b32 s72, s2, 7
s_add_u32 s72, s72, 0xc80000
v_mov_b32 v17, s72
s_waitcnt vmcnt(0)
v_mov_b32 v16, s66
s_mov_b64 exec, 1
buffer_store_dword v16, v17, s[16:19], 0 offen sc1
s_mov_b64 exec, -1
s_mov_b32 s84, 0
L_yhalf:
s_setprio 1
s_lshr_b32 s82, s2, 4
s_and_b32 s83, s2, 15
v_mov_b32 v101, 0
v_and_b32 v1, 15, v0
v_lshrrev_b32 v2, 4, v0
v_lshrrev_b32 v4, 3, v0
v_mul_u32_u24 v3, 4096, v4
v_and_b32 v4, 2, v4
v_and_b32 v5, 7, v0
v_xor_b32 v4, v4, v5
v_lshl_add_u32 v20, v4, 4, v3
v_xor_b32 v21, 64, v20
s_mul_i32 s70, s82, 262144
s_lshr_b32 s69, s83, 2
s_lshl_b32 s69, s69, 10
s_add_u32 s70, s70, s69
s_and_b32 s69, s83, 3
s_lshl_b32 s69, s69, 7
s_add_u32 s70, s70, s69
s_lshl_b32 s69, s84, 9
s_add_u32 s70, s70, s69
s_add_u32 s90, s70, 0x780000
v_lshrrev_b32 v8, 2, v1
v_and_b32 v9, 3, v1
v_lshl_add_u32 v10, v2, 3, v8
v_lshlrev_b32 v10, 7, v10
v_and_b32 v11, 2, v8
v_and_b32 v12, 1, v2
v_lshl_or_b32 v11, v12, 2, v11
v_lshrrev_b32 v12, 1, v9
v_xor_b32 v11, v11, v12
v_lshl_add_u32 v10, v11, 4, v10
v_and_b32 v11, 1, v9
v_lshl_add_u32 v10, v11, 3, v10
v_add_u32 v10, s81, v10
v_lshrrev_b32 v11, 1, v1
v_xor_b32 v11, v11, v2
v_lshlrev_b32 v11, 4, v11
v_lshl_add_u32 v11, v1, 7, v11
v_add_u32 v11, s81, v11
v_xor_b32 v18, 64, v11
v_lshrrev_b32 v12, 3, v0
v_lshrrev_b32 v13, 1, v12
v_and_b32 v14, 7, v0
v_xor_b32 v13, v13, v14
v_lshlrev_b32 v13, 4, v13
v_lshl_add_u32 v13, v12, 7, v13
v_add_u32 v13, s81, v13
v_xor_b32 v19, 64, v13
v_mul_u32_u24 v12, 2304, v12
v_lshl_add_u32 v12, v14, 4, v12
s_lshl_b32 s75, s83, 4
s_add_u32 s75, s75, s84
s_mul_i32 s75, s75, 18432
s_lshl_b32 s69, s82, 7
s_add_u32 s75, s75, s69
s_add_u32 s75, s75, 1152
v_lshlrev_b32 v28, 4, v0
v_add_u32 v28, s81, v28
s_mov_b32 s65, 0
s_cmp_lg_u32 s84, 0
s_cbranch_scc1 ylw_221
s_lshl_b32 s72, s82, 13
s_add_u32 s72, s72, 0xca0000
v_lshlrev_b32 v14, 7, v0
v_add_u32 v14, s72, v14
s_cmp_ge_u32 s65, 6
s_cbranch_scc1 ok_222
poll_223:
ds_read_b32 v102, v101 offset:96
s_waitcnt lgkmcnt(0)
v_readfirstlane_b32 s65, v102
s_cmp_ge_u32 s65, 6
s_cbranch_scc1 ok_222
s_sub_u32 s64, s64, 1
s_cbranch_scc0 poll_223
s_mov_b32 s64, 0
ok_222:
s_sleep 18
s_mov_b64 s[70:71], exec
poll_225:
buffer_load_dword v15, v14, s[16:19], 0 offen sc1
s_waitcnt vmcnt(0)
v_cmp_ne_u32 vcc, s66, v15
s_cmp_eq_u64 vcc, 0
s_cbranch_scc1 ok_224
s_sleep 3
s_sub_u32 s64, s64, 64
s_cbranch_scc0 poll_225
s_mov_b32 s64, 0
ok_224:
s_mov_b64 exec, s[70:71]
v_mov_b32 v15, 1
ds_write_b32 v101, v15 offset:128
s_branch ygo_220
ylw_221:
s_cmp_ge_u32 s65, 1
s_cbranch_scc1 ok_226
poll_227:
ds_read_b32 v102, v101 offset:128
s_waitcnt lgkmcnt(0)
v_readfirstlane_b32 s65, v102
s_cmp_ge_u32 s65, 1
s_cbranch_scc1 ok_226
s_sleep 2
s_sub_u32 s64, s64, 1
s_cbranch_scc0 poll_227
s_mov_b32 s64, 0
ok_226:
ygo_220:
s_mov_b32 s93, 1
s_add_u32 s91, s90, 0
buffer_load_dwordx4 v[96:99], v20, s[16:19], s91 offen sc1
s_add_u32 s91, s90, 32768
buffer_load_dwordx4 v[100:103], v21, s[16:19], s91 offen sc1
s_add_u32 s91, s90, 65536
buffer_load_dwordx4 v[104:107], v20, s[16:19], s91 offen sc1
s_add_u32 s91, s90, 98304
buffer_load_dwordx4 v[108:111], v21, s[16:19], s91 offen sc1
s_add_u32 s91, s90, 131072
buffer_load_dwordx4 v[112:115], v20, s[16:19], s91 offen sc1
s_add_u32 s91, s90, 163840
buffer_load_dwordx4 v[116:119], v21, s[16:19], s91 offen sc1
s_add_u32 s91, s90, 196608
buffer_load_dwordx4 v[120:123], v20, s[16:19], s91 offen sc1
s_add_u32 s91, s90, 229376
buffer_load_dwordx4 v[124:127], v21, s[16:19], s91 offen sc1
s_waitcnt vmcnt(7)
v_max_u32 v24, v96, v97
ds_write_b128 v28, v[96:99] offset:0
v_max3_u32 v24, v98, v99, v24
s_waitcnt vmcnt(6)
v_max3_u32 v24, v100, v101, v24
ds_write_b128 v28, v[100:103] offset:1024
v_max3_u32 v24, v102, v103, v24
s_waitcnt vmcnt(5)
v_max_u32 v25, v104, v105
ds_write_b128 v28, v[104:107] offset:2048
v_max3_u32 v25, v106, v107, v25
s_waitcnt vmcnt(4)
v_max3_u32 v25, v108, v109, v25
ds_write_b128 v28, v[108:111] offset:3072
v_max3_u32 v25, v110, v111, v25
s_waitcnt vmcnt(3)
v_max_u32 v26, v112, v113
ds_write_b128 v28, v[112:115] offset:4096
v_max3_u32 v26, v114, v115, v26
s_waitcnt vmcnt(2)
v_max3_u32 v26, v116, v117, v26
ds_write_b128 v28, v[116:119] offset:5120
v_max3_u32 v26, v118, v119, v26
s_waitcnt vmcnt(1)
v_max_u32 v27, v120, v121
ds_write_b128 v28, v[120:123] offset:6144
v_max3_u32 v27, v122, v123, v27
s_waitcnt vmcnt(0)
v_max3_u32 v27, v124, v125, v27
ds_write_b128 v28, v[124:127] offset:7168
v_max3_u32 v27, v126, v127, v27
v_max3_u32 v29, v24, v25, v26
v_max_u32 v29, v29, v27
v_cmp_eq_u32 vcc, -1, v29
s_cbranch_vccnz yslow_228
ygood_229:
s_waitcnt lgkmcnt(0)
v_xor_b32 v14, 0, v10
ds_read_b64_tr_b16 v[32:33], v14 offset:0
ds_read_b64_tr_b16 v[34:35], v14 offset:512
ds_read_b64_tr_b16 v[36:37], v14 offset:4096
ds_read_b64_tr_b16 v[38:39], v14 offset:4608
v_xor_b32 v14, 32, v10
ds_read_b64_tr_b16 v[40:41], v14 offset:0
ds_read_b64_tr_b16 v[42:43], v14 offset:512
ds_read_b64_tr_b16 v[44:45], v14 offset:4096
ds_read_b64_tr_b16 v[46:47], v14 offset:4608
v_xor_b32 v14, 64, v10
ds_read_b64_tr_b16 v[48:49], v14 offset:0
ds_read_b64_tr_b16 v[50:51], v14 offset:512
ds_read_b64_tr_b16 v[52:53], v14 offset:4096
ds_read_b64_tr_b16 v[54:55], v14 offset:4608
v_xor_b32 v14, 96, v10
ds_read_b64_tr_b16 v[56:57], v14 offset:0
ds_read_b64_tr_b16 v[58:59], v14 offset:512
ds_read_b64_tr_b16 v[60:61], v14 offset:4096
ds_read_b64_tr_b16 v[62:63], v14 offset:4608
s_waitcnt lgkmcnt(0)
ds_write_b128 v11, v[32:35] offset:0
ds_write_b128 v18, v[36:39] offset:0
ds_write_b128 v11, v[40:43] offset:2048
ds_write_b128 v18, v[44:47] offset:2048
ds_write_b128 v11, v[48:51] offset:4096
ds_write_b128 v18, v[52:55] offset:4096
ds_write_b128 v11, v[56:59] offset:6144
ds_write_b128 v18, v[60:63] offset:6144
s_waitcnt lgkmcnt(0)
ds_read_b128 v[96:99], v13 offset:0
ds_read_b128 v[100:103], v19 offset:1024
ds_read_b128 v[104:107], v13 offset:2048
ds_read_b128 v[108:111], v19 offset:3072
ds_read_b128 v[112:115], v13 offset:4096
ds_read_b128 v[116:119], v19 offset:5120
ds_read_b128 v[120:123], v13 offset:6144
ds_read_b128 v[124:127], v19 offset:7168
s_waitcnt lgkmcnt(7)
buffer_store_dwordx4 v[96:99], v12, s[20:23], s75 offen nt
s_add_u32 s75, s75, 36864
s_waitcnt lgkmcnt(6)
buffer_store_dwordx4 v[100:103], v12, s[20:23], s75 offen nt
s_add_u32 s75, s75, 36864
s_waitcnt lgkmcnt(5)
buffer_store_dwordx4 v[104:107], v12, s[20:23], s75 offen nt
s_add_u32 s75, s75, 36864
s_waitcnt lgkmcnt(4)
buffer_store_dwordx4 v[108:111], v12, s[20:23], s75 offen nt
s_add_u32 s75, s75, 36864
s_waitcnt lgkmcnt(3)
buffer_store_dwordx4 v[112:115], v12, s[20:23], s75 offen nt
s_add_u32 s75, s75, 36864
s_waitcnt lgkmcnt(2)
buffer_store_dwordx4 v[116:119], v12, s[20:23], s75 offen nt
s_add_u32 s75, s75, 36864
s_waitcnt lgkmcnt(1)
buffer_store_dwordx4 v[120:123], v12, s[20:23], s75 offen nt
s_add_u32 s75, s75, 36864
s_waitcnt lgkmcnt(0)
buffer_store_dwordx4 v[124:127], v12, s[20:23], s75 offen nt
L_end:
s_endpgm
yslow_228:
yloop_230:
s_add_u32 s93, s93, 1
s_sleep 1
s_mov_b32 s92, 0
v_cmp_eq_u32 vcc, -1, v24
s_cbranch_vccz ysk_231
s_add_u32 s91, s90, 0
buffer_load_dwordx4 v[96:99], v20, s[16:19], s91 offen sc1
s_add_u32 s91, s90, 32768
buffer_load_dwordx4 v[100:103], v21, s[16:19], s91 offen sc1
s_bitset1_b32 s92, 0
ysk_231:
v_cmp_eq_u32 vcc, -1, v25
s_cbranch_vccz ysk_232
s_add_u32 s91, s90, 65536
buffer_load_dwordx4 v[104:107], v20, s[16:19], s91 offen sc1
s_add_u32 s91, s90, 98304
buffer_load_dwordx4 v[108:111], v21, s[16:19], s91 offen sc1
s_bitset1_b32 s92, 1
ysk_232:
v_cmp_eq_u32 vcc, -1, v26
s_cbranch_vccz ysk_233
s_add_u32 s91, s90, 131072
buffer_load_dwordx4 v[112:115], v20, s[16:19], s91 offen sc1
s_add_u32 s91, s90, 163840
buffer_load_dwordx4 v[116:119], v21, s[16:19], s91 offen sc1
s_bitset1_b32 s92, 2
ysk_233:
v_cmp_eq_u32 vcc, -1, v27
s_cbranch_vccz ysk_234
s_add_u32 s91, s90, 196608
buffer_load_dwordx4 v[120:123], v20, s[16:19], s91 offen sc1
s_add_u32 s91, s90, 229376
buffer_load_dwordx4 v[124:127], v21, s[16:19], s91 offen sc1
s_bitset1_b32 s92, 3
ysk_234:
s_waitcnt vmcnt(0)
s_bitcmp1_b32 s92, 0
s_cbranch_scc0 ysk_235
v_max_u32 v24, v96, v97
ds_write_b128 v28, v[96:99] offset:0
v_max3_u32 v24, v98, v99, v24
v_max3_u32 v24, v100, v101, v24
ds_write_b128 v28, v[100:103] offset:1024
v_max3_u32 v24, v102, v103, v24
ysk_235:
s_bitcmp1_b32 s92, 1
s_cbranch_scc0 ysk_236
v_max_u32 v25, v104, v105
ds_write_b128 v28, v[104:107] offset:2048
v_max3_u32 v25, v106, v107, v25
v_max3_u32 v25, v108, v109, v25
ds_write_b128 v28, v[108:111] offset:3072
v_max3_u32 v25, v110, v111, v25
ysk_236:
s_bitcmp1_b32 s92, 2
s_cbranch_scc0 ysk_237
v_max_u32 v26, v112, v113
ds_write_b128 v28, v[112:115] offset:4096
v_max3_u32 v26, v114, v115, v26
v_max3_u32 v26, v116, v117, v26
ds_write_b128 v28, v[116:119] offset:5120
v_max3_u32 v26, v118, v119, v26
ysk_237:
s_bitcmp1_b32 s92, 3
s_cbranch_scc0 ysk_238
v_max_u32 v27, v120, v121
ds_write_b128 v28, v[120:123] offset:6144
v_max3_u32 v27, v122, v123, v27
v_max3_u32 v27, v124, v125, v27
ds_write_b128 v28, v[124:127] offset:7168
v_max3_u32 v27, v126, v127, v27
ysk_238:
v_max3_u32 v29, v24, v25, v26
v_max_u32 v29, v29, v27
v_cmp_eq_u32 vcc, -1, v29
s_cbranch_vccz ygood_229
s_sub_u32 s64, s64, 64
s_cbranch_scc0 yloop_230
s_mov_b32 s64, 0
s_branch ygood_229
.section .rodata,"a"
.p2align 6
.amdhsa_kernel concat_heads__linear_kernel_hedgehog__ssm_conv_s4d__prompt_kernel
  .amdhsa_next_free_vgpr 256
  .amdhsa_next_free_sgpr 102
  .amdhsa_accum_offset 256
  .amdhsa_group_segment_fixed_size 0
  .amdhsa_kernarg_size 112
  .amdhsa_user_sgpr_count 2
  .amdhsa_user_sgpr_kernarg_segment_ptr 1
  .amdhsa_system_sgpr_workgroup_id_x 1
.end_amdhsa_kernel
```
